```python
import torch

def _softmax(x, axis=-1):
    return torch.softmax(x, dim=axis)
def _gelu(x):
    return torch.nn.functional.gelu(x, approximate="tanh")
def _silu(x):
    return torch.nn.functional.silu(x)
def _sigmoid(x):
    return torch.sigmoid(x)
def _layernorm(x, axis=-1, eps=1e-5):
    m = x.mean(dim=axis, keepdim=True)
    v = x.var(dim=axis, keepdim=True, unbiased=False)
    return (x - m) / torch.sqrt(v + eps)
def _scatter_add(tgt, idx, src, axis=0):
    return tgt.clone().index_add_(axis, idx, src)
def _segment_sum(src, seg, n):
    out = torch.zeros((n,) + src.shape[1:], dtype=src.dtype)
    return out.index_add_(0, seg, src)
def _pad(x, pw):
    flat = tuple(v for pair in reversed(pw) for v in pair)
    return torch.nn.functional.pad(x, flat)

kernel_name = 'parallel_sum__ssm_conv_s4__dense_activation_gelu__prompt'

def setup_inputs():

    _w = (lambda a: (lambda t: t.to(torch.bfloat16) if t.is_floating_point() else t)(torch.as_tensor(a)))
    def _A_setup():
        B, L, D, N = 1, 2048, 576, 128
        A_re = -(lambda _x: torch.exp(torch.as_tensor(_x)))((lambda *s: torch.randn(*s, dtype=torch.bfloat16) * 6.4)(D, N))
        A_im = torch.pi * (lambda *s: torch.randn(*s, dtype=torch.bfloat16) * 0.05)(D, N)
        B_re = (lambda *s: torch.randn(*s, dtype=torch.bfloat16) * 0.1)(D, N)
        B_im = (lambda *s: torch.randn(*s, dtype=torch.bfloat16) * 0.1)(D, N)
        C_re = (lambda *s: torch.randn(*s, dtype=torch.bfloat16) * 0.1)(D, N)
        C_im = (lambda *s: torch.randn(*s, dtype=torch.bfloat16) * 0.1)(D, N)
        log_dt = (lambda *s: torch.randn(*s, dtype=torch.bfloat16) * 0.05)(D) * 0.5 - 4.0
        Dskip = (lambda *s: torch.randn(*s, dtype=torch.bfloat16) * 0.05)(D)
        return {
            "u": _w((lambda *s: torch.randn(*s, dtype=torch.bfloat16) * 0.05)(B, L, D)),
            "A_re": _w(A_re),
            "A_im": _w(A_im),
            "B_re": _w(B_re),
            "B_im": _w(B_im),
            "C_re": _w(C_re),
            "C_im": _w(C_im),
            "log_dt": _w(log_dt),
            "Dskip": _w(Dskip),
        }
    _A_in = _A_setup()

    def _B_setup():
        B, S, D, F = 1, 2048, 576, 4608
        return {
            "x": _w((lambda *s: torch.randn(*s, dtype=torch.bfloat16) * 0.05)(B, S, D)),
            "w1": _w((lambda *s: torch.randn(*s, dtype=torch.bfloat16) * 0.8)(D, F) * (D ** -0.5)),
            "b1": _w((lambda *s: torch.randn(*s, dtype=torch.bfloat16) * 0.2)(F) * 0.01),
            "w2": _w((lambda *s: torch.randn(*s, dtype=torch.bfloat16) * 0.2)(F, D) * (F ** -0.5)),
            "b2": _w((lambda *s: torch.randn(*s, dtype=torch.bfloat16) * 0.2)(D) * 0.01),
        }
    _B_in = _B_setup()

    return {
        "A_u": _A_in["u"],
        "A_A_re": _A_in["A_re"],
        "A_A_im": _A_in["A_im"],
        "A_B_re": _A_in["B_re"],
        "A_B_im": _A_in["B_im"],
        "A_C_re": _A_in["C_re"],
        "A_C_im": _A_in["C_im"],
        "A_log_dt": _A_in["log_dt"],
        "A_Dskip": _A_in["Dskip"],
        "B_x": _B_in["x"],
        "B_w1": _B_in["w1"],
        "B_b1": _B_in["b1"],
        "B_w2": _B_in["w2"],
        "B_b2": _B_in["b2"],
    }

def reference(A_u, A_A_re, A_A_im, A_B_re, A_B_im, A_C_re, A_C_im, A_log_dt, A_Dskip, B_x, B_w1, B_b1, B_w2, B_b2):
    def _A_ref(u, A_re, A_im, B_re, B_im, C_re, C_im, log_dt, Dskip):
        Bsz, L, D = u.shape
        dt = torch.exp(log_dt)[:, None]
        A = A_re + 1j * A_im
        Bc = B_re + 1j * B_im
        Cc = C_re + 1j * C_im
        logdA = dt * A
        dB = dt * Bc
        l = (lambda x, dt: x.to(dt))(torch.arange(L), A_re.dtype)
        P = torch.exp(logdA[:, :, None] * l[None, None, :])
        K = torch.einsum("dn,dnl,dn->dl", Cc, P, dB).real
        L2 = 2 * L
        Kp = _pad(K, ((0, 0), (0, L)))
        up = (lambda x, *d: x.permute(*d))(u, 0, 2, 1)
        up = _pad(up, ((0, 0), (0, 0), (0, L)))
        Kf = (lambda x, axes=(-2,-1): torch.fft.rfft2(x.float(), dim=axes))(Kp[:, None, :], axes=(-2, -1))
        Uf = (lambda x, axes=(-2,-1): torch.fft.rfft2(x.float(), dim=axes))(up[:, :, None, :], axes=(-2, -1))
        Yf = Uf * Kf[None, :, :, :]
        y = (lambda x, s, axes=(-2,-1): torch.fft.irfft2(x, s=s, dim=axes).to(torch.bfloat16))(Yf, (1, L2), axes=(-2, -1))[:, :, 0, :L]
        y = (lambda x, *d: x.permute(*d))(y, 0, 2, 1) + u * Dskip[None, None, :]
        return y

    def _B_ref(x, w1, b1, w2, b2):
        h = torch.einsum("bsd,df->bsf", x, w1) + b1
        h = _gelu(h)
        return torch.einsum("bsf,fd->bsd", h, w2) + b2

    x = A_u
    xn = _layernorm(x, axis=-1)
    return x + _A_ref(xn, A_A_re, A_A_im, A_B_re, A_B_im, A_C_re, A_C_im, A_log_dt, A_Dskip) + _B_ref(xn, B_w1, B_b1, B_w2, B_b2)
```

```asm
; @launch kernel=ka_kernel grid=(256,1,1) block=(256,1,1) lds=157952
; @launch kernel=kb_kernel grid=(144,1,1) block=(512,1,1) lds=159296
.amdgcn_target "amdgcn-amd-amdhsa--gfx950"
.text
.globl ka_kernel
.p2align 8
.type ka_kernel,@function
ka_kernel:
  s_cmp_ge_u32 s2, 256
  s_cbranch_scc1 ka_end
  s_load_dwordx2 s[100:101], s[0:1], 0
  s_load_dwordx4 s[48:51], s[0:1], 80
  s_load_dwordx2 s[52:53], s[0:1], 96
  s_load_dwordx2 s[54:55], s[0:1], 128
  v_lshrrev_b32 v1, 6, v0
  v_and_b32 v2, 63, v0
  v_readfirstlane_b32 s43, v1
  s_getpc_b64 s[46:47]
ka_pc:
  s_lshr_b32 s5, s2, 3
  s_lshl_b32 s5, s5, 2
  s_add_u32 s5, s5, s43
  s_lshl_b32 s5, s5, 12
  v_lshl_add_u32 v44, v2, 6, s5
  v_min_u32 v44, k_code_end-ka_pc, v44
  v_mov_b32 v73, s47
  v_add_co_u32 v72, vcc, s46, v44
  s_nop 1
  v_addc_co_u32 v73, vcc, 0, v73, vcc
  global_load_dword v68, v[72:73], off
  s_and_b32 s3, s2, 3
  s_lshl_b32 s3, s3, 1
  s_bfe_u32 s4, s2, 0x10003
  s_add_u32 s3, s3, s4
  s_bfe_u32 s4, s2, 0x10002
  s_lshl_b32 s4, s4, 4
  s_lshr_b32 s5, s2, 4
  s_add_u32 s4, s4, s5
  s_and_b32 s61, s4, 1
  s_and_b32 s96, s4, 15
  v_lshlrev_b32 v3, 4, v2
  s_lshr_b32 s5, s2, 3
  s_lshl_b32 s5, s5, 2
  s_add_u32 s5, s5, s43
  s_mul_i32 s6, s5, 43
  s_lshr_b32 s6, s6, 8
  s_mul_i32 s7, s6, 6
  s_sub_u32 s5, s5, s7
  s_lshl_b32 s5, s5, 3
  s_add_u32 s5, s5, 8
  s_load_dwordx2 s[94:95], s[0:1], s5
  s_mul_i32 s7, s6, 86
  s_lshr_b32 s7, s7, 8
  s_mul_i32 s7, s7, 3
  s_sub_u32 s6, s6, s7
  s_mul_i32 s6, s6, 48
  v_min_u32 v74, 47, v2
  v_add_u32 v74, s6, v74
  s_and_b32 s5, s2, 7
  s_lshl_b32 s6, s5, 14
  s_lshl_b32 s5, s5, 11
  s_add_u32 s5, s5, 114688
  v_cmp_gt_u32 vcc, 128, v74
  v_mov_b32 v75, s5
  v_mov_b32 v76, s6
  v_cndmask_b32 v75, v75, v76, vcc
  v_lshl_add_u32 v74, v74, 7, v75
  s_lshl_b32 s5, s4, 6
  s_lshl_b32 s6, s43, 4
  s_add_u32 s5, s5, s6
  s_mul_i32 s5, s5, 1152
  v_lshrrev_b32 v32, 3, v2
  v_and_b32 v33, 7, v2
  v_mul_u32_u24 v34, 1152, v32
  v_lshl_add_u32 v34, v33, 4, v34
  v_add_u32 v34, s5, v34
  v_add_u32 v35, 9216, v34
  s_waitcnt lgkmcnt(0)
  global_load_dwordx4 v[128:131], v34, s[100:101] offset:0
  global_load_dwordx4 v[132:135], v34, s[100:101] offset:128
  global_load_dwordx4 v[136:139], v34, s[100:101] offset:256
  global_load_dwordx4 v[140:143], v34, s[100:101] offset:384
  global_load_dwordx4 v[144:147], v34, s[100:101] offset:512
  global_load_dwordx4 v[148:151], v34, s[100:101] offset:640
  global_load_dwordx4 v[152:155], v34, s[100:101] offset:768
  global_load_dwordx4 v[156:159], v34, s[100:101] offset:896
  global_load_dwordx4 v[160:163], v34, s[100:101] offset:1024
  global_load_dwordx4 v[164:167], v35, s[100:101] offset:0
  global_load_dwordx4 v[168:171], v35, s[100:101] offset:128
  global_load_dwordx4 v[172:175], v35, s[100:101] offset:256
  global_load_dwordx4 v[176:179], v35, s[100:101] offset:384
  global_load_dwordx4 v[180:183], v35, s[100:101] offset:512
  global_load_dwordx4 v[184:187], v35, s[100:101] offset:640
  global_load_dwordx4 v[188:191], v35, s[100:101] offset:768
  global_load_dwordx4 v[192:195], v35, s[100:101] offset:896
  global_load_dwordx4 v[196:199], v35, s[100:101] offset:1024
  s_mul_i32 s7, s3, 1152
  s_lshl_b32 s44, s43, 8
  s_lshl_b32 s46, s61, 7
  s_mul_i32 s47, s61, 73728
  s_add_u32 s5, s43, 0
  s_and_b32 s5, s5, 3
  s_mul_i32 s24, s5, 1327104
  s_add_u32 s24, s24, s7
  s_mul_i32 s6, s3, 663552
  s_mul_i32 s56, s5, 147456
  s_add_u32 s56, s56, s6
  s_add_u32 s28, s56, s47
  s_sub_u32 s56, s56, s47
  s_add_u32 s56, s56, 73728
  s_mul_i32 s32, s5, 18432
  s_add_u32 s32, s32, s6
  s_add_u32 s32, s32, 589824
  s_lshl_b32 s6, s5, 10
  s_add_u32 s6, s6, 32768
  v_add_u32 v18, s6, v3
  s_add_u32 s5, s43, 1
  s_and_b32 s5, s5, 3
  s_mul_i32 s25, s5, 1327104
  s_add_u32 s25, s25, s7
  s_mul_i32 s6, s3, 663552
  s_mul_i32 s57, s5, 147456
  s_add_u32 s57, s57, s6
  s_add_u32 s29, s57, s47
  s_sub_u32 s57, s57, s47
  s_add_u32 s57, s57, 73728
  s_mul_i32 s33, s5, 18432
  s_add_u32 s33, s33, s6
  s_add_u32 s33, s33, 589824
  s_cmp_eq_u32 s5, 0
  s_cselect_b32 s97, -3, 1
  s_mul_i32 s97, s97, 9216
  s_lshl_b32 s6, s5, 10
  s_add_u32 s6, s6, 32768
  v_add_u32 v19, s6, v3
  s_add_u32 s5, s43, 2
  s_and_b32 s5, s5, 3
  s_mul_i32 s26, s5, 1327104
  s_add_u32 s26, s26, s7
  s_mul_i32 s6, s3, 663552
  s_mul_i32 s58, s5, 147456
  s_add_u32 s58, s58, s6
  s_add_u32 s30, s58, s47
  s_sub_u32 s58, s58, s47
  s_add_u32 s58, s58, 73728
  s_mul_i32 s34, s5, 18432
  s_add_u32 s34, s34, s6
  s_add_u32 s34, s34, 589824
  s_cmp_eq_u32 s5, 0
  s_cselect_b32 s98, -3, 1
  s_mul_i32 s98, s98, 9216
  s_lshl_b32 s6, s5, 10
  s_add_u32 s6, s6, 32768
  v_add_u32 v20, s6, v3
  s_add_u32 s5, s43, 3
  s_and_b32 s5, s5, 3
  s_mul_i32 s27, s5, 1327104
  s_add_u32 s27, s27, s7
  s_mul_i32 s6, s3, 663552
  s_mul_i32 s59, s5, 147456
  s_add_u32 s59, s59, s6
  s_add_u32 s31, s59, s47
  s_sub_u32 s59, s59, s47
  s_add_u32 s59, s59, 73728
  s_mul_i32 s35, s5, 18432
  s_add_u32 s35, s35, s6
  s_add_u32 s35, s35, 589824
  s_cmp_eq_u32 s5, 0
  s_cselect_b32 s99, -3, 1
  s_mul_i32 s99, s99, 9216
  s_lshl_b32 s6, s5, 10
  s_add_u32 s6, s6, 32768
  v_add_u32 v21, s6, v3
  s_add_u32 s36, s24, 1024
  s_sub_u32 s36, s36, s44
  s_add_u32 s37, s28, 1024
  s_sub_u32 s37, s37, s44
  s_add_u32 s60, s56, 1024
  s_sub_u32 s60, s60, s44
  s_add_u32 s38, s32, 1024
  s_sub_u32 s38, s38, s44
  s_sub_u32 s36, s36, s46
  s_mul_i32 s41, s43, 20480
  s_add_u32 s41, s41, 73728
  v_lshrrev_b32 v32, 3, v2
  v_bfe_u32 v33, v2, 4, 1
  v_lshlrev_b32 v33, 2, v33
  v_and_b32 v34, 7, v2
  v_xor_b32 v33, v33, v34
  v_lshl_add_u32 v33, v33, 4, s44
  v_mul_u32_u24 v34, 9216, v32
  v_add_u32 v34, v34, v33
  v_add_u32 v4, s46, v34
  v_add_u32 v5, 72704, v4
  v_xor_b32 v6, 128, v4
  v_add_u32 v7, 72704, v6
  v_mul_u32_u24 v8, 1152, v32
  v_add_u32 v8, v8, v33
  v_add_u32 v9, 8192, v8
  s_mov_b32 s16, s54
  s_mov_b32 s17, s55
  s_mov_b32 s18, 268435456
  s_mov_b32 s19, 0x00020000
  s_mov_b32 s8, s48
  s_mov_b32 s9, s49
  s_mov_b32 s10, 5308416
  s_mov_b32 s11, 0x00020000
  s_mov_b32 s12, s52
  s_mov_b32 s13, s53
  s_mov_b32 s14, 5308416
  s_mov_b32 s15, 0x00020000
  s_mov_b32 s20, s50
  s_mov_b32 s21, s51
  s_mov_b32 s22, 9216
  s_mov_b32 s23, 0x00020000
  v_lshrrev_b32 v36, 5, v2
  v_and_b32 v37, 31, v2
  v_lshlrev_b32 v37, 1, v37
  v_lshl_add_u32 v36, v36, 14, v37
  s_lshl_b32 s5, s43, 14
  s_add_u32 s5, s5, 1024
  s_add_u32 s5, s5, s7
  v_add_u32 v53, s5, v36
  s_add_u32 s5, s44, s46
  v_add_u32 v54, s5, v36
  v_xor_b32 v55, 128, v54
  v_add_u32 v54, s7, v54
  v_add_u32 v55, s7, v55
  s_add_u32 m0, s41, 0
  s_add_u32 s42, s36, 0
  buffer_load_dwordx4 v4, s[8:11], s42 offen lds
  buffer_load_dwordx4 v5, s[8:11], s42 offen offset:1024 lds
  s_add_u32 m0, s41, 2048
  s_add_u32 s42, s36, 147456
  buffer_load_dwordx4 v4, s[8:11], s42 offen lds
  buffer_load_dwordx4 v5, s[8:11], s42 offen offset:1024 lds
  s_add_u32 m0, s41, 4096
  s_add_u32 s42, s36, 294912
  buffer_load_dwordx4 v4, s[8:11], s42 offen lds
  buffer_load_dwordx4 v5, s[8:11], s42 offen offset:1024 lds
  s_lshl_b32 s5, s4, 6
  v_add_u32 v52, s5, v2
  v_mul_u32_u24 v56, 1152, v52
  s_mul_i32 s5, s3, 144
  v_add_u32 v56, s5, v56
  s_lshl_b32 s5, s43, 4
  v_add_u32 v57, s5, v56
  s_and_b32 s5, s4, 15
  s_lshl_b32 s5, s5, 2
  s_add_u32 s5, s5, s43
  s_mul_i32 s6, s5, 81
  s_mul_i32 s45, s3, 663552
  v_add_u32 v43, 0, v2
  v_min_u32 v43, 80, v43
  v_add_u32 v43, s6, v43
  v_mul_u32_u24 v44, 7282, v43
  v_lshrrev_b32 v44, 16, v44
  v_mul_u32_u24 v44, 8064, v44
  v_lshlrev_b32 v43, 7, v43
  v_add3_u32 v69, v44, v43, s7
  v_add_u32 v58, s45, v43
  v_add_u32 v43, 64, v2
  v_min_u32 v43, 80, v43
  v_add_u32 v43, s6, v43
  v_mul_u32_u24 v44, 7282, v43
  v_lshrrev_b32 v44, 16, v44
  v_mul_u32_u24 v44, 8064, v44
  v_lshlrev_b32 v43, 7, v43
  v_add3_u32 v70, v44, v43, s7
  v_add_u32 v59, s45, v43
  v_lshrrev_b32 v32, 5, v2
  v_bfe_u32 v33, v2, 2, 2
  v_bfe_u32 v34, v2, 4, 1
  v_lshlrev_b32 v34, 5, v34
  v_and_b32 v36, 3, v2
  v_lshl_add_u32 v34, v36, 3, v34
  v_lshl_add_u32 v34, v33, 7, v34
  v_add_u32 v34, s41, v34
  v_bfe_u32 v36, v2, 3, 1
  v_lshlrev_b32 v36, 6, v36
  v_xor_b32 v37, 64, v36
  v_lshl_add_u32 v40, v32, 10, v34
  v_add_u32 v10, v40, v36
  v_add_u32 v11, v40, v37
  v_lshl_add_u32 v40, v32, 9, v34
  v_add_u32 v12, v40, v36
  v_add_u32 v13, v40, v37
  s_lshr_b32 s5, s43, 1
  s_lshl_b32 s6, s43, 4
  s_lshl_b32 s7, s5, 2
  s_add_u32 s6, s6, s7
  s_lshl_b32 s6, s6, 10
  s_mov_b32 s62, s6
  s_and_b32 s6, s43, 1
  s_lshl_b32 s6, s6, 1
  s_lshl_b32 s7, s5, 3
  s_add_u32 s6, s6, s7
  s_lshl_b32 s63, s6, 10
  v_bfe_u32 v33, v2, 1, 4
  v_and_b32 v36, 1, v2
  v_lshlrev_b32 v33, 4, v33
  v_lshl_add_u32 v33, v36, 8, v33
  v_lshl_add_u32 v25, v32, 17, v33
  s_lshl_b32 s7, s43, 13
  v_add_u32 v23, s7, v3
  s_add_u32 s7, s44, s3
  s_lshl_b32 s7, s7, 14
  s_lshl_b32 s45, s4, 9
  s_add_u32 s45, s45, 10485760
  s_add_u32 s39, s7, s45
  s_lshl_b32 s7, s43, 2
  s_add_u32 s7, s7, 128
  s_lshl_b32 s7, s7, 3
  s_add_u32 s7, s7, s3
  s_lshl_b32 s7, s7, 14
  s_add_u32 s40, s7, s45
  v_and_b32 v33, 31, v2
  s_mul_i32 s7, s43, 9216
  v_lshl_add_u32 v34, v32, 9, s7
  s_add_u32 s5, s43, 0
  s_and_b32 s5, s5, 3
  s_lshl_b32 s5, s5, 1
  v_add_u32 v36, s5, v32
  v_xor_b32 v36, v36, v33
  v_lshl_add_u32 v14, v36, 4, v34
  s_add_u32 s5, s43, 1
  s_and_b32 s5, s5, 3
  s_lshl_b32 s5, s5, 1
  v_add_u32 v36, s5, v32
  v_xor_b32 v36, v36, v33
  v_lshl_add_u32 v15, v36, 4, v34
  s_add_u32 s5, s43, 2
  s_and_b32 s5, s5, 3
  s_lshl_b32 s5, s5, 1
  v_add_u32 v36, s5, v32
  v_xor_b32 v36, v36, v33
  v_lshl_add_u32 v16, v36, 4, v34
  s_add_u32 s5, s43, 3
  s_and_b32 s5, s5, 3
  s_lshl_b32 s5, s5, 1
  v_add_u32 v36, s5, v32
  v_xor_b32 v36, v36, v33
  v_lshl_add_u32 v17, v36, 4, v34
  v_lshlrev_b32 v46, 2, v33
  v_add_u32 v46, 155648, v46
  v_lshrrev_b32 v32, 3, v2
  v_and_b32 v33, 7, v2
  s_lshr_b32 s5, s43, 1
  s_mul_i32 s5, s5, 36864
  s_and_b32 s6, s43, 1
  s_lshl_b32 s6, s6, 8
  s_add_u32 s5, s5, s6
  v_xor_b32 v34, v32, v33
  v_lshl_add_u32 v34, v34, 4, s5
  v_lshl_add_u32 v47, v33, 9, v34
  s_lshl_b32 s5, s43, 6
  s_add_u32 s5, s5, 155648
  v_lshl_add_u32 v48, v32, 2, s5
  s_lshl_b32 s5, s4, 9
  s_lshl_b32 s6, s43, 7
  s_add_u32 s5, s5, s6
  s_add_u32 s5, s5, 2359296
  v_lshl_add_u32 v49, v32, 3, s5
  v_lshlrev_b32 v40, 3, v52
  s_mul_i32 s5, s3, 294912
  s_add_u32 s5, s5, 0
  v_add_u32 v40, s5, v40
  s_lshl_b32 s5, s43, 15
  v_add_u32 v41, s5, v40
  v_mov_b32 v27, 0
  v_mov_b32 v28, 0
  v_mov_b32 v29, 0
  v_mov_b32 v31, 0
  v_accvgpr_write_b32 a240, 0
  v_accvgpr_write_b32 a241, 0
  v_accvgpr_write_b32 a243, 0
  v_accvgpr_write_b32 a245, 0
  v_accvgpr_write_b32 a247, 0
  v_accvgpr_write_b32 a249, 0
  v_accvgpr_write_b32 a251, 0
  v_accvgpr_write_b32 a253, 0
  v_accvgpr_write_b32 a254, 0
  v_accvgpr_write_b32 a255, 0
  s_mov_b32 s5, 0x3f803f80
  s_mov_b32 s6, 0x00003f80
  s_mov_b32 s7, 0x3f800000
  s_waitcnt vmcnt(23)
  v_dot2_f32_bf16 v32, v128, s5, 0
  v_dot2_f32_bf16 v34, v128, v128, 0
  v_dot2_f32_bf16 v33, v129, s5, 0
  v_dot2_f32_bf16 v35, v129, v129, 0
  v_dot2_f32_bf16 v32, v130, s5, v32
  v_dot2_f32_bf16 v34, v130, v130, v34
  v_dot2_f32_bf16 v33, v131, s5, v33
  v_dot2_f32_bf16 v35, v131, v131, v35
  s_add_u32 m0, s41, 6144
  s_add_u32 s42, s36, 442368
  buffer_load_dwordx4 v4, s[8:11], s42 offen lds
  buffer_load_dwordx4 v5, s[8:11], s42 offen offset:1024 lds
  s_waitcnt vmcnt(24)
  v_dot2_f32_bf16 v32, v132, s5, v32
  v_dot2_f32_bf16 v34, v132, v132, v34
  v_dot2_f32_bf16 v33, v133, s5, v33
  v_dot2_f32_bf16 v35, v133, v133, v35
  v_dot2_f32_bf16 v32, v134, s5, v32
  v_dot2_f32_bf16 v34, v134, v134, v34
  v_dot2_f32_bf16 v33, v135, s5, v33
  v_dot2_f32_bf16 v35, v135, v135, v35
  s_add_u32 m0, s41, 8192
  s_add_u32 s42, s36, 589824
  buffer_load_dwordx4 v4, s[8:11], s42 offen lds
  buffer_load_dwordx4 v5, s[8:11], s42 offen offset:1024 lds
  s_waitcnt vmcnt(25)
  v_dot2_f32_bf16 v32, v136, s5, v32
  v_dot2_f32_bf16 v34, v136, v136, v34
  v_dot2_f32_bf16 v33, v137, s5, v33
  v_dot2_f32_bf16 v35, v137, v137, v35
  v_dot2_f32_bf16 v32, v138, s5, v32
  v_dot2_f32_bf16 v34, v138, v138, v34
  v_dot2_f32_bf16 v33, v139, s5, v33
  v_dot2_f32_bf16 v35, v139, v139, v35
  s_add_u32 m0, s41, 10240
  s_add_u32 s42, s36, 737280
  buffer_load_dwordx4 v4, s[8:11], s42 offen lds
  buffer_load_dwordx4 v5, s[8:11], s42 offen offset:1024 lds
  s_waitcnt vmcnt(26)
  v_dot2_f32_bf16 v32, v140, s5, v32
  v_dot2_f32_bf16 v34, v140, v140, v34
  v_dot2_f32_bf16 v33, v141, s5, v33
  v_dot2_f32_bf16 v35, v141, v141, v35
  v_dot2_f32_bf16 v32, v142, s5, v32
  v_dot2_f32_bf16 v34, v142, v142, v34
  v_dot2_f32_bf16 v33, v143, s5, v33
  v_dot2_f32_bf16 v35, v143, v143, v35
  s_add_u32 m0, s41, 12288
  s_add_u32 s42, s36, 884736
  buffer_load_dwordx4 v4, s[8:11], s42 offen lds
  buffer_load_dwordx4 v5, s[8:11], s42 offen offset:1024 lds
  s_waitcnt vmcnt(27)
  v_dot2_f32_bf16 v32, v144, s5, v32
  v_dot2_f32_bf16 v34, v144, v144, v34
  v_dot2_f32_bf16 v33, v145, s5, v33
  v_dot2_f32_bf16 v35, v145, v145, v35
  v_dot2_f32_bf16 v32, v146, s5, v32
  v_dot2_f32_bf16 v34, v146, v146, v34
  v_dot2_f32_bf16 v33, v147, s5, v33
  v_dot2_f32_bf16 v35, v147, v147, v35
  s_add_u32 m0, s41, 14336
  s_add_u32 s42, s36, 1032192
  buffer_load_dwordx4 v4, s[8:11], s42 offen lds
  buffer_load_dwordx4 v5, s[8:11], s42 offen offset:1024 lds
  s_waitcnt vmcnt(28)
  v_dot2_f32_bf16 v32, v148, s5, v32
  v_dot2_f32_bf16 v34, v148, v148, v34
  v_dot2_f32_bf16 v33, v149, s5, v33
  v_dot2_f32_bf16 v35, v149, v149, v35
  v_dot2_f32_bf16 v32, v150, s5, v32
  v_dot2_f32_bf16 v34, v150, v150, v34
  v_dot2_f32_bf16 v33, v151, s5, v33
  v_dot2_f32_bf16 v35, v151, v151, v35
  s_add_u32 m0, s41, 16384
  s_add_u32 s42, s36, 1179648
  buffer_load_dwordx4 v4, s[8:11], s42 offen lds
  buffer_load_dwordx4 v5, s[8:11], s42 offen offset:1024 lds
  s_waitcnt vmcnt(29)
  v_dot2_f32_bf16 v32, v152, s5, v32
  v_dot2_f32_bf16 v34, v152, v152, v34
  v_dot2_f32_bf16 v33, v153, s5, v33
  v_dot2_f32_bf16 v35, v153, v153, v35
  v_dot2_f32_bf16 v32, v154, s5, v32
  v_dot2_f32_bf16 v34, v154, v154, v34
  v_dot2_f32_bf16 v33, v155, s5, v33
  v_dot2_f32_bf16 v35, v155, v155, v35
  s_add_u32 m0, s41, 18432
  s_add_u32 s42, s24, 0
  buffer_load_dwordx4 v4, s[8:11], s42 offen lds
  buffer_load_dwordx4 v5, s[8:11], s42 offen offset:1024 lds
  s_waitcnt vmcnt(30)
  v_dot2_f32_bf16 v32, v156, s5, v32
  v_dot2_f32_bf16 v34, v156, v156, v34
  v_dot2_f32_bf16 v33, v157, s5, v33
  v_dot2_f32_bf16 v35, v157, v157, v35
  v_dot2_f32_bf16 v32, v158, s5, v32
  v_dot2_f32_bf16 v34, v158, v158, v34
  v_dot2_f32_bf16 v33, v159, s5, v33
  v_dot2_f32_bf16 v35, v159, v159, v35
  buffer_load_dword v64, v69, s[8:11], 0 offen
  s_waitcnt vmcnt(30)
  v_dot2_f32_bf16 v32, v160, s5, v32
  v_dot2_f32_bf16 v34, v160, v160, v34
  v_dot2_f32_bf16 v33, v161, s5, v33
  v_dot2_f32_bf16 v35, v161, v161, v35
  v_dot2_f32_bf16 v32, v162, s5, v32
  v_dot2_f32_bf16 v34, v162, v162, v34
  v_dot2_f32_bf16 v33, v163, s5, v33
  v_dot2_f32_bf16 v35, v163, v163, v35
  buffer_load_dword v65, v70, s[8:11], 0 offen
  s_nop 2
  v_add_f32 v32, v32, v33
  v_add_f32 v34, v34, v35
  s_nop 0
  v_add_f32_dpp v32, v32, v32 quad_perm:[1,0,3,2] row_mask:0xf bank_mask:0xf
  v_add_f32_dpp v34, v34, v34 quad_perm:[1,0,3,2] row_mask:0xf bank_mask:0xf
  s_nop 0
  v_add_f32_dpp v32, v32, v32 quad_perm:[2,3,0,1] row_mask:0xf bank_mask:0xf
  v_add_f32_dpp v34, v34, v34 quad_perm:[2,3,0,1] row_mask:0xf bank_mask:0xf
  s_nop 0
  v_add_f32_dpp v32, v32, v32 row_half_mirror row_mask:0xf bank_mask:0xf
  v_add_f32_dpp v34, v34, v34 row_half_mirror row_mask:0xf bank_mask:0xf
  v_mul_f32 v32, 0x3ae38e39, v32
  v_mul_f32 v34, 0x3ae38e39, v34
  v_fma_f32 v34, -v32, v32, v34
  v_max_f32 v34, 0, v34
  v_cvt_pk_bf16_f32 v35, v32, v34
  v_lshlrev_b32 v32, 16, v35
  v_and_b32 v34, 0xffff0000, v35
  v_xor_b32 v50, 0x80000000, v32
  v_lshlrev_b32 v200, 16, v128
  v_and_b32 v201, 0xffff0000, v128
  v_lshlrev_b32 v202, 16, v129
  v_and_b32 v203, 0xffff0000, v129
  v_lshlrev_b32 v204, 16, v130
  v_and_b32 v205, 0xffff0000, v130
  v_lshlrev_b32 v206, 16, v131
  v_and_b32 v207, 0xffff0000, v131
  v_pk_add_f32 v[200:201], v[200:201], v[50:51] op_sel_hi:[1,0]
  v_pk_add_f32 v[202:203], v[202:203], v[50:51] op_sel_hi:[1,0]
  v_pk_add_f32 v[204:205], v[204:205], v[50:51] op_sel_hi:[1,0]
  v_pk_add_f32 v[206:207], v[206:207], v[50:51] op_sel_hi:[1,0]
  v_add_f32 v34, 0x3727c5ac, v34
  buffer_load_ushort v228, v53, s[20:23], 0 offen offset:0
  buffer_load_ushort v229, v53, s[20:23], 0 offen offset:64
  v_cvt_pk_bf16_f32 v128, v200, v201
  v_cvt_pk_bf16_f32 v129, v202, v203
  v_cvt_pk_bf16_f32 v130, v204, v205
  v_cvt_pk_bf16_f32 v131, v206, v207
  ds_write_b128 v47, v[128:131] offset:0
  v_lshlrev_b32 v208, 16, v132
  v_and_b32 v209, 0xffff0000, v132
  v_lshlrev_b32 v210, 16, v133
  v_and_b32 v211, 0xffff0000, v133
  v_lshlrev_b32 v212, 16, v134
  v_and_b32 v213, 0xffff0000, v134
  v_lshlrev_b32 v214, 16, v135
  v_and_b32 v215, 0xffff0000, v135
  v_pk_add_f32 v[208:209], v[208:209], v[50:51] op_sel_hi:[1,0]
  v_pk_add_f32 v[210:211], v[210:211], v[50:51] op_sel_hi:[1,0]
  v_pk_add_f32 v[212:213], v[212:213], v[50:51] op_sel_hi:[1,0]
  v_pk_add_f32 v[214:215], v[214:215], v[50:51] op_sel_hi:[1,0]
  v_cvt_pk_bf16_f32 v34, v34, v34
  buffer_load_ushort v230, v54, s[20:23], 0 offen offset:0
  buffer_load_ushort v231, v54, s[20:23], 0 offen offset:64
  v_cvt_pk_bf16_f32 v132, v208, v209
  v_cvt_pk_bf16_f32 v133, v210, v211
  v_cvt_pk_bf16_f32 v134, v212, v213
  v_cvt_pk_bf16_f32 v135, v214, v215
  ds_write_b128 v47, v[132:135] offset:4096
  v_lshlrev_b32 v200, 16, v136
  v_and_b32 v201, 0xffff0000, v136
  v_lshlrev_b32 v202, 16, v137
  v_and_b32 v203, 0xffff0000, v137
  v_lshlrev_b32 v204, 16, v138
  v_and_b32 v205, 0xffff0000, v138
  v_lshlrev_b32 v206, 16, v139
  v_and_b32 v207, 0xffff0000, v139
  v_pk_add_f32 v[200:201], v[200:201], v[50:51] op_sel_hi:[1,0]
  v_pk_add_f32 v[202:203], v[202:203], v[50:51] op_sel_hi:[1,0]
  v_pk_add_f32 v[204:205], v[204:205], v[50:51] op_sel_hi:[1,0]
  v_pk_add_f32 v[206:207], v[206:207], v[50:51] op_sel_hi:[1,0]
  v_lshlrev_b32 v34, 16, v34
  buffer_load_ushort v232, v55, s[20:23], 0 offen offset:0
  buffer_load_ushort v233, v55, s[20:23], 0 offen offset:64
  v_cvt_pk_bf16_f32 v136, v200, v201
  v_cvt_pk_bf16_f32 v137, v202, v203
  v_cvt_pk_bf16_f32 v138, v204, v205
  v_cvt_pk_bf16_f32 v139, v206, v207
  ds_write_b128 v47, v[136:139] offset:8192
  v_lshlrev_b32 v208, 16, v140
  v_and_b32 v209, 0xffff0000, v140
  v_lshlrev_b32 v210, 16, v141
  v_and_b32 v211, 0xffff0000, v141
  v_lshlrev_b32 v212, 16, v142
  v_and_b32 v213, 0xffff0000, v142
  v_lshlrev_b32 v214, 16, v143
  v_and_b32 v215, 0xffff0000, v143
  v_pk_add_f32 v[208:209], v[208:209], v[50:51] op_sel_hi:[1,0]
  v_pk_add_f32 v[210:211], v[210:211], v[50:51] op_sel_hi:[1,0]
  v_pk_add_f32 v[212:213], v[212:213], v[50:51] op_sel_hi:[1,0]
  v_pk_add_f32 v[214:215], v[214:215], v[50:51] op_sel_hi:[1,0]
  v_sqrt_f32 v33, v34
  v_cvt_pk_bf16_f32 v140, v208, v209
  v_cvt_pk_bf16_f32 v141, v210, v211
  v_cvt_pk_bf16_f32 v142, v212, v213
  v_cvt_pk_bf16_f32 v143, v214, v215
  ds_write_b128 v47, v[140:143] offset:12288
  v_lshlrev_b32 v200, 16, v144
  v_and_b32 v201, 0xffff0000, v144
  v_lshlrev_b32 v202, 16, v145
  v_and_b32 v203, 0xffff0000, v145
  v_lshlrev_b32 v204, 16, v146
  v_and_b32 v205, 0xffff0000, v146
  v_lshlrev_b32 v206, 16, v147
  v_and_b32 v207, 0xffff0000, v147
  v_pk_add_f32 v[200:201], v[200:201], v[50:51] op_sel_hi:[1,0]
  v_pk_add_f32 v[202:203], v[202:203], v[50:51] op_sel_hi:[1,0]
  v_pk_add_f32 v[204:205], v[204:205], v[50:51] op_sel_hi:[1,0]
  v_pk_add_f32 v[206:207], v[206:207], v[50:51] op_sel_hi:[1,0]
  v_rcp_f32 v35, v33
  v_cvt_pk_bf16_f32 v144, v200, v201
  v_cvt_pk_bf16_f32 v145, v202, v203
  v_cvt_pk_bf16_f32 v146, v204, v205
  v_cvt_pk_bf16_f32 v147, v206, v207
  ds_write_b128 v47, v[144:147] offset:16384
  v_lshlrev_b32 v208, 16, v148
  v_and_b32 v209, 0xffff0000, v148
  v_lshlrev_b32 v210, 16, v149
  v_and_b32 v211, 0xffff0000, v149
  v_lshlrev_b32 v212, 16, v150
  v_and_b32 v213, 0xffff0000, v150
  v_lshlrev_b32 v214, 16, v151
  v_and_b32 v215, 0xffff0000, v151
  v_pk_add_f32 v[208:209], v[208:209], v[50:51] op_sel_hi:[1,0]
  v_pk_add_f32 v[210:211], v[210:211], v[50:51] op_sel_hi:[1,0]
  v_pk_add_f32 v[212:213], v[212:213], v[50:51] op_sel_hi:[1,0]
  v_pk_add_f32 v[214:215], v[214:215], v[50:51] op_sel_hi:[1,0]
  v_fma_f32 v34, -v33, v33, v34
  v_cvt_pk_bf16_f32 v148, v208, v209
  v_cvt_pk_bf16_f32 v149, v210, v211
  v_cvt_pk_bf16_f32 v150, v212, v213
  v_cvt_pk_bf16_f32 v151, v214, v215
  ds_write_b128 v47, v[148:151] offset:20480
  v_lshlrev_b32 v200, 16, v152
  v_and_b32 v201, 0xffff0000, v152
  v_lshlrev_b32 v202, 16, v153
  v_and_b32 v203, 0xffff0000, v153
  v_lshlrev_b32 v204, 16, v154
  v_and_b32 v205, 0xffff0000, v154
  v_lshlrev_b32 v206, 16, v155
  v_and_b32 v207, 0xffff0000, v155
  v_pk_add_f32 v[200:201], v[200:201], v[50:51] op_sel_hi:[1,0]
  v_pk_add_f32 v[202:203], v[202:203], v[50:51] op_sel_hi:[1,0]
  v_pk_add_f32 v[204:205], v[204:205], v[50:51] op_sel_hi:[1,0]
  v_pk_add_f32 v[206:207], v[206:207], v[50:51] op_sel_hi:[1,0]
  v_mul_f32 v35, 0.5, v35
  v_cvt_pk_bf16_f32 v152, v200, v201
  v_cvt_pk_bf16_f32 v153, v202, v203
  v_cvt_pk_bf16_f32 v154, v204, v205
  v_cvt_pk_bf16_f32 v155, v206, v207
  ds_write_b128 v47, v[152:155] offset:24576
  v_lshlrev_b32 v208, 16, v156
  v_and_b32 v209, 0xffff0000, v156
  v_lshlrev_b32 v210, 16, v157
  v_and_b32 v211, 0xffff0000, v157
  v_lshlrev_b32 v212, 16, v158
  v_and_b32 v213, 0xffff0000, v158
  v_lshlrev_b32 v214, 16, v159
  v_and_b32 v215, 0xffff0000, v159
  v_pk_add_f32 v[208:209], v[208:209], v[50:51] op_sel_hi:[1,0]
  v_pk_add_f32 v[210:211], v[210:211], v[50:51] op_sel_hi:[1,0]
  v_pk_add_f32 v[212:213], v[212:213], v[50:51] op_sel_hi:[1,0]
  v_pk_add_f32 v[214:215], v[214:215], v[50:51] op_sel_hi:[1,0]
  v_fmac_f32 v33, v34, v35
  v_cvt_pk_bf16_f32 v156, v208, v209
  v_cvt_pk_bf16_f32 v157, v210, v211
  v_cvt_pk_bf16_f32 v158, v212, v213
  v_cvt_pk_bf16_f32 v159, v214, v215
  ds_write_b128 v47, v[156:159] offset:28672
  v_lshlrev_b32 v200, 16, v160
  v_and_b32 v201, 0xffff0000, v160
  v_lshlrev_b32 v202, 16, v161
  v_and_b32 v203, 0xffff0000, v161
  v_lshlrev_b32 v204, 16, v162
  v_and_b32 v205, 0xffff0000, v162
  v_lshlrev_b32 v206, 16, v163
  v_and_b32 v207, 0xffff0000, v163
  v_pk_add_f32 v[200:201], v[200:201], v[50:51] op_sel_hi:[1,0]
  v_pk_add_f32 v[202:203], v[202:203], v[50:51] op_sel_hi:[1,0]
  v_pk_add_f32 v[204:205], v[204:205], v[50:51] op_sel_hi:[1,0]
  v_pk_add_f32 v[206:207], v[206:207], v[50:51] op_sel_hi:[1,0]
  v_cvt_pk_bf16_f32 v33, v33, v33
  v_lshlrev_b32 v33, 16, v33
  v_cvt_pk_bf16_f32 v160, v200, v201
  v_cvt_pk_bf16_f32 v161, v202, v203
  v_cvt_pk_bf16_f32 v162, v204, v205
  v_cvt_pk_bf16_f32 v163, v206, v207
  ds_write_b128 v47, v[160:163] offset:32768
  ds_write_b32 v48, v33 offset:0
  s_waitcnt vmcnt(36)
  v_dot2_f32_bf16 v36, v164, s5, 0
  v_dot2_f32_bf16 v38, v164, v164, 0
  v_dot2_f32_bf16 v37, v165, s5, 0
  v_dot2_f32_bf16 v39, v165, v165, 0
  v_dot2_f32_bf16 v36, v166, s5, v36
  v_dot2_f32_bf16 v38, v166, v166, v38
  v_dot2_f32_bf16 v37, v167, s5, v37
  v_dot2_f32_bf16 v39, v167, v167, v39
  s_waitcnt vmcnt(35)
  v_dot2_f32_bf16 v36, v168, s5, v36
  v_dot2_f32_bf16 v38, v168, v168, v38
  v_dot2_f32_bf16 v37, v169, s5, v37
  v_dot2_f32_bf16 v39, v169, v169, v39
  v_dot2_f32_bf16 v36, v170, s5, v36
  v_dot2_f32_bf16 v38, v170, v170, v38
  v_dot2_f32_bf16 v37, v171, s5, v37
  v_dot2_f32_bf16 v39, v171, v171, v39
  s_waitcnt vmcnt(34)
  v_dot2_f32_bf16 v36, v172, s5, v36
  v_dot2_f32_bf16 v38, v172, v172, v38
  v_dot2_f32_bf16 v37, v173, s5, v37
  v_dot2_f32_bf16 v39, v173, v173, v39
  v_dot2_f32_bf16 v36, v174, s5, v36
  v_dot2_f32_bf16 v38, v174, v174, v38
  v_dot2_f32_bf16 v37, v175, s5, v37
  v_dot2_f32_bf16 v39, v175, v175, v39
  s_waitcnt vmcnt(33)
  v_dot2_f32_bf16 v36, v176, s5, v36
  v_dot2_f32_bf16 v38, v176, v176, v38
  v_dot2_f32_bf16 v37, v177, s5, v37
  v_dot2_f32_bf16 v39, v177, v177, v39
  v_dot2_f32_bf16 v36, v178, s5, v36
  v_dot2_f32_bf16 v38, v178, v178, v38
  v_dot2_f32_bf16 v37, v179, s5, v37
  v_dot2_f32_bf16 v39, v179, v179, v39
  s_waitcnt vmcnt(32)
  v_dot2_f32_bf16 v36, v180, s5, v36
  v_dot2_f32_bf16 v38, v180, v180, v38
  v_dot2_f32_bf16 v37, v181, s5, v37
  v_dot2_f32_bf16 v39, v181, v181, v39
  v_dot2_f32_bf16 v36, v182, s5, v36
  v_dot2_f32_bf16 v38, v182, v182, v38
  v_dot2_f32_bf16 v37, v183, s5, v37
  v_dot2_f32_bf16 v39, v183, v183, v39
  s_waitcnt vmcnt(31)
  v_dot2_f32_bf16 v36, v184, s5, v36
  v_dot2_f32_bf16 v38, v184, v184, v38
  v_dot2_f32_bf16 v37, v185, s5, v37
  v_dot2_f32_bf16 v39, v185, v185, v39
  v_dot2_f32_bf16 v36, v186, s5, v36
  v_dot2_f32_bf16 v38, v186, v186, v38
  v_dot2_f32_bf16 v37, v187, s5, v37
  v_dot2_f32_bf16 v39, v187, v187, v39
  s_waitcnt vmcnt(30)
  v_dot2_f32_bf16 v36, v188, s5, v36
  v_dot2_f32_bf16 v38, v188, v188, v38
  v_dot2_f32_bf16 v37, v189, s5, v37
  v_dot2_f32_bf16 v39, v189, v189, v39
  v_dot2_f32_bf16 v36, v190, s5, v36
  v_dot2_f32_bf16 v38, v190, v190, v38
  v_dot2_f32_bf16 v37, v191, s5, v37
  v_dot2_f32_bf16 v39, v191, v191, v39
  s_waitcnt vmcnt(29)
  v_dot2_f32_bf16 v36, v192, s5, v36
  v_dot2_f32_bf16 v38, v192, v192, v38
  v_dot2_f32_bf16 v37, v193, s5, v37
  v_dot2_f32_bf16 v39, v193, v193, v39
  v_dot2_f32_bf16 v36, v194, s5, v36
  v_dot2_f32_bf16 v38, v194, v194, v38
  v_dot2_f32_bf16 v37, v195, s5, v37
  v_dot2_f32_bf16 v39, v195, v195, v39
  s_waitcnt vmcnt(28)
  v_dot2_f32_bf16 v36, v196, s5, v36
  v_dot2_f32_bf16 v38, v196, v196, v38
  v_dot2_f32_bf16 v37, v197, s5, v37
  v_dot2_f32_bf16 v39, v197, v197, v39
  v_dot2_f32_bf16 v36, v198, s5, v36
  v_dot2_f32_bf16 v38, v198, v198, v38
  v_dot2_f32_bf16 v37, v199, s5, v37
  v_dot2_f32_bf16 v39, v199, v199, v39
  s_nop 2
  v_add_f32 v36, v36, v37
  v_add_f32 v38, v38, v39
  s_nop 0
  v_add_f32_dpp v36, v36, v36 quad_perm:[1,0,3,2] row_mask:0xf bank_mask:0xf
  v_add_f32_dpp v38, v38, v38 quad_perm:[1,0,3,2] row_mask:0xf bank_mask:0xf
  s_nop 0
  v_add_f32_dpp v36, v36, v36 quad_perm:[2,3,0,1] row_mask:0xf bank_mask:0xf
  v_add_f32_dpp v38, v38, v38 quad_perm:[2,3,0,1] row_mask:0xf bank_mask:0xf
  s_nop 0
  v_add_f32_dpp v36, v36, v36 row_half_mirror row_mask:0xf bank_mask:0xf
  v_add_f32_dpp v38, v38, v38 row_half_mirror row_mask:0xf bank_mask:0xf
  v_mul_f32 v36, 0x3ae38e39, v36
  v_mul_f32 v38, 0x3ae38e39, v38
  v_fma_f32 v38, -v36, v36, v38
  v_max_f32 v38, 0, v38
  v_cvt_pk_bf16_f32 v39, v36, v38
  v_lshlrev_b32 v36, 16, v39
  v_and_b32 v38, 0xffff0000, v39
  v_xor_b32 v50, 0x80000000, v36
  v_lshlrev_b32 v200, 16, v164
  v_and_b32 v201, 0xffff0000, v164
  v_lshlrev_b32 v202, 16, v165
  v_and_b32 v203, 0xffff0000, v165
  v_lshlrev_b32 v204, 16, v166
  v_and_b32 v205, 0xffff0000, v166
  v_lshlrev_b32 v206, 16, v167
  v_and_b32 v207, 0xffff0000, v167
  v_pk_add_f32 v[200:201], v[200:201], v[50:51] op_sel_hi:[1,0]
  v_pk_add_f32 v[202:203], v[202:203], v[50:51] op_sel_hi:[1,0]
  v_pk_add_f32 v[204:205], v[204:205], v[50:51] op_sel_hi:[1,0]
  v_pk_add_f32 v[206:207], v[206:207], v[50:51] op_sel_hi:[1,0]
  v_add_f32 v38, 0x3727c5ac, v38
  v_cvt_pk_bf16_f32 v164, v200, v201
  v_cvt_pk_bf16_f32 v165, v202, v203
  v_cvt_pk_bf16_f32 v166, v204, v205
  v_cvt_pk_bf16_f32 v167, v206, v207
  ds_write_b128 v47, v[164:167] offset:128
  v_lshlrev_b32 v208, 16, v168
  v_and_b32 v209, 0xffff0000, v168
  v_lshlrev_b32 v210, 16, v169
  v_and_b32 v211, 0xffff0000, v169
  v_lshlrev_b32 v212, 16, v170
  v_and_b32 v213, 0xffff0000, v170
  v_lshlrev_b32 v214, 16, v171
  v_and_b32 v215, 0xffff0000, v171
  v_pk_add_f32 v[208:209], v[208:209], v[50:51] op_sel_hi:[1,0]
  v_pk_add_f32 v[210:211], v[210:211], v[50:51] op_sel_hi:[1,0]
  v_pk_add_f32 v[212:213], v[212:213], v[50:51] op_sel_hi:[1,0]
  v_pk_add_f32 v[214:215], v[214:215], v[50:51] op_sel_hi:[1,0]
  v_cvt_pk_bf16_f32 v38, v38, v38
  v_cvt_pk_bf16_f32 v168, v208, v209
  v_cvt_pk_bf16_f32 v169, v210, v211
  v_cvt_pk_bf16_f32 v170, v212, v213
  v_cvt_pk_bf16_f32 v171, v214, v215
  ds_write_b128 v47, v[168:171] offset:4224
  v_lshlrev_b32 v200, 16, v172
  v_and_b32 v201, 0xffff0000, v172
  v_lshlrev_b32 v202, 16, v173
  v_and_b32 v203, 0xffff0000, v173
  v_lshlrev_b32 v204, 16, v174
  v_and_b32 v205, 0xffff0000, v174
  v_lshlrev_b32 v206, 16, v175
  v_and_b32 v207, 0xffff0000, v175
  v_pk_add_f32 v[200:201], v[200:201], v[50:51] op_sel_hi:[1,0]
  v_pk_add_f32 v[202:203], v[202:203], v[50:51] op_sel_hi:[1,0]
  v_pk_add_f32 v[204:205], v[204:205], v[50:51] op_sel_hi:[1,0]
  v_pk_add_f32 v[206:207], v[206:207], v[50:51] op_sel_hi:[1,0]
  v_lshlrev_b32 v38, 16, v38
  global_load_dwordx4 v[216:219], v57, s[100:101]
  v_cvt_pk_bf16_f32 v172, v200, v201
  v_cvt_pk_bf16_f32 v173, v202, v203
  v_cvt_pk_bf16_f32 v174, v204, v205
  v_cvt_pk_bf16_f32 v175, v206, v207
  ds_write_b128 v47, v[172:175] offset:8320
  v_lshlrev_b32 v208, 16, v176
  v_and_b32 v209, 0xffff0000, v176
  v_lshlrev_b32 v210, 16, v177
  v_and_b32 v211, 0xffff0000, v177
  v_lshlrev_b32 v212, 16, v178
  v_and_b32 v213, 0xffff0000, v178
  v_lshlrev_b32 v214, 16, v179
  v_and_b32 v215, 0xffff0000, v179
  v_pk_add_f32 v[208:209], v[208:209], v[50:51] op_sel_hi:[1,0]
  v_pk_add_f32 v[210:211], v[210:211], v[50:51] op_sel_hi:[1,0]
  v_pk_add_f32 v[212:213], v[212:213], v[50:51] op_sel_hi:[1,0]
  v_pk_add_f32 v[214:215], v[214:215], v[50:51] op_sel_hi:[1,0]
  v_sqrt_f32 v37, v38
  v_cvt_pk_bf16_f32 v176, v208, v209
  v_cvt_pk_bf16_f32 v177, v210, v211
  v_cvt_pk_bf16_f32 v178, v212, v213
  v_cvt_pk_bf16_f32 v179, v214, v215
  ds_write_b128 v47, v[176:179] offset:12416
  v_lshlrev_b32 v200, 16, v180
  v_and_b32 v201, 0xffff0000, v180
  v_lshlrev_b32 v202, 16, v181
  v_and_b32 v203, 0xffff0000, v181
  v_lshlrev_b32 v204, 16, v182
  v_and_b32 v205, 0xffff0000, v182
  v_lshlrev_b32 v206, 16, v183
  v_and_b32 v207, 0xffff0000, v183
  v_pk_add_f32 v[200:201], v[200:201], v[50:51] op_sel_hi:[1,0]
  v_pk_add_f32 v[202:203], v[202:203], v[50:51] op_sel_hi:[1,0]
  v_pk_add_f32 v[204:205], v[204:205], v[50:51] op_sel_hi:[1,0]
  v_pk_add_f32 v[206:207], v[206:207], v[50:51] op_sel_hi:[1,0]
  v_rcp_f32 v39, v37
  v_cvt_pk_bf16_f32 v180, v200, v201
  v_cvt_pk_bf16_f32 v181, v202, v203
  v_cvt_pk_bf16_f32 v182, v204, v205
  v_cvt_pk_bf16_f32 v183, v206, v207
  ds_write_b128 v47, v[180:183] offset:16512
  v_lshlrev_b32 v208, 16, v184
  v_and_b32 v209, 0xffff0000, v184
  v_lshlrev_b32 v210, 16, v185
  v_and_b32 v211, 0xffff0000, v185
  v_lshlrev_b32 v212, 16, v186
  v_and_b32 v213, 0xffff0000, v186
  v_lshlrev_b32 v214, 16, v187
  v_and_b32 v215, 0xffff0000, v187
  v_pk_add_f32 v[208:209], v[208:209], v[50:51] op_sel_hi:[1,0]
  v_pk_add_f32 v[210:211], v[210:211], v[50:51] op_sel_hi:[1,0]
  v_pk_add_f32 v[212:213], v[212:213], v[50:51] op_sel_hi:[1,0]
  v_pk_add_f32 v[214:215], v[214:215], v[50:51] op_sel_hi:[1,0]
  v_fma_f32 v38, -v37, v37, v38
  global_load_dwordx4 v[220:223], v57, s[100:101] offset:64
  v_cvt_pk_bf16_f32 v184, v208, v209
  v_cvt_pk_bf16_f32 v185, v210, v211
  v_cvt_pk_bf16_f32 v186, v212, v213
  v_cvt_pk_bf16_f32 v187, v214, v215
  ds_write_b128 v47, v[184:187] offset:20608
  v_lshlrev_b32 v200, 16, v188
  v_and_b32 v201, 0xffff0000, v188
  v_lshlrev_b32 v202, 16, v189
  v_and_b32 v203, 0xffff0000, v189
  v_lshlrev_b32 v204, 16, v190
  v_and_b32 v205, 0xffff0000, v190
  v_lshlrev_b32 v206, 16, v191
  v_and_b32 v207, 0xffff0000, v191
  v_pk_add_f32 v[200:201], v[200:201], v[50:51] op_sel_hi:[1,0]
  v_pk_add_f32 v[202:203], v[202:203], v[50:51] op_sel_hi:[1,0]
  v_pk_add_f32 v[204:205], v[204:205], v[50:51] op_sel_hi:[1,0]
  v_pk_add_f32 v[206:207], v[206:207], v[50:51] op_sel_hi:[1,0]
  v_mul_f32 v39, 0.5, v39
  v_cvt_pk_bf16_f32 v188, v200, v201
  v_cvt_pk_bf16_f32 v189, v202, v203
  v_cvt_pk_bf16_f32 v190, v204, v205
  v_cvt_pk_bf16_f32 v191, v206, v207
  ds_write_b128 v47, v[188:191] offset:24704
  v_lshlrev_b32 v208, 16, v192
  v_and_b32 v209, 0xffff0000, v192
  v_lshlrev_b32 v210, 16, v193
  v_and_b32 v211, 0xffff0000, v193
  v_lshlrev_b32 v212, 16, v194
  v_and_b32 v213, 0xffff0000, v194
  v_lshlrev_b32 v214, 16, v195
  v_and_b32 v215, 0xffff0000, v195
  v_pk_add_f32 v[208:209], v[208:209], v[50:51] op_sel_hi:[1,0]
  v_pk_add_f32 v[210:211], v[210:211], v[50:51] op_sel_hi:[1,0]
  v_pk_add_f32 v[212:213], v[212:213], v[50:51] op_sel_hi:[1,0]
  v_pk_add_f32 v[214:215], v[214:215], v[50:51] op_sel_hi:[1,0]
  v_fmac_f32 v37, v38, v39
  v_cvt_pk_bf16_f32 v192, v208, v209
  v_cvt_pk_bf16_f32 v193, v210, v211
  v_cvt_pk_bf16_f32 v194, v212, v213
  v_cvt_pk_bf16_f32 v195, v214, v215
  ds_write_b128 v47, v[192:195] offset:28800
  v_lshlrev_b32 v200, 16, v196
  v_and_b32 v201, 0xffff0000, v196
  v_lshlrev_b32 v202, 16, v197
  v_and_b32 v203, 0xffff0000, v197
  v_lshlrev_b32 v204, 16, v198
  v_and_b32 v205, 0xffff0000, v198
  v_lshlrev_b32 v206, 16, v199
  v_and_b32 v207, 0xffff0000, v199
  v_pk_add_f32 v[200:201], v[200:201], v[50:51] op_sel_hi:[1,0]
  v_pk_add_f32 v[202:203], v[202:203], v[50:51] op_sel_hi:[1,0]
  v_pk_add_f32 v[204:205], v[204:205], v[50:51] op_sel_hi:[1,0]
  v_pk_add_f32 v[206:207], v[206:207], v[50:51] op_sel_hi:[1,0]
  v_cvt_pk_bf16_f32 v37, v37, v37
  v_lshlrev_b32 v37, 16, v37
  global_load_dwordx4 v[224:227], v56, s[100:101] offset:128
  v_cvt_pk_bf16_f32 v196, v200, v201
  v_cvt_pk_bf16_f32 v197, v202, v203
  v_cvt_pk_bf16_f32 v198, v204, v205
  v_cvt_pk_bf16_f32 v199, v206, v207
  ds_write_b128 v47, v[196:199] offset:32896
  ds_write_b32 v48, v37 offset:32
  s_waitcnt vmcnt(3)
  v_lshlrev_b32 v228, 16, v228
  v_lshlrev_b32 v229, 16, v229
  v_lshlrev_b32 v230, 16, v230
  v_lshlrev_b32 v231, 16, v231
  v_lshlrev_b32 v232, 16, v232
  v_lshlrev_b32 v233, 16, v233
  v_accvgpr_write_b32 a242, v228
  v_accvgpr_write_b32 a244, v229
  v_accvgpr_write_b32 a246, v230
  v_accvgpr_write_b32 a248, v231
  v_accvgpr_write_b32 a250, v232
  v_accvgpr_write_b32 a252, v233
  global_load_dword v75, v74, s[94:95]
  s_waitcnt lgkmcnt(0)
  s_barrier
  ds_read_b32 v26, v46 offset:0
  ds_read_b32 v30, v46 offset:128
  ds_read_b64_tr_b16 a[224:225], v10 offset:0
  ds_read_b64_tr_b16 a[226:227], v10 offset:512
  ds_read_b64_tr_b16 a[228:229], v11 offset:0
  ds_read_b64_tr_b16 a[230:231], v11 offset:512
  ds_read_b128 a[0:3], v14 offset:0
  ds_read_b128 a[4:7], v14 offset:36864
  ds_read_b128 a[8:11], v15 offset:1024
  ds_read_b128 a[12:15], v15 offset:37888
  ds_read_b128 a[16:19], v16 offset:2048
  ds_read_b128 a[20:23], v16 offset:38912
  s_waitcnt lgkmcnt(10)
  v_rcp_f32 v0, v26
  v_rcp_f32 v1, v30
  s_lshl_b32 s5, s43, 1
  s_sub_u32 s5, s5, s3
  v_mul_f32 v2, v0, v0
  v_mul_f32 v24, v1, v1
  v_mul_f32 v2, v2, v0
  v_mul_f32 v24, v24, v1
  v_mul_f32 v2, 0xbdd2d3e8, v2
  v_mul_f32 v24, 0xbdd2d3e8, v24
  v_mul_f32 v0, 0xc0135761, v0
  v_mul_f32 v1, 0xc0135761, v1
  v_mfma_f32_32x32x16_bf16 v[128:143], a[242:245], v[26:29], 0
  ds_read_b128 a[24:27], v17 offset:3072
  ds_read_b128 a[28:31], v17 offset:39936
  ds_read_b128 a[32:35], v14 offset:4096
  ds_read_b128 a[36:39], v14 offset:40960
  ds_read_b128 a[40:43], v15 offset:5120
  ds_read_b128 a[44:47], v15 offset:41984
  v_mfma_f32_32x32x16_bf16 v[144:159], a[240:243], v[28:31], 0
  ds_read_b128 a[48:51], v16 offset:6144
  ds_read_b128 a[52:55], v16 offset:43008
  ds_read_b128 a[56:59], v17 offset:7168
  ds_read_b128 a[60:63], v17 offset:44032
  ds_read_b128 a[64:67], v14 offset:8192
  ds_read_b128 a[68:71], v14 offset:45056
  v_mfma_f32_32x32x16_bf16 v[160:175], a[244:247], v[26:29], 0
  v_mfma_f32_32x32x16_bf16 v[176:191], a[242:245], v[28:31], 0
  s_waitcnt lgkmcnt(15)
  v_mfma_f32_32x32x16_bf16 v[128:143], a[224:227], a[0:3], v[128:143]
  ds_read_b64_tr_b16 a[232:233], v10 offset:2048
  ds_read_b64_tr_b16 a[234:235], v10 offset:2560
  v_mfma_f32_32x32x16_bf16 v[144:159], a[224:227], a[4:7], v[144:159]
  ds_read_b64_tr_b16 a[236:237], v11 offset:2048
  ds_read_b64_tr_b16 a[238:239], v11 offset:2560
  v_mfma_f32_32x32x16_bf16 v[160:175], a[228:231], a[0:3], v[160:175]
  s_add_u32 m0, s41, 0
  s_add_u32 s42, s24, 147456
  buffer_load_dwordx4 v4, s[8:11], s42 offen lds
  buffer_load_dwordx4 v5, s[8:11], s42 offen offset:1024 lds
  v_mfma_f32_32x32x16_bf16 v[176:191], a[228:231], a[4:7], v[176:191]
  s_waitcnt lgkmcnt(2)
  v_mfma_f32_32x32x16_bf16 v[128:143], a[232:235], a[8:11], v[128:143]
  ds_read_b64_tr_b16 a[224:225], v10 offset:4096
  ds_read_b64_tr_b16 a[226:227], v10 offset:4608
  v_mfma_f32_32x32x16_bf16 v[144:159], a[232:235], a[12:15], v[144:159]
  ds_read_b64_tr_b16 a[228:229], v11 offset:4096
  ds_read_b64_tr_b16 a[230:231], v11 offset:4608
  s_waitcnt lgkmcnt(4)
  v_mfma_f32_32x32x16_bf16 v[160:175], a[236:239], a[8:11], v[160:175]
  s_add_u32 m0, s41, 2048
  s_add_u32 s42, s24, 294912
  buffer_load_dwordx4 v4, s[8:11], s42 offen lds
  buffer_load_dwordx4 v5, s[8:11], s42 offen offset:1024 lds
  v_mfma_f32_32x32x16_bf16 v[176:191], a[236:239], a[12:15], v[176:191]
  s_waitcnt lgkmcnt(2)
  v_mfma_f32_32x32x16_bf16 v[128:143], a[224:227], a[16:19], v[128:143]
  ds_read_b64_tr_b16 a[232:233], v10 offset:6144
  ds_read_b64_tr_b16 a[234:235], v10 offset:6656
  s_add_u32 s6, s5, 0
  s_cmp_eq_u32 s6, 0
  s_cselect_b32 s6, 0, 268435456
  v_add_u32 v50, s6, v49
  buffer_store_dwordx2 v[32:33], v50, s[16:19], 0 offen
  v_mfma_f32_32x32x16_bf16 v[144:159], a[224:227], a[20:23], v[144:159]
  ds_read_b64_tr_b16 a[236:237], v11 offset:6144
  ds_read_b64_tr_b16 a[238:239], v11 offset:6656
  s_waitcnt vmcnt(6)
  s_mov_b32 s6, 0
  buffer_store_dwordx2 v[216:217], v41, s[16:19], s6 offen
  s_waitcnt lgkmcnt(4)
  v_mfma_f32_32x32x16_bf16 v[160:175], a[228:231], a[16:19], v[160:175]
  s_add_u32 m0, s41, 4096
  s_add_u32 s42, s24, 442368
  buffer_load_dwordx4 v4, s[8:11], s42 offen lds
  buffer_load_dwordx4 v5, s[8:11], s42 offen offset:1024 lds
  s_mov_b32 s6, 16384
  buffer_store_dwordx2 v[218:219], v41, s[16:19], s6 offen
  v_mfma_f32_32x32x16_bf16 v[176:191], a[228:231], a[20:23], v[176:191]
  s_add_u32 s6, s5, 1
  s_cmp_eq_u32 s6, 0
  s_cselect_b32 s6, 64, 268435456
  v_add_u32 v51, s6, v49
  buffer_store_dwordx2 v[36:37], v51, s[16:19], 0 offen
  s_waitcnt lgkmcnt(2)
  v_mfma_f32_32x32x16_bf16 v[128:143], a[232:235], a[24:27], v[128:143]
  ds_read_b64_tr_b16 a[224:225], v10 offset:8192
  ds_read_b64_tr_b16 a[226:227], v10 offset:8704
  s_mov_b32 s6, 131072
  buffer_store_dwordx2 v[220:221], v41, s[16:19], s6 offen
  s_mov_b32 s6, 147456
  buffer_store_dwordx2 v[222:223], v41, s[16:19], s6 offen
  v_add_u32 v14, s97, v14
  v_mfma_f32_32x32x16_bf16 v[144:159], a[232:235], a[28:31], v[144:159]
  ds_read_b64_tr_b16 a[228:229], v11 offset:8192
  ds_read_b64_tr_b16 a[230:231], v11 offset:8704
  s_mov_b32 s6, 262144
  buffer_store_dwordx2 v[224:225], v40, s[16:19], s6 offen
  s_mov_b32 s6, 278528
  buffer_store_dwordx2 v[226:227], v40, s[16:19], s6 offen
  s_waitcnt lgkmcnt(4)
  v_mfma_f32_32x32x16_bf16 v[160:175], a[236:239], a[24:27], v[160:175]
  s_add_u32 m0, s41, 6144
  s_add_u32 s42, s24, 589824
  buffer_load_dwordx4 v4, s[8:11], s42 offen lds
  buffer_load_dwordx4 v5, s[8:11], s42 offen offset:1024 lds
  v_add_u32 v15, s97, v15
  v_add_u32 v16, s97, v16
  v_add_u32 v17, s97, v17
  v_mfma_f32_32x32x16_bf16 v[176:191], a[236:239], a[28:31], v[176:191]
  ds_read_b128 a[72:75], v15 offset:0
  ds_read_b128 a[76:79], v15 offset:36864
  ds_read_b128 a[80:83], v16 offset:1024
  ds_read_b128 a[84:87], v16 offset:37888
  s_waitcnt lgkmcnt(6)
  v_mfma_f32_32x32x16_bf16 v[128:143], a[224:227], a[32:35], v[128:143]
  ds_read_b64_tr_b16 a[232:233], v10 offset:10240
  ds_read_b64_tr_b16 a[234:235], v10 offset:10752
  ds_read_b128 a[88:91], v17 offset:2048
  ds_read_b128 a[92:95], v17 offset:38912
  ds_read_b128 a[96:99], v14 offset:3072
  ds_read_b128 a[100:103], v14 offset:39936
  v_mfma_f32_32x32x16_bf16 v[144:159], a[224:227], a[36:39], v[144:159]
  ds_read_b64_tr_b16 a[236:237], v11 offset:10240
  ds_read_b64_tr_b16 a[238:239], v11 offset:10752
  s_waitcnt lgkmcnt(12)
  v_mfma_f32_32x32x16_bf16 v[160:175], a[228:231], a[32:35], v[160:175]
  s_add_u32 m0, s41, 8192
  s_add_u32 s42, s24, 737280
  buffer_load_dwordx4 v4, s[8:11], s42 offen lds
  buffer_load_dwordx4 v5, s[8:11], s42 offen offset:1024 lds
  v_mfma_f32_32x32x16_bf16 v[176:191], a[228:231], a[36:39], v[176:191]
  s_waitcnt lgkmcnt(6)
  v_mfma_f32_32x32x16_bf16 v[128:143], a[232:235], a[40:43], v[128:143]
  ds_read_b64_tr_b16 a[224:225], v10 offset:12288
  ds_read_b64_tr_b16 a[226:227], v10 offset:12800
  ds_read_b128 a[104:107], v15 offset:4096
  ds_read_b128 a[108:111], v15 offset:40960
  v_mfma_f32_32x32x16_bf16 v[144:159], a[232:235], a[44:47], v[144:159]
  ds_read_b64_tr_b16 a[228:229], v11 offset:12288
  ds_read_b64_tr_b16 a[230:231], v11 offset:12800
  s_waitcnt lgkmcnt(6)
  v_mfma_f32_32x32x16_bf16 v[160:175], a[236:239], a[40:43], v[160:175]
  s_add_u32 m0, s41, 10240
  s_add_u32 s42, s24, 884736
  buffer_load_dwordx4 v4, s[8:11], s42 offen lds
  buffer_load_dwordx4 v5, s[8:11], s42 offen offset:1024 lds
  v_mfma_f32_32x32x16_bf16 v[176:191], a[236:239], a[44:47], v[176:191]
  s_waitcnt lgkmcnt(4)
  v_mfma_f32_32x32x16_bf16 v[128:143], a[224:227], a[48:51], v[128:143]
  ds_read_b64_tr_b16 a[232:233], v10 offset:14336
  ds_read_b64_tr_b16 a[234:235], v10 offset:14848
  ds_read_b128 a[112:115], v16 offset:5120
  ds_read_b128 a[116:119], v16 offset:41984
  ds_read_b128 a[120:123], v17 offset:6144
  ds_read_b128 a[124:127], v17 offset:43008
  v_mfma_f32_32x32x16_bf16 v[144:159], a[224:227], a[52:55], v[144:159]
  ds_read_b64_tr_b16 a[236:237], v11 offset:14336
  ds_read_b64_tr_b16 a[238:239], v11 offset:14848
  s_waitcnt lgkmcnt(8)
  v_mfma_f32_32x32x16_bf16 v[160:175], a[228:231], a[48:51], v[160:175]
  s_add_u32 m0, s41, 12288
  s_add_u32 s42, s24, 1032192
  buffer_load_dwordx4 v4, s[8:11], s42 offen lds
  buffer_load_dwordx4 v5, s[8:11], s42 offen offset:1024 lds
  v_mfma_f32_32x32x16_bf16 v[176:191], a[228:231], a[52:55], v[176:191]
  s_waitcnt lgkmcnt(6)
  v_mfma_f32_32x32x16_bf16 v[128:143], a[232:235], a[56:59], v[128:143]
  ds_read_b64_tr_b16 a[224:225], v10 offset:16384
  ds_read_b64_tr_b16 a[226:227], v10 offset:16896
  ds_read_b128 a[128:131], v14 offset:7168
  ds_read_b128 a[132:135], v14 offset:44032
  v_mfma_f32_32x32x16_bf16 v[144:159], a[232:235], a[60:63], v[144:159]
  ds_read_b64_tr_b16 a[228:229], v11 offset:16384
  ds_read_b64_tr_b16 a[230:231], v11 offset:16896
  s_waitcnt lgkmcnt(6)
  v_mfma_f32_32x32x16_bf16 v[160:175], a[236:239], a[56:59], v[160:175]
  s_add_u32 m0, s41, 14336
  s_add_u32 s42, s24, 1179648
  buffer_load_dwordx4 v4, s[8:11], s42 offen lds
  buffer_load_dwordx4 v5, s[8:11], s42 offen offset:1024 lds
  v_mfma_f32_32x32x16_bf16 v[176:191], a[236:239], a[60:63], v[176:191]
  s_waitcnt lgkmcnt(4)
  v_mfma_f32_32x32x16_bf16 v[128:143], a[224:227], a[64:67], v[128:143]
  ds_read_b64_tr_b16 a[232:233], v10 offset:18432
  ds_read_b64_tr_b16 a[234:235], v10 offset:18944
  ds_read_b128 a[136:139], v15 offset:8192
  ds_read_b128 a[140:143], v15 offset:45056
  v_add_u32 v14, s98, v14
  v_add_u32 v15, s98, v15
  v_add_u32 v16, s98, v16
  v_mfma_f32_32x32x16_bf16 v[144:159], a[224:227], a[68:71], v[144:159]
  ds_read_b64_tr_b16 a[236:237], v11 offset:18432
  ds_read_b64_tr_b16 a[238:239], v11 offset:18944
  v_add_u32 v17, s98, v17
  ds_read_b128 a[144:147], v16 offset:0
  ds_read_b128 a[148:151], v16 offset:36864
  s_waitcnt lgkmcnt(8)
  v_mfma_f32_32x32x16_bf16 v[160:175], a[228:231], a[64:67], v[160:175]
  s_add_u32 m0, s41, 16384
  s_add_u32 s42, s25, 0
  buffer_load_dwordx4 v4, s[8:11], s42 offen lds
  buffer_load_dwordx4 v5, s[8:11], s42 offen offset:1024 lds
  v_mfma_f32_32x32x16_bf16 v[176:191], a[228:231], a[68:71], v[176:191]
  s_waitcnt vmcnt(26)
  v_mfma_f32_32x32x16_bf16 v[64:79], a[246:249], v[26:29], 0
  ds_read_b128 a[152:155], v17 offset:1024
  ds_read_b128 a[156:159], v17 offset:37888
  v_mfma_f32_32x32x16_bf16 v[80:95], a[244:247], v[28:31], 0
  v_mfma_f32_32x32x16_bf16 v[96:111], a[248:251], v[26:29], 0
  v_mfma_f32_32x32x16_bf16 v[112:127], a[246:249], v[28:31], 0
  s_cmp_lg_u32 s96, 0
  s_cbranch_scc1 ka_pf0
  buffer_load_dword v61, v58, s[12:15], 0 offen
  buffer_load_dword v62, v59, s[12:15], 0 offen
ka_pf0:
  s_waitcnt lgkmcnt(8)
  v_mfma_f32_32x32x16_bf16 v[64:79], a[232:235], a[0:3], v[64:79]
  s_waitcnt vmcnt(24)
  ds_read_b64_tr_b16 a[224:225], v10 offset:0
  ds_read_b64_tr_b16 a[226:227], v10 offset:512
  v_mfma_f32_32x32x16_bf16 v[80:95], a[232:235], a[4:7], v[80:95]
  ds_read_b64_tr_b16 a[228:229], v11 offset:0
  ds_read_b64_tr_b16 a[230:231], v11 offset:512
  s_waitcnt lgkmcnt(8)
  v_mfma_f32_32x32x16_bf16 v[96:111], a[236:239], a[0:3], v[96:111]
  s_add_u32 m0, s41, 18432
  s_add_u32 s42, s25, 147456
  buffer_load_dwordx4 v4, s[8:11], s42 offen lds
  buffer_load_dwordx4 v5, s[8:11], s42 offen offset:1024 lds
  v_mfma_f32_32x32x16_bf16 v[112:127], a[236:239], a[4:7], v[112:127]
  s_cmp_lg_u32 s96, 1
  s_cbranch_scc1 ka_pf1
  buffer_load_dword v61, v58, s[12:15], 0 offen
  buffer_load_dword v62, v59, s[12:15], 0 offen
ka_pf1:
  s_waitcnt lgkmcnt(2)
  v_mfma_f32_32x32x16_bf16 v[64:79], a[224:227], a[8:11], v[64:79]
  s_waitcnt vmcnt(24)
  ds_read_b64_tr_b16 a[232:233], v10 offset:2048
  ds_read_b64_tr_b16 a[234:235], v10 offset:2560
  ds_read_b128 a[160:163], v14 offset:2048
  ds_read_b128 a[164:167], v14 offset:38912
  ds_read_b128 a[168:171], v15 offset:3072
  ds_read_b128 a[172:175], v15 offset:39936
  v_mfma_f32_32x32x16_bf16 v[80:95], a[224:227], a[12:15], v[80:95]
  ds_read_b64_tr_b16 a[236:237], v11 offset:2048
  ds_read_b64_tr_b16 a[238:239], v11 offset:2560
  s_waitcnt lgkmcnt(8)
  v_mfma_f32_32x32x16_bf16 v[96:111], a[228:231], a[8:11], v[96:111]
  s_add_u32 m0, s41, 0
  s_add_u32 s42, s25, 294912
  buffer_load_dwordx4 v4, s[8:11], s42 offen lds
  buffer_load_dwordx4 v5, s[8:11], s42 offen offset:1024 lds
  v_mfma_f32_32x32x16_bf16 v[112:127], a[228:231], a[12:15], v[112:127]
  s_waitcnt lgkmcnt(6)
  v_mfma_f32_32x32x16_bf16 v[64:79], a[232:235], a[16:19], v[64:79]
  s_waitcnt vmcnt(22)
  ds_read_b64_tr_b16 a[224:225], v10 offset:4096
  ds_read_b64_tr_b16 a[226:227], v10 offset:4608
  ds_read_b128 a[176:179], v16 offset:4096
  ds_read_b128 a[180:183], v16 offset:40960
  v_mfma_f32_32x32x16_bf16 v[80:95], a[232:235], a[20:23], v[80:95]
  ds_read_b64_tr_b16 a[228:229], v11 offset:4096
  ds_read_b64_tr_b16 a[230:231], v11 offset:4608
  s_waitcnt lgkmcnt(6)
  v_mfma_f32_32x32x16_bf16 v[96:111], a[236:239], a[16:19], v[96:111]
  s_add_u32 m0, s41, 2048
  s_add_u32 s42, s25, 442368
  buffer_load_dwordx4 v4, s[8:11], s42 offen lds
  buffer_load_dwordx4 v5, s[8:11], s42 offen offset:1024 lds
  v_mfma_f32_32x32x16_bf16 v[112:127], a[236:239], a[20:23], v[112:127]
  s_cmp_lg_u32 s96, 2
  s_cbranch_scc1 ka_pf2
  buffer_load_dword v61, v58, s[12:15], 0 offen
  buffer_load_dword v62, v59, s[12:15], 0 offen
ka_pf2:
  s_waitcnt lgkmcnt(4)
  v_mfma_f32_32x32x16_bf16 v[64:79], a[224:227], a[24:27], v[64:79]
  s_waitcnt vmcnt(16)
  ds_read_b64_tr_b16 a[232:233], v10 offset:6144
  ds_read_b64_tr_b16 a[234:235], v10 offset:6656
  ds_read_b128 a[184:187], v17 offset:5120
  ds_read_b128 a[188:191], v17 offset:41984
  ds_read_b128 a[192:195], v14 offset:6144
  ds_read_b128 a[196:199], v14 offset:43008
  v_mfma_f32_32x32x16_bf16 v[80:95], a[224:227], a[28:31], v[80:95]
  ds_read_b64_tr_b16 a[236:237], v11 offset:6144
  ds_read_b64_tr_b16 a[238:239], v11 offset:6656
  s_waitcnt lgkmcnt(8)
  v_mfma_f32_32x32x16_bf16 v[96:111], a[228:231], a[24:27], v[96:111]
  s_add_u32 m0, s41, 4096
  s_add_u32 s42, s25, 589824
  buffer_load_dwordx4 v4, s[8:11], s42 offen lds
  buffer_load_dwordx4 v5, s[8:11], s42 offen offset:1024 lds
  v_mfma_f32_32x32x16_bf16 v[112:127], a[228:231], a[28:31], v[112:127]
  s_cmp_lg_u32 s96, 3
  s_cbranch_scc1 ka_pf3
  buffer_load_dword v61, v58, s[12:15], 0 offen
  buffer_load_dword v62, v59, s[12:15], 0 offen
ka_pf3:
  s_waitcnt lgkmcnt(6)
  v_mfma_f32_32x32x16_bf16 v[64:79], a[232:235], a[32:35], v[64:79]
  s_waitcnt vmcnt(16)
  ds_read_b64_tr_b16 a[224:225], v10 offset:8192
  ds_read_b64_tr_b16 a[226:227], v10 offset:8704
  ds_read_b128 a[200:203], v15 offset:7168
  ds_read_b128 a[204:207], v15 offset:44032
  v_mfma_f32_32x32x16_bf16 v[80:95], a[232:235], a[36:39], v[80:95]
  ds_read_b64_tr_b16 a[228:229], v11 offset:8192
  ds_read_b64_tr_b16 a[230:231], v11 offset:8704
  s_waitcnt lgkmcnt(6)
  v_mfma_f32_32x32x16_bf16 v[96:111], a[236:239], a[32:35], v[96:111]
  s_add_u32 m0, s41, 6144
  s_add_u32 s42, s25, 737280
  buffer_load_dwordx4 v4, s[8:11], s42 offen lds
  buffer_load_dwordx4 v5, s[8:11], s42 offen offset:1024 lds
  v_mfma_f32_32x32x16_bf16 v[112:127], a[236:239], a[36:39], v[112:127]
  s_waitcnt lgkmcnt(4)
  v_mfma_f32_32x32x16_bf16 v[64:79], a[224:227], a[40:43], v[64:79]
  s_waitcnt vmcnt(16)
  ds_read_b64_tr_b16 a[232:233], v10 offset:10240
  ds_read_b64_tr_b16 a[234:235], v10 offset:10752
  ds_read_b128 a[208:211], v16 offset:8192
  ds_read_b128 a[212:215], v16 offset:45056
  v_add_u32 v14, s99, v14
  v_add_u32 v15, s99, v15
  v_mfma_f32_32x32x16_bf16 v[80:95], a[224:227], a[44:47], v[80:95]
  ds_read_b64_tr_b16 a[236:237], v11 offset:10240
  ds_read_b64_tr_b16 a[238:239], v11 offset:10752
  v_add_u32 v16, s99, v16
  v_add_u32 v17, s99, v17
  ds_read_b128 a[216:219], v17 offset:0
  ds_read_b128 a[220:223], v17 offset:36864
  s_waitcnt lgkmcnt(8)
  v_mfma_f32_32x32x16_bf16 v[96:111], a[228:231], a[40:43], v[96:111]
  s_add_u32 m0, s41, 8192
  s_add_u32 s42, s25, 884736
  buffer_load_dwordx4 v4, s[8:11], s42 offen lds
  buffer_load_dwordx4 v5, s[8:11], s42 offen offset:1024 lds
  v_mfma_f32_32x32x16_bf16 v[112:127], a[228:231], a[44:47], v[112:127]
  s_cmp_lg_u32 s96, 4
  s_cbranch_scc1 ka_pf4
  buffer_load_dword v61, v58, s[12:15], 0 offen
  buffer_load_dword v62, v59, s[12:15], 0 offen
ka_pf4:
  s_waitcnt lgkmcnt(6)
  v_mfma_f32_32x32x16_bf16 v[64:79], a[232:235], a[48:51], v[64:79]
  s_waitcnt vmcnt(16)
  ds_read_b64_tr_b16 a[224:225], v10 offset:12288
  ds_read_b64_tr_b16 a[226:227], v10 offset:12800
  ds_read_b128 v[192:195], v14 offset:1024
  ds_read_b128 v[196:199], v14 offset:37888
  v_mfma_f32_32x32x16_bf16 v[80:95], a[232:235], a[52:55], v[80:95]
  ds_read_b64_tr_b16 a[228:229], v11 offset:12288
  ds_read_b64_tr_b16 a[230:231], v11 offset:12800
  s_waitcnt lgkmcnt(8)
  v_mfma_f32_32x32x16_bf16 v[96:111], a[236:239], a[48:51], v[96:111]
  s_add_u32 m0, s41, 10240
  s_add_u32 s42, s25, 1032192
  buffer_load_dwordx4 v4, s[8:11], s42 offen lds
  buffer_load_dwordx4 v5, s[8:11], s42 offen offset:1024 lds
  v_mfma_f32_32x32x16_bf16 v[112:127], a[236:239], a[52:55], v[112:127]
  s_cmp_lg_u32 s96, 5
  s_cbranch_scc1 ka_pf5
  buffer_load_dword v61, v58, s[12:15], 0 offen
  buffer_load_dword v62, v59, s[12:15], 0 offen
ka_pf5:
  s_waitcnt lgkmcnt(4)
  v_mfma_f32_32x32x16_bf16 v[64:79], a[224:227], a[56:59], v[64:79]
  s_waitcnt vmcnt(16)
  ds_read_b64_tr_b16 a[232:233], v10 offset:14336
  ds_read_b64_tr_b16 a[234:235], v10 offset:14848
  ds_read_b128 v[200:203], v15 offset:2048
  ds_read_b128 v[204:207], v15 offset:38912
  ds_read_b128 v[208:211], v16 offset:3072
  ds_read_b128 v[212:215], v16 offset:39936
  v_mfma_f32_32x32x16_bf16 v[80:95], a[224:227], a[60:63], v[80:95]
  ds_read_b64_tr_b16 a[236:237], v11 offset:14336
  ds_read_b64_tr_b16 a[238:239], v11 offset:14848
  s_waitcnt lgkmcnt(8)
  v_mfma_f32_32x32x16_bf16 v[96:111], a[228:231], a[56:59], v[96:111]
  s_add_u32 m0, s41, 12288
  s_add_u32 s42, s25, 1179648
  buffer_load_dwordx4 v4, s[8:11], s42 offen lds
  buffer_load_dwordx4 v5, s[8:11], s42 offen offset:1024 lds
  v_mfma_f32_32x32x16_bf16 v[112:127], a[228:231], a[60:63], v[112:127]
  s_waitcnt lgkmcnt(6)
  v_mfma_f32_32x32x16_bf16 v[64:79], a[232:235], a[64:67], v[64:79]
  s_waitcnt vmcnt(16)
  ds_read_b64_tr_b16 a[224:225], v10 offset:16384
  ds_read_b64_tr_b16 a[226:227], v10 offset:16896
  ds_read_b128 v[216:219], v17 offset:4096
  ds_read_b128 v[220:223], v17 offset:40960
  v_mfma_f32_32x32x16_bf16 v[80:95], a[232:235], a[68:71], v[80:95]
  ds_read_b64_tr_b16 a[228:229], v11 offset:16384
  ds_read_b64_tr_b16 a[230:231], v11 offset:16896
  s_waitcnt lgkmcnt(6)
  v_mfma_f32_32x32x16_bf16 v[96:111], a[236:239], a[64:67], v[96:111]
  s_add_u32 m0, s41, 14336
  s_add_u32 s42, s26, 0
  buffer_load_dwordx4 v4, s[8:11], s42 offen lds
  buffer_load_dwordx4 v5, s[8:11], s42 offen offset:1024 lds
  v_mfma_f32_32x32x16_bf16 v[112:127], a[236:239], a[68:71], v[112:127]
  s_cmp_lg_u32 s96, 6
  s_cbranch_scc1 ka_pf6
  buffer_load_dword v61, v58, s[12:15], 0 offen
  buffer_load_dword v62, v59, s[12:15], 0 offen
ka_pf6:
  s_waitcnt lgkmcnt(4)
  v_mfma_f32_32x32x16_bf16 v[64:79], a[224:227], a[72:75], v[64:79]
  s_waitcnt vmcnt(16)
  ds_read_b64_tr_b16 a[232:233], v10 offset:18432
  ds_read_b64_tr_b16 a[234:235], v10 offset:18944
  ds_read_b128 v[224:227], v14 offset:5120
  ds_read_b128 v[228:231], v14 offset:41984
  ds_read_b128 v[232:235], v15 offset:6144
  ds_read_b128 v[236:239], v15 offset:43008
  v_mfma_f32_32x32x16_bf16 v[80:95], a[224:227], a[76:79], v[80:95]
  ds_read_b64_tr_b16 a[236:237], v11 offset:18432
  ds_read_b64_tr_b16 a[238:239], v11 offset:18944
  s_waitcnt lgkmcnt(8)
  v_mfma_f32_32x32x16_bf16 v[96:111], a[228:231], a[72:75], v[96:111]
  s_add_u32 m0, s41, 16384
  s_add_u32 s42, s26, 147456
  buffer_load_dwordx4 v4, s[8:11], s42 offen lds
  buffer_load_dwordx4 v5, s[8:11], s42 offen offset:1024 lds
  v_mfma_f32_32x32x16_bf16 v[112:127], a[228:231], a[76:79], v[112:127]
  s_cmp_lg_u32 s96, 7
  s_cbranch_scc1 ka_pf7
  buffer_load_dword v61, v58, s[12:15], 0 offen
  buffer_load_dword v62, v59, s[12:15], 0 offen
ka_pf7:
  s_waitcnt lgkmcnt(6)
  v_mfma_f32_32x32x16_bf16 v[64:79], a[232:235], a[80:83], v[64:79]
  s_waitcnt vmcnt(16)
  ds_read_b64_tr_b16 a[224:225], v10 offset:0
  ds_read_b64_tr_b16 a[226:227], v10 offset:512
  ds_read_b128 v[240:243], v16 offset:7168
  ds_read_b128 v[244:247], v16 offset:44032
  v_mfma_f32_32x32x16_bf16 v[80:95], a[232:235], a[84:87], v[80:95]
  ds_read_b64_tr_b16 a[228:229], v11 offset:0
  ds_read_b64_tr_b16 a[230:231], v11 offset:512
  s_waitcnt lgkmcnt(6)
  v_mfma_f32_32x32x16_bf16 v[96:111], a[236:239], a[80:83], v[96:111]
  s_add_u32 m0, s41, 18432
  s_add_u32 s42, s26, 294912
  buffer_load_dwordx4 v4, s[8:11], s42 offen lds
  buffer_load_dwordx4 v5, s[8:11], s42 offen offset:1024 lds
  v_mfma_f32_32x32x16_bf16 v[112:127], a[236:239], a[84:87], v[112:127]
  s_waitcnt lgkmcnt(4)
  v_mfma_f32_32x32x16_bf16 v[64:79], a[224:227], a[88:91], v[64:79]
  s_waitcnt vmcnt(16)
  ds_read_b64_tr_b16 a[232:233], v10 offset:2048
  ds_read_b64_tr_b16 a[234:235], v10 offset:2560
  ds_read_b128 v[248:251], v17 offset:8192
  ds_read_b128 v[252:255], v17 offset:45056
  v_mfma_f32_32x32x16_bf16 v[80:95], a[224:227], a[92:95], v[80:95]
  ds_read_b64_tr_b16 a[236:237], v11 offset:2048
  ds_read_b64_tr_b16 a[238:239], v11 offset:2560
  s_waitcnt lgkmcnt(6)
  v_mfma_f32_32x32x16_bf16 v[96:111], a[228:231], a[88:91], v[96:111]
  s_add_u32 m0, s41, 0
  s_add_u32 s42, s26, 442368
  buffer_load_dwordx4 v4, s[8:11], s42 offen lds
  buffer_load_dwordx4 v5, s[8:11], s42 offen offset:1024 lds
  v_mfma_f32_32x32x16_bf16 v[112:127], a[228:231], a[92:95], v[112:127]
  s_cmp_lg_u32 s96, 8
  s_cbranch_scc1 ka_pf8
  buffer_load_dword v61, v58, s[12:15], 0 offen
  buffer_load_dword v62, v59, s[12:15], 0 offen
ka_pf8:
  s_waitcnt lgkmcnt(4)
  v_mfma_f32_32x32x16_bf16 v[64:79], a[232:235], a[96:99], v[64:79]
  s_waitcnt vmcnt(16)
  ds_read_b64_tr_b16 a[224:225], v10 offset:4096
  ds_read_b64_tr_b16 a[226:227], v10 offset:4608
  s_waitcnt lgkmcnt(0)
  s_barrier
  v_add_u32 v22, s62, v3
  ds_write_b128 v22, v[128:131] offset:0
  v_mfma_f32_32x32x16_bf16 v[80:95], a[232:235], a[100:103], v[80:95]
  ds_read_b64_tr_b16 a[228:229], v11 offset:4096
  ds_read_b64_tr_b16 a[230:231], v11 offset:4608
  ds_write_b128 v22, v[132:135] offset:1024
  ds_write_b128 v22, v[136:139] offset:2048
  ds_write_b128 v22, v[140:143] offset:3072
  ds_write_b128 v22, v[144:147] offset:4096
  v_mfma_f32_32x32x16_bf16 v[96:111], a[236:239], a[96:99], v[96:111]
  s_add_u32 m0, s41, 2048
  s_add_u32 s42, s26, 589824
  buffer_load_dwordx4 v4, s[8:11], s42 offen lds
  buffer_load_dwordx4 v5, s[8:11], s42 offen offset:1024 lds
  ds_write_b128 v22, v[148:151] offset:5120
  ds_write_b128 v22, v[152:155] offset:6144
  ds_write_b128 v22, v[156:159] offset:7168
  v_mfma_f32_32x32x16_bf16 v[112:127], a[236:239], a[100:103], v[112:127]
  ds_write_b128 v22, v[160:163] offset:8192
  ds_write_b128 v22, v[164:167] offset:9216
  ds_write_b128 v22, v[168:171] offset:10240
  ds_write_b128 v22, v[172:175] offset:11264
  ds_write_b128 v22, v[176:179] offset:12288
  ds_write_b128 v22, v[180:183] offset:13312
  s_cmp_lg_u32 s96, 9
  s_cbranch_scc1 ka_pf9
  buffer_load_dword v61, v58, s[12:15], 0 offen
  buffer_load_dword v62, v59, s[12:15], 0 offen
ka_pf9:
  v_mfma_f32_32x32x16_bf16 v[64:79], a[224:227], a[104:107], v[64:79]
  s_waitcnt vmcnt(16)
  ds_read_b64_tr_b16 a[232:233], v10 offset:6144
  ds_read_b64_tr_b16 a[234:235], v10 offset:6656
  ds_write_b128 v22, v[184:187] offset:14336
  ds_write_b128 v22, v[188:191] offset:15360
  s_waitcnt lgkmcnt(0)
  s_barrier
  v_mfma_f32_32x32x16_bf16 v[80:95], a[224:227], a[108:111], v[80:95]
  ds_read_b64_tr_b16 a[236:237], v11 offset:6144
  ds_read_b64_tr_b16 a[238:239], v11 offset:6656
  v_add_u32 v22, s63, v3
  ds_read_b128 v[128:131], v22 offset:0
  ds_read_b128 v[132:135], v22 offset:1024
  ds_read_b128 v[136:139], v22 offset:4096
  v_mfma_f32_32x32x16_bf16 v[96:111], a[228:231], a[104:107], v[96:111]
  s_add_u32 m0, s41, 4096
  s_add_u32 s42, s26, 737280
  buffer_load_dwordx4 v4, s[8:11], s42 offen lds
  buffer_load_dwordx4 v5, s[8:11], s42 offen offset:1024 lds
  ds_read_b128 v[140:143], v22 offset:5120
  ds_read_b128 v[144:147], v22 offset:16384
  ds_read_b128 v[148:151], v22 offset:17408
  v_mfma_f32_32x32x16_bf16 v[112:127], a[228:231], a[108:111], v[112:127]
  ds_read_b128 v[152:155], v22 offset:20480
  ds_read_b128 v[156:159], v22 offset:21504
  ds_read_b128 v[160:163], v22 offset:36864
  ds_read_b128 v[164:167], v22 offset:37888
  ds_read_b128 v[168:171], v22 offset:40960
  ds_read_b128 v[172:175], v22 offset:41984
  v_mfma_f32_32x32x16_bf16 v[64:79], a[232:235], a[112:115], v[64:79]
  s_waitcnt vmcnt(16)
  ds_read_b64_tr_b16 a[224:225], v10 offset:8192
  ds_read_b64_tr_b16 a[226:227], v10 offset:8704
  ds_read_b128 v[176:179], v22 offset:53248
  ds_read_b128 v[180:183], v22 offset:54272
  ds_read_b128 v[184:187], v22 offset:57344
  ds_read_b128 v[188:191], v22 offset:58368
  v_mfma_f32_32x32x16_bf16 v[80:95], a[232:235], a[116:119], v[80:95]
  ds_read_b64_tr_b16 a[228:229], v11 offset:8192
  ds_read_b64_tr_b16 a[230:231], v11 offset:8704
  s_waitcnt lgkmcnt(15)
  v_add_f32 v128, v128, v144
  v_add_f32 v129, v129, v145
  v_add_f32 v130, v130, v146
  v_mfma_f32_32x32x16_bf16 v[96:111], a[236:239], a[112:115], v[96:111]
  s_add_u32 m0, s41, 6144
  s_add_u32 s42, s26, 884736
  buffer_load_dwordx4 v4, s[8:11], s42 offen lds
  buffer_load_dwordx4 v5, s[8:11], s42 offen offset:1024 lds
  v_add_f32 v131, v131, v147
  s_waitcnt lgkmcnt(14)
  v_add_f32 v132, v132, v148
  v_mfma_f32_32x32x16_bf16 v[112:127], a[236:239], a[116:119], v[112:127]
  v_add_f32 v133, v133, v149
  v_add_f32 v134, v134, v150
  v_add_f32 v135, v135, v151
  s_waitcnt lgkmcnt(13)
  v_add_f32 v136, v136, v152
  v_add_f32 v137, v137, v153
  s_cmp_lg_u32 s96, 10
  s_cbranch_scc1 ka_pf10
  buffer_load_dword v61, v58, s[12:15], 0 offen
  buffer_load_dword v62, v59, s[12:15], 0 offen
ka_pf10:
  s_waitcnt lgkmcnt(6)
  v_mfma_f32_32x32x16_bf16 v[64:79], a[224:227], a[120:123], v[64:79]
  s_waitcnt vmcnt(16)
  ds_read_b64_tr_b16 a[232:233], v10 offset:10240
  ds_read_b64_tr_b16 a[234:235], v10 offset:10752
  v_add_f32 v138, v138, v154
  v_add_f32 v139, v139, v155
  v_add_f32 v140, v140, v156
  v_add_f32 v141, v141, v157
  v_mfma_f32_32x32x16_bf16 v[80:95], a[224:227], a[124:127], v[80:95]
  ds_read_b64_tr_b16 a[236:237], v11 offset:10240
  ds_read_b64_tr_b16 a[238:239], v11 offset:10752
  v_add_f32 v142, v142, v158
  v_add_f32 v143, v143, v159
  v_add_f32 v128, v128, v160
  v_add_f32 v129, v129, v161
  s_waitcnt lgkmcnt(4)
  v_mfma_f32_32x32x16_bf16 v[96:111], a[228:231], a[120:123], v[96:111]
  s_add_u32 m0, s41, 8192
  s_add_u32 s42, s26, 1032192
  buffer_load_dwordx4 v4, s[8:11], s42 offen lds
  buffer_load_dwordx4 v5, s[8:11], s42 offen offset:1024 lds
  v_add_f32 v130, v130, v162
  v_add_f32 v131, v131, v163
  v_add_f32 v132, v132, v164
  v_mfma_f32_32x32x16_bf16 v[112:127], a[228:231], a[124:127], v[112:127]
  v_add_f32 v133, v133, v165
  v_add_f32 v134, v134, v166
  v_add_f32 v135, v135, v167
  v_add_f32 v136, v136, v168
  v_add_f32 v137, v137, v169
  v_add_f32 v138, v138, v170
  s_cmp_lg_u32 s96, 11
  s_cbranch_scc1 ka_pf11
  buffer_load_dword v61, v58, s[12:15], 0 offen
  buffer_load_dword v62, v59, s[12:15], 0 offen
ka_pf11:
  s_waitcnt lgkmcnt(2)
  v_mfma_f32_32x32x16_bf16 v[64:79], a[232:235], a[128:131], v[64:79]
  s_waitcnt vmcnt(16)
  ds_read_b64_tr_b16 a[224:225], v10 offset:12288
  ds_read_b64_tr_b16 a[226:227], v10 offset:12800
  v_add_f32 v139, v139, v171
  v_add_f32 v140, v140, v172
  v_add_f32 v141, v141, v173
  v_add_f32 v142, v142, v174
  v_mfma_f32_32x32x16_bf16 v[80:95], a[232:235], a[132:135], v[80:95]
  ds_read_b64_tr_b16 a[228:229], v11 offset:12288
  ds_read_b64_tr_b16 a[230:231], v11 offset:12800
  v_add_f32 v143, v143, v175
  v_add_f32 v128, v128, v176
  v_add_f32 v129, v129, v177
  v_add_f32 v130, v130, v178
  s_waitcnt lgkmcnt(4)
  v_mfma_f32_32x32x16_bf16 v[96:111], a[236:239], a[128:131], v[96:111]
  s_add_u32 m0, s41, 10240
  s_add_u32 s42, s26, 1179648
  buffer_load_dwordx4 v4, s[8:11], s42 offen lds
  buffer_load_dwordx4 v5, s[8:11], s42 offen offset:1024 lds
  v_add_f32 v131, v131, v179
  v_add_f32 v132, v132, v180
  v_add_f32 v133, v133, v181
  v_mfma_f32_32x32x16_bf16 v[112:127], a[236:239], a[132:135], v[112:127]
  v_add_f32 v134, v134, v182
  v_add_f32 v135, v135, v183
  v_add_f32 v136, v136, v184
  v_add_f32 v137, v137, v185
  v_add_f32 v138, v138, v186
  v_add_f32 v139, v139, v187
  s_waitcnt lgkmcnt(2)
  v_mfma_f32_32x32x16_bf16 v[64:79], a[224:227], a[136:139], v[64:79]
  s_waitcnt vmcnt(16)
  ds_read_b64_tr_b16 a[232:233], v10 offset:14336
  ds_read_b64_tr_b16 a[234:235], v10 offset:14848
  v_add_f32 v140, v140, v188
  v_add_f32 v141, v141, v189
  v_add_f32 v142, v142, v190
  v_add_f32 v143, v143, v191
  v_mfma_f32_32x32x16_bf16 v[80:95], a[224:227], a[140:143], v[80:95]
  ds_read_b64_tr_b16 a[236:237], v11 offset:14336
  ds_read_b64_tr_b16 a[238:239], v11 offset:14848
  v_mul_f32 v32, v128, v128
  v_mul_f32 v33, v129, v129
  v_mul_f32 v34, v130, v130
  v_fma_f32 v32, v32, v2, v0
  s_waitcnt lgkmcnt(4)
  v_mfma_f32_32x32x16_bf16 v[96:111], a[228:231], a[136:139], v[96:111]
  s_add_u32 m0, s41, 12288
  s_add_u32 s42, s27, 0
  buffer_load_dwordx4 v4, s[8:11], s42 offen lds
  buffer_load_dwordx4 v5, s[8:11], s42 offen offset:1024 lds
  v_mul_f32 v32, v128, v32
  v_fma_f32 v33, v33, v2, v0
  v_fma_f32 v34, v34, v2, v0
  v_mfma_f32_32x32x16_bf16 v[112:127], a[228:231], a[140:143], v[112:127]
  v_exp_f32 v32, v32
  v_mul_f32 v33, v129, v33
  v_mul_f32 v34, v130, v34
  v_mul_f32 v35, v131, v131
  v_mul_f32 v36, v132, v132
  s_cmp_lg_u32 s96, 12
  s_cbranch_scc1 ka_pf12
  buffer_load_dword v61, v58, s[12:15], 0 offen
  buffer_load_dword v62, v59, s[12:15], 0 offen
ka_pf12:
  s_waitcnt lgkmcnt(2)
  v_mfma_f32_32x32x16_bf16 v[64:79], a[232:235], a[144:147], v[64:79]
  s_waitcnt vmcnt(16)
  ds_read_b64_tr_b16 a[224:225], v10 offset:16384
  ds_read_b64_tr_b16 a[226:227], v10 offset:16896
  v_fma_f32 v32, v32, v26, v26
  v_exp_f32 v33, v33
  v_fma_f32 v35, v35, v2, v0
  v_mfma_f32_32x32x16_bf16 v[80:95], a[232:235], a[148:151], v[80:95]
  ds_read_b64_tr_b16 a[228:229], v11 offset:16384
  ds_read_b64_tr_b16 a[230:231], v11 offset:16896
  v_rcp_f32 v32, v32
  v_fma_f32 v33, v33, v26, v26
  v_mul_f32 v35, v131, v35
  s_waitcnt lgkmcnt(4)
  v_mfma_f32_32x32x16_bf16 v[96:111], a[236:239], a[144:147], v[96:111]
  s_add_u32 m0, s41, 14336
  s_add_u32 s42, s27, 147456
  buffer_load_dwordx4 v4, s[8:11], s42 offen lds
  buffer_load_dwordx4 v5, s[8:11], s42 offen offset:1024 lds
  v_mul_f32 v32, v128, v32
  v_rcp_f32 v33, v33
  v_mfma_f32_32x32x16_bf16 v[112:127], a[236:239], a[148:151], v[112:127]
  v_exp_f32 v34, v34
  v_exp_f32 v35, v35
  v_fma_f32 v36, v36, v2, v0
  v_mul_f32 v33, v129, v33
  s_cmp_lg_u32 s96, 13
  s_cbranch_scc1 ka_pf13
  buffer_load_dword v61, v58, s[12:15], 0 offen
  buffer_load_dword v62, v59, s[12:15], 0 offen
ka_pf13:
  s_waitcnt lgkmcnt(2)
  v_mfma_f32_32x32x16_bf16 v[64:79], a[224:227], a[152:155], v[64:79]
  s_waitcnt vmcnt(16)
  ds_read_b64_tr_b16 a[232:233], v10 offset:18432
  ds_read_b64_tr_b16 a[234:235], v10 offset:18944
  v_fma_f32 v34, v34, v26, v26
  v_fma_f32 v35, v35, v26, v26
  v_cvt_pk_bf16_f32 v48, v32, v33
  v_mul_f32 v36, v132, v36
  v_mfma_f32_32x32x16_bf16 v[80:95], a[224:227], a[156:159], v[80:95]
  ds_read_b64_tr_b16 a[236:237], v11 offset:18432
  ds_read_b64_tr_b16 a[238:239], v11 offset:18944
  v_rcp_f32 v34, v34
  v_rcp_f32 v35, v35
  s_waitcnt lgkmcnt(4)
  v_mfma_f32_32x32x16_bf16 v[96:111], a[228:231], a[152:155], v[96:111]
  s_add_u32 m0, s41, 16384
  s_add_u32 s42, s27, 294912
  buffer_load_dwordx4 v4, s[8:11], s42 offen lds
  buffer_load_dwordx4 v5, s[8:11], s42 offen offset:1024 lds
  v_mul_f32 v34, v130, v34
  v_mul_f32 v35, v131, v35
  v_mul_f32 v37, v133, v133
  v_mfma_f32_32x32x16_bf16 v[112:127], a[228:231], a[156:159], v[112:127]
  v_cvt_pk_bf16_f32 v49, v34, v35
  v_exp_f32 v36, v36
  v_fma_f32 v37, v37, v2, v0
  v_mul_f32 v38, v134, v134
  v_mul_f32 v39, v135, v135
  s_waitcnt lgkmcnt(2)
  v_mfma_f32_32x32x16_bf16 v[64:79], a[232:235], a[160:163], v[64:79]
  s_waitcnt vmcnt(16)
  ds_read_b64_tr_b16 a[224:225], v10 offset:0
  ds_read_b64_tr_b16 a[226:227], v10 offset:512
  v_fma_f32 v36, v36, v26, v26
  v_mul_f32 v37, v133, v37
  v_fma_f32 v38, v38, v2, v0
  v_fma_f32 v39, v39, v2, v0
  v_mfma_f32_32x32x16_bf16 v[80:95], a[232:235], a[164:167], v[80:95]
  ds_read_b64_tr_b16 a[228:229], v11 offset:0
  ds_read_b64_tr_b16 a[230:231], v11 offset:512
  v_rcp_f32 v36, v36
  v_exp_f32 v37, v37
  s_waitcnt lgkmcnt(4)
  v_mfma_f32_32x32x16_bf16 v[96:111], a[236:239], a[160:163], v[96:111]
  s_add_u32 m0, s41, 18432
  s_add_u32 s42, s27, 442368
  buffer_load_dwordx4 v4, s[8:11], s42 offen lds
  buffer_load_dwordx4 v5, s[8:11], s42 offen offset:1024 lds
  v_mul_f32 v36, v132, v36
  v_fma_f32 v37, v37, v26, v26
  v_mul_f32 v38, v134, v38
  v_mfma_f32_32x32x16_bf16 v[112:127], a[236:239], a[164:167], v[112:127]
  v_rcp_f32 v37, v37
  v_exp_f32 v38, v38
  v_mul_f32 v39, v135, v39
  v_mul_f32 v40, v136, v136
  s_cmp_lg_u32 s96, 14
  s_cbranch_scc1 ka_pf14
  buffer_load_dword v61, v58, s[12:15], 0 offen
  buffer_load_dword v62, v59, s[12:15], 0 offen
ka_pf14:
  s_waitcnt lgkmcnt(2)
  v_mfma_f32_32x32x16_bf16 v[64:79], a[224:227], a[168:171], v[64:79]
  s_waitcnt vmcnt(16)
  ds_read_b64_tr_b16 a[232:233], v10 offset:2048
  ds_read_b64_tr_b16 a[234:235], v10 offset:2560
  v_mul_f32 v37, v133, v37
  v_fma_f32 v38, v38, v26, v26
  v_exp_f32 v39, v39
  v_mfma_f32_32x32x16_bf16 v[80:95], a[224:227], a[172:175], v[80:95]
  ds_read_b64_tr_b16 a[236:237], v11 offset:2048
  ds_read_b64_tr_b16 a[238:239], v11 offset:2560
  v_rcp_f32 v38, v38
  v_fma_f32 v39, v39, v26, v26
  v_cvt_pk_bf16_f32 v50, v36, v37
  s_waitcnt lgkmcnt(4)
  v_mfma_f32_32x32x16_bf16 v[96:111], a[228:231], a[168:171], v[96:111]
  s_add_u32 m0, s41, 0
  s_add_u32 s42, s27, 589824
  buffer_load_dwordx4 v4, s[8:11], s42 offen lds
  buffer_load_dwordx4 v5, s[8:11], s42 offen offset:1024 lds
  v_mul_f32 v38, v134, v38
  v_rcp_f32 v39, v39
  v_mfma_f32_32x32x16_bf16 v[112:127], a[228:231], a[172:175], v[112:127]
  v_fma_f32 v40, v40, v24, v1
  v_mul_f32 v41, v137, v137
  v_mul_f32 v42, v138, v138
  v_mul_f32 v39, v135, v39
  v_mul_f32 v40, v136, v40
  v_fma_f32 v41, v41, v24, v1
  s_cmp_lg_u32 s96, 15
  s_cbranch_scc1 ka_pf15
  buffer_load_dword v61, v58, s[12:15], 0 offen
  buffer_load_dword v62, v59, s[12:15], 0 offen
ka_pf15:
  s_waitcnt lgkmcnt(2)
  v_mfma_f32_32x32x16_bf16 v[64:79], a[232:235], a[176:179], v[64:79]
  s_waitcnt vmcnt(16)
  ds_read_b64_tr_b16 a[224:225], v10 offset:4096
  ds_read_b64_tr_b16 a[226:227], v10 offset:4608
  v_cvt_pk_bf16_f32 v51, v38, v39
  ds_write_b128 v18, v[48:51] offset:0
  v_exp_f32 v40, v40
  v_mfma_f32_32x32x16_bf16 v[80:95], a[232:235], a[180:183], v[80:95]
  ds_read_b64_tr_b16 a[228:229], v11 offset:4096
  ds_read_b64_tr_b16 a[230:231], v11 offset:4608
  v_mul_f32 v41, v137, v41
  v_fma_f32 v40, v40, v30, v30
  v_fma_f32 v42, v42, v24, v1
  v_mul_f32 v43, v139, v139
  s_waitcnt lgkmcnt(5)
  v_mfma_f32_32x32x16_bf16 v[96:111], a[236:239], a[176:179], v[96:111]
  s_add_u32 m0, s41, 2048
  s_add_u32 s42, s27, 737280
  buffer_load_dwordx4 v4, s[8:11], s42 offen lds
  buffer_load_dwordx4 v5, s[8:11], s42 offen offset:1024 lds
  v_rcp_f32 v40, v40
  v_mul_f32 v42, v138, v42
  v_mfma_f32_32x32x16_bf16 v[112:127], a[236:239], a[180:183], v[112:127]
  v_exp_f32 v41, v41
  v_exp_f32 v42, v42
  v_mul_f32 v40, v136, v40
  v_fma_f32 v43, v43, v24, v1
  s_waitcnt lgkmcnt(3)
  v_mfma_f32_32x32x16_bf16 v[64:79], a[224:227], a[184:187], v[64:79]
  s_waitcnt vmcnt(16)
  ds_read_b64_tr_b16 a[232:233], v10 offset:6144
  ds_read_b64_tr_b16 a[234:235], v10 offset:6656
  v_fma_f32 v41, v41, v30, v30
  v_fma_f32 v42, v42, v30, v30
  v_mul_f32 v43, v139, v43
  v_mul_f32 v44, v140, v140
  v_mfma_f32_32x32x16_bf16 v[80:95], a[224:227], a[188:191], v[80:95]
  ds_read_b64_tr_b16 a[236:237], v11 offset:6144
  ds_read_b64_tr_b16 a[238:239], v11 offset:6656
  v_rcp_f32 v41, v41
  v_rcp_f32 v42, v42
  s_waitcnt lgkmcnt(4)
  v_mfma_f32_32x32x16_bf16 v[96:111], a[228:231], a[184:187], v[96:111]
  s_add_u32 m0, s41, 4096
  s_add_u32 s42, s27, 884736
  buffer_load_dwordx4 v4, s[8:11], s42 offen lds
  buffer_load_dwordx4 v5, s[8:11], s42 offen offset:1024 lds
  v_mul_f32 v41, v137, v41
  v_mul_f32 v42, v138, v42
  v_fma_f32 v44, v44, v24, v1
  v_mfma_f32_32x32x16_bf16 v[112:127], a[228:231], a[188:191], v[112:127]
  v_exp_f32 v43, v43
  v_cvt_pk_bf16_f32 v52, v40, v41
  v_mul_f32 v44, v140, v44
  v_mul_f32 v45, v141, v141
  v_mul_f32 v46, v142, v142
  s_waitcnt lgkmcnt(2)
  v_mfma_f32_32x32x16_bf16 v[64:79], a[232:235], a[192:195], v[64:79]
  s_waitcnt vmcnt(16)
  ds_read_b64_tr_b16 a[224:225], v10 offset:8192
  ds_read_b64_tr_b16 a[226:227], v10 offset:8704
  v_fma_f32 v43, v43, v30, v30
  v_exp_f32 v44, v44
  v_fma_f32 v45, v45, v24, v1
  v_mfma_f32_32x32x16_bf16 v[80:95], a[232:235], a[196:199], v[80:95]
  ds_read_b64_tr_b16 a[228:229], v11 offset:8192
  ds_read_b64_tr_b16 a[230:231], v11 offset:8704
  v_rcp_f32 v43, v43
  v_fma_f32 v44, v44, v30, v30
  v_mul_f32 v45, v141, v45
  s_waitcnt lgkmcnt(4)
  v_mfma_f32_32x32x16_bf16 v[96:111], a[236:239], a[192:195], v[96:111]
  s_add_u32 m0, s41, 6144
  s_add_u32 s42, s27, 1032192
  buffer_load_dwordx4 v4, s[8:11], s42 offen lds
  buffer_load_dwordx4 v5, s[8:11], s42 offen offset:1024 lds
  v_mul_f32 v43, v139, v43
  v_rcp_f32 v44, v44
  v_mfma_f32_32x32x16_bf16 v[112:127], a[236:239], a[196:199], v[112:127]
  v_cvt_pk_bf16_f32 v53, v42, v43
  v_exp_f32 v45, v45
  v_fma_f32 v46, v46, v24, v1
  v_mul_f32 v44, v140, v44
  v_mul_f32 v47, v143, v143
  s_waitcnt lgkmcnt(2)
  v_mfma_f32_32x32x16_bf16 v[64:79], a[224:227], a[200:203], v[64:79]
  s_waitcnt vmcnt(16)
  ds_read_b64_tr_b16 a[232:233], v10 offset:10240
  ds_read_b64_tr_b16 a[234:235], v10 offset:10752
  v_fma_f32 v45, v45, v30, v30
  v_mul_f32 v46, v142, v46
  v_fma_f32 v47, v47, v24, v1
  v_mfma_f32_32x32x16_bf16 v[80:95], a[224:227], a[204:207], v[80:95]
  ds_read_b64_tr_b16 a[236:237], v11 offset:10240
  ds_read_b64_tr_b16 a[238:239], v11 offset:10752
  v_rcp_f32 v45, v45
  v_exp_f32 v46, v46
  s_waitcnt lgkmcnt(4)
  v_mfma_f32_32x32x16_bf16 v[96:111], a[228:231], a[200:203], v[96:111]
  s_add_u32 m0, s41, 8192
  s_add_u32 s42, s27, 1179648
  buffer_load_dwordx4 v4, s[8:11], s42 offen lds
  buffer_load_dwordx4 v5, s[8:11], s42 offen offset:1024 lds
  v_mul_f32 v45, v141, v45
  v_fma_f32 v46, v46, v30, v30
  v_mul_f32 v47, v143, v47
  v_mfma_f32_32x32x16_bf16 v[112:127], a[228:231], a[204:207], v[112:127]
  v_rcp_f32 v46, v46
  v_exp_f32 v47, v47
  v_cvt_pk_bf16_f32 v54, v44, v45
  s_waitcnt lgkmcnt(2)
  v_mfma_f32_32x32x16_bf16 v[64:79], a[232:235], a[208:211], v[64:79]
  s_waitcnt vmcnt(16)
  ds_read_b64_tr_b16 a[224:225], v10 offset:12288
  ds_read_b64_tr_b16 a[226:227], v10 offset:12800
  v_mul_f32 v46, v142, v46
  v_fma_f32 v47, v47, v30, v30
  v_mfma_f32_32x32x16_bf16 v[80:95], a[232:235], a[212:215], v[80:95]
  ds_read_b64_tr_b16 a[228:229], v11 offset:12288
  ds_read_b64_tr_b16 a[230:231], v11 offset:12800
  v_rcp_f32 v47, v47
  s_waitcnt lgkmcnt(4)
  v_mfma_f32_32x32x16_bf16 v[96:111], a[236:239], a[208:211], v[96:111]
  s_add_u32 m0, s41, 10240
  s_add_u32 s42, s24, 0
  buffer_load_dwordx4 v6, s[8:11], s42 offen lds
  buffer_load_dwordx4 v7, s[8:11], s42 offen offset:1024 lds
  v_mul_f32 v47, v143, v47
  v_mfma_f32_32x32x16_bf16 v[112:127], a[236:239], a[212:215], v[112:127]
  s_waitcnt lgkmcnt(2)
  v_mfma_f32_32x32x16_bf16 v[64:79], a[224:227], a[216:219], v[64:79]
  s_waitcnt vmcnt(16)
  ds_read_b64_tr_b16 a[232:233], v10 offset:14336
  ds_read_b64_tr_b16 a[234:235], v10 offset:14848
  v_cvt_pk_bf16_f32 v55, v46, v47
  ds_write_b128 v18, v[52:55] offset:36864
  s_waitcnt lgkmcnt(0)
  s_barrier
  v_mfma_f32_32x32x16_bf16 v[80:95], a[224:227], a[220:223], v[80:95]
  ds_read_b64_tr_b16 a[236:237], v11 offset:14336
  ds_read_b64_tr_b16 a[238:239], v11 offset:14848
  v_mfma_f32_32x32x16_bf16 v[96:111], a[228:231], a[216:219], v[96:111]
  s_add_u32 m0, s41, 12288
  s_add_u32 s42, s24, 147456
  buffer_load_dwordx4 v6, s[8:11], s42 offen lds
  buffer_load_dwordx4 v7, s[8:11], s42 offen offset:1024 lds
  v_mfma_f32_32x32x16_bf16 v[112:127], a[228:231], a[220:223], v[112:127]
  v_mfma_f32_32x32x16_bf16 v[64:79], a[232:235], v[192:195], v[64:79]
  s_waitcnt vmcnt(16)
  ds_read_b64_tr_b16 a[224:225], v10 offset:16384
  ds_read_b64_tr_b16 a[226:227], v10 offset:16896
  v_mfma_f32_32x32x16_bf16 v[80:95], a[232:235], v[196:199], v[80:95]
  ds_read_b64_tr_b16 a[228:229], v11 offset:16384
  ds_read_b64_tr_b16 a[230:231], v11 offset:16896
  s_waitcnt lgkmcnt(4)
  v_mfma_f32_32x32x16_bf16 v[96:111], a[236:239], v[192:195], v[96:111]
  s_add_u32 m0, s41, 14336
  s_add_u32 s42, s24, 294912
  buffer_load_dwordx4 v6, s[8:11], s42 offen lds
  buffer_load_dwordx4 v7, s[8:11], s42 offen offset:1024 lds
  v_mfma_f32_32x32x16_bf16 v[112:127], a[236:239], v[196:199], v[112:127]
  s_waitcnt lgkmcnt(2)
  v_mfma_f32_32x32x16_bf16 v[64:79], a[224:227], v[200:203], v[64:79]
  s_waitcnt vmcnt(16)
  ds_read_b64_tr_b16 a[232:233], v10 offset:18432
  ds_read_b64_tr_b16 a[234:235], v10 offset:18944
  v_mfma_f32_32x32x16_bf16 v[80:95], a[224:227], v[204:207], v[80:95]
  ds_read_b64_tr_b16 a[236:237], v11 offset:18432
  ds_read_b64_tr_b16 a[238:239], v11 offset:18944
  s_waitcnt lgkmcnt(4)
  v_mfma_f32_32x32x16_bf16 v[96:111], a[228:231], v[200:203], v[96:111]
  s_add_u32 m0, s41, 16384
  s_add_u32 s42, s24, 442368
  buffer_load_dwordx4 v6, s[8:11], s42 offen lds
  buffer_load_dwordx4 v7, s[8:11], s42 offen offset:1024 lds
  v_mfma_f32_32x32x16_bf16 v[112:127], a[228:231], v[204:207], v[112:127]
  s_waitcnt lgkmcnt(2)
  v_mfma_f32_32x32x16_bf16 v[64:79], a[232:235], v[208:211], v[64:79]
  s_waitcnt vmcnt(16)
  ds_read_b64_tr_b16 a[224:225], v10 offset:0
  ds_read_b64_tr_b16 a[226:227], v10 offset:512
  v_mfma_f32_32x32x16_bf16 v[80:95], a[232:235], v[212:215], v[80:95]
  ds_read_b64_tr_b16 a[228:229], v11 offset:0
  ds_read_b64_tr_b16 a[230:231], v11 offset:512
  s_waitcnt lgkmcnt(4)
  v_mfma_f32_32x32x16_bf16 v[96:111], a[236:239], v[208:211], v[96:111]
  s_add_u32 m0, s41, 18432
  s_add_u32 s42, s24, 589824
  buffer_load_dwordx4 v6, s[8:11], s42 offen lds
  buffer_load_dwordx4 v7, s[8:11], s42 offen offset:1024 lds
  v_mfma_f32_32x32x16_bf16 v[112:127], a[236:239], v[212:215], v[112:127]
  s_waitcnt lgkmcnt(2)
  v_mfma_f32_32x32x16_bf16 v[64:79], a[224:227], v[216:219], v[64:79]
  s_waitcnt vmcnt(16)
  ds_read_b64_tr_b16 a[232:233], v10 offset:2048
  ds_read_b64_tr_b16 a[234:235], v10 offset:2560
  v_mfma_f32_32x32x16_bf16 v[80:95], a[224:227], v[220:223], v[80:95]
  ds_read_b64_tr_b16 a[236:237], v11 offset:2048
  ds_read_b64_tr_b16 a[238:239], v11 offset:2560
  s_waitcnt lgkmcnt(4)
  v_mfma_f32_32x32x16_bf16 v[96:111], a[228:231], v[216:219], v[96:111]
  s_add_u32 m0, s41, 0
  s_add_u32 s42, s24, 737280
  buffer_load_dwordx4 v6, s[8:11], s42 offen lds
  buffer_load_dwordx4 v7, s[8:11], s42 offen offset:1024 lds
  v_mfma_f32_32x32x16_bf16 v[112:127], a[228:231], v[220:223], v[112:127]
  s_waitcnt lgkmcnt(2)
  v_mfma_f32_32x32x16_bf16 v[64:79], a[232:235], v[224:227], v[64:79]
  s_waitcnt vmcnt(16)
  ds_read_b64_tr_b16 a[224:225], v10 offset:4096
  ds_read_b64_tr_b16 a[226:227], v10 offset:4608
  v_mfma_f32_32x32x16_bf16 v[80:95], a[232:235], v[228:231], v[80:95]
  ds_read_b64_tr_b16 a[228:229], v11 offset:4096
  ds_read_b64_tr_b16 a[230:231], v11 offset:4608
  s_waitcnt lgkmcnt(4)
  v_mfma_f32_32x32x16_bf16 v[96:111], a[236:239], v[224:227], v[96:111]
  s_add_u32 m0, s41, 2048
  s_add_u32 s42, s24, 884736
  buffer_load_dwordx4 v6, s[8:11], s42 offen lds
  buffer_load_dwordx4 v7, s[8:11], s42 offen offset:1024 lds
  v_mfma_f32_32x32x16_bf16 v[112:127], a[236:239], v[228:231], v[112:127]
  s_waitcnt lgkmcnt(2)
  v_mfma_f32_32x32x16_bf16 v[64:79], a[224:227], v[232:235], v[64:79]
  s_waitcnt vmcnt(16)
  ds_read_b64_tr_b16 a[232:233], v10 offset:6144
  ds_read_b64_tr_b16 a[234:235], v10 offset:6656
  v_mfma_f32_32x32x16_bf16 v[80:95], a[224:227], v[236:239], v[80:95]
  ds_read_b64_tr_b16 a[236:237], v11 offset:6144
  ds_read_b64_tr_b16 a[238:239], v11 offset:6656
  s_waitcnt lgkmcnt(4)
  v_mfma_f32_32x32x16_bf16 v[96:111], a[228:231], v[232:235], v[96:111]
  s_add_u32 m0, s41, 4096
  s_add_u32 s42, s24, 1032192
  buffer_load_dwordx4 v6, s[8:11], s42 offen lds
  buffer_load_dwordx4 v7, s[8:11], s42 offen offset:1024 lds
  v_mfma_f32_32x32x16_bf16 v[112:127], a[228:231], v[236:239], v[112:127]
  s_waitcnt lgkmcnt(2)
  v_mfma_f32_32x32x16_bf16 v[64:79], a[232:235], v[240:243], v[64:79]
  s_waitcnt vmcnt(16)
  ds_read_b64_tr_b16 a[224:225], v10 offset:8192
  ds_read_b64_tr_b16 a[226:227], v10 offset:8704
  v_mfma_f32_32x32x16_bf16 v[80:95], a[232:235], v[244:247], v[80:95]
  ds_read_b64_tr_b16 a[228:229], v11 offset:8192
  ds_read_b64_tr_b16 a[230:231], v11 offset:8704
  s_waitcnt lgkmcnt(4)
  v_mfma_f32_32x32x16_bf16 v[96:111], a[236:239], v[240:243], v[96:111]
  s_add_u32 m0, s41, 6144
  s_add_u32 s42, s24, 1179648
  buffer_load_dwordx4 v6, s[8:11], s42 offen lds
  buffer_load_dwordx4 v7, s[8:11], s42 offen offset:1024 lds
  v_mfma_f32_32x32x16_bf16 v[112:127], a[236:239], v[244:247], v[112:127]
  s_waitcnt lgkmcnt(2)
  v_mfma_f32_32x32x16_bf16 v[64:79], a[224:227], v[248:251], v[64:79]
  s_waitcnt vmcnt(16)
  ds_read_b64_tr_b16 a[232:233], v10 offset:10240
  ds_read_b64_tr_b16 a[234:235], v10 offset:10752
  v_mfma_f32_32x32x16_bf16 v[80:95], a[224:227], v[252:255], v[80:95]
  ds_read_b64_tr_b16 a[236:237], v11 offset:10240
  ds_read_b64_tr_b16 a[238:239], v11 offset:10752
  s_waitcnt lgkmcnt(4)
  v_mfma_f32_32x32x16_bf16 v[96:111], a[228:231], v[248:251], v[96:111]
  s_add_u32 m0, s41, 8192
  s_add_u32 s42, s25, 0
  buffer_load_dwordx4 v6, s[8:11], s42 offen lds
  buffer_load_dwordx4 v7, s[8:11], s42 offen offset:1024 lds
  v_mfma_f32_32x32x16_bf16 v[112:127], a[228:231], v[252:255], v[112:127]
  v_mfma_f32_32x32x16_bf16 v[128:143], a[250:253], v[26:29], 0
  v_mul_f32 v32, v64, v64
  v_mul_f32 v33, v65, v65
  v_mul_f32 v34, v66, v66
  v_fma_f32 v32, v32, v2, v0
  v_fma_f32 v33, v33, v2, v0
  v_fma_f32 v34, v34, v2, v0
  v_mfma_f32_32x32x16_bf16 v[144:159], a[248:251], v[28:31], 0
  v_mul_f32 v32, v64, v32
  v_mul_f32 v33, v65, v33
  v_mul_f32 v34, v66, v34
  v_exp_f32 v32, v32
  v_mul_f32 v35, v67, v67
  v_mfma_f32_32x32x16_bf16 v[160:175], a[252:255], v[26:29], 0
  v_exp_f32 v33, v33
  v_exp_f32 v34, v34
  v_fma_f32 v32, v32, v26, v26
  v_fma_f32 v35, v35, v2, v0
  v_mfma_f32_32x32x16_bf16 v[176:191], a[250:253], v[28:31], 0
  v_rcp_f32 v32, v32
  v_fma_f32 v33, v33, v26, v26
  v_fma_f32 v34, v34, v26, v26
  v_mul_f32 v35, v67, v35
  v_mul_f32 v36, v68, v68
  s_waitcnt lgkmcnt(2)
  v_mfma_f32_32x32x16_bf16 v[128:143], a[232:235], a[0:3], v[128:143]
  s_waitcnt vmcnt(16)
  ds_read_b64_tr_b16 a[224:225], v10 offset:12288
  ds_read_b64_tr_b16 a[226:227], v10 offset:12800
  v_mul_f32 v32, v64, v32
  v_rcp_f32 v33, v33
  v_fma_f32 v36, v36, v2, v0
  v_mfma_f32_32x32x16_bf16 v[144:159], a[232:235], a[4:7], v[144:159]
  ds_read_b64_tr_b16 a[228:229], v11 offset:12288
  ds_read_b64_tr_b16 a[230:231], v11 offset:12800
  v_mul_f32 v33, v65, v33
  v_rcp_f32 v34, v34
  v_mul_f32 v36, v68, v36
  s_waitcnt lgkmcnt(4)
  v_mfma_f32_32x32x16_bf16 v[160:175], a[236:239], a[0:3], v[160:175]
  s_add_u32 m0, s41, 10240
  s_add_u32 s42, s25, 147456
  buffer_load_dwordx4 v6, s[8:11], s42 offen lds
  buffer_load_dwordx4 v7, s[8:11], s42 offen offset:1024 lds
  v_mul_f32 v34, v66, v34
  v_exp_f32 v35, v35
  v_mfma_f32_32x32x16_bf16 v[176:191], a[236:239], a[4:7], v[176:191]
  v_cvt_pk_bf16_f32 v56, v32, v33
  v_exp_f32 v36, v36
  v_mul_f32 v37, v69, v69
  v_fma_f32 v35, v35, v26, v26
  v_mul_f32 v38, v70, v70
  s_waitcnt lgkmcnt(2)
  v_mfma_f32_32x32x16_bf16 v[128:143], a[224:227], a[8:11], v[128:143]
  s_waitcnt vmcnt(16)
  ds_read_b64_tr_b16 a[232:233], v10 offset:14336
  ds_read_b64_tr_b16 a[234:235], v10 offset:14848
  v_rcp_f32 v35, v35
  v_fma_f32 v36, v36, v26, v26
  v_fma_f32 v37, v37, v2, v0
  v_mfma_f32_32x32x16_bf16 v[144:159], a[224:227], a[12:15], v[144:159]
  ds_read_b64_tr_b16 a[236:237], v11 offset:14336
  ds_read_b64_tr_b16 a[238:239], v11 offset:14848
  v_mul_f32 v35, v67, v35
  v_rcp_f32 v36, v36
  v_mul_f32 v37, v69, v37
  s_waitcnt lgkmcnt(4)
  v_mfma_f32_32x32x16_bf16 v[160:175], a[228:231], a[8:11], v[160:175]
  s_add_u32 m0, s41, 12288
  s_add_u32 s42, s25, 294912
  buffer_load_dwordx4 v6, s[8:11], s42 offen lds
  buffer_load_dwordx4 v7, s[8:11], s42 offen offset:1024 lds
  v_cvt_pk_bf16_f32 v57, v34, v35
  v_mul_f32 v36, v68, v36
  v_fma_f32 v38, v38, v2, v0
  v_mfma_f32_32x32x16_bf16 v[176:191], a[228:231], a[12:15], v[176:191]
  v_exp_f32 v37, v37
  v_mul_f32 v38, v70, v38
  v_mul_f32 v39, v71, v71
  v_mul_f32 v40, v72, v72
  v_mul_f32 v41, v73, v73
  s_waitcnt lgkmcnt(2)
  v_mfma_f32_32x32x16_bf16 v[128:143], a[232:235], a[16:19], v[128:143]
  s_waitcnt vmcnt(16)
  ds_read_b64_tr_b16 a[224:225], v10 offset:16384
  ds_read_b64_tr_b16 a[226:227], v10 offset:16896
  v_fma_f32 v37, v37, v26, v26
  v_exp_f32 v38, v38
  v_fma_f32 v39, v39, v2, v0
  v_mfma_f32_32x32x16_bf16 v[144:159], a[232:235], a[20:23], v[144:159]
  ds_read_b64_tr_b16 a[228:229], v11 offset:16384
  ds_read_b64_tr_b16 a[230:231], v11 offset:16896
  v_rcp_f32 v37, v37
  v_fma_f32 v38, v38, v26, v26
  v_mul_f32 v39, v71, v39
  s_waitcnt lgkmcnt(4)
  v_mfma_f32_32x32x16_bf16 v[160:175], a[236:239], a[16:19], v[160:175]
  s_add_u32 m0, s41, 14336
  s_add_u32 s42, s25, 442368
  buffer_load_dwordx4 v6, s[8:11], s42 offen lds
  buffer_load_dwordx4 v7, s[8:11], s42 offen offset:1024 lds
  v_mul_f32 v37, v69, v37
  v_rcp_f32 v38, v38
  v_mfma_f32_32x32x16_bf16 v[176:191], a[236:239], a[20:23], v[176:191]
  v_exp_f32 v39, v39
  v_cvt_pk_bf16_f32 v58, v36, v37
  v_fma_f32 v40, v40, v2, v0
  v_mul_f32 v38, v70, v38
  v_fma_f32 v41, v41, v2, v0
  s_waitcnt lgkmcnt(2)
  v_mfma_f32_32x32x16_bf16 v[128:143], a[224:227], a[24:27], v[128:143]
  s_waitcnt vmcnt(16)
  ds_read_b64_tr_b16 a[232:233], v10 offset:18432
  ds_read_b64_tr_b16 a[234:235], v10 offset:18944
  v_fma_f32 v39, v39, v26, v26
  v_mul_f32 v40, v72, v40
  v_mul_f32 v41, v73, v41
  v_mul_f32 v42, v74, v74
  v_mfma_f32_32x32x16_bf16 v[144:159], a[224:227], a[28:31], v[144:159]
  ds_read_b64_tr_b16 a[236:237], v11 offset:18432
  ds_read_b64_tr_b16 a[238:239], v11 offset:18944
  v_rcp_f32 v39, v39
  v_exp_f32 v40, v40
  s_waitcnt lgkmcnt(4)
  v_mfma_f32_32x32x16_bf16 v[160:175], a[228:231], a[24:27], v[160:175]
  s_add_u32 m0, s41, 16384
  s_add_u32 s42, s25, 589824
  buffer_load_dwordx4 v6, s[8:11], s42 offen lds
  buffer_load_dwordx4 v7, s[8:11], s42 offen offset:1024 lds
  v_mul_f32 v39, v71, v39
  v_fma_f32 v40, v40, v26, v26
  v_fma_f32 v42, v42, v2, v0
  v_mfma_f32_32x32x16_bf16 v[176:191], a[228:231], a[28:31], v[176:191]
  v_cvt_pk_bf16_f32 v59, v38, v39
  ds_write_b128 v23, v[56:59] offset:0
  v_rcp_f32 v40, v40
  v_exp_f32 v41, v41
  s_waitcnt lgkmcnt(3)
  v_mfma_f32_32x32x16_bf16 v[128:143], a[232:235], a[32:35], v[128:143]
  s_waitcnt vmcnt(16)
  ds_read_b64_tr_b16 a[224:225], v10 offset:0
  ds_read_b64_tr_b16 a[226:227], v10 offset:512
  v_mul_f32 v40, v72, v40
  v_fma_f32 v41, v41, v26, v26
  v_mul_f32 v42, v74, v42
  v_mul_f32 v43, v75, v75
  v_mfma_f32_32x32x16_bf16 v[144:159], a[232:235], a[36:39], v[144:159]
  ds_read_b64_tr_b16 a[228:229], v11 offset:0
  ds_read_b64_tr_b16 a[230:231], v11 offset:512
  v_rcp_f32 v41, v41
  v_exp_f32 v42, v42
  s_waitcnt lgkmcnt(5)
  v_mfma_f32_32x32x16_bf16 v[160:175], a[236:239], a[32:35], v[160:175]
  s_add_u32 m0, s41, 18432
  s_add_u32 s42, s25, 737280
  buffer_load_dwordx4 v6, s[8:11], s42 offen lds
  buffer_load_dwordx4 v7, s[8:11], s42 offen offset:1024 lds
  v_mul_f32 v41, v73, v41
  v_fma_f32 v42, v42, v26, v26
  v_fma_f32 v43, v43, v2, v0
  v_mfma_f32_32x32x16_bf16 v[176:191], a[236:239], a[36:39], v[176:191]
  v_rcp_f32 v42, v42
  v_mul_f32 v43, v75, v43
  v_cvt_pk_bf16_f32 v60, v40, v41
  v_mul_f32 v44, v76, v76
  v_mul_f32 v45, v77, v77
  s_waitcnt lgkmcnt(2)
  v_mfma_f32_32x32x16_bf16 v[128:143], a[224:227], a[40:43], v[128:143]
  s_waitcnt vmcnt(16)
  ds_read_b64_tr_b16 a[232:233], v10 offset:2048
  ds_read_b64_tr_b16 a[234:235], v10 offset:2560
  v_mul_f32 v42, v74, v42
  v_exp_f32 v43, v43
  v_fma_f32 v44, v44, v2, v0
  v_mfma_f32_32x32x16_bf16 v[144:159], a[224:227], a[44:47], v[144:159]
  ds_read_b64_tr_b16 a[236:237], v11 offset:2048
  ds_read_b64_tr_b16 a[238:239], v11 offset:2560
  v_fma_f32 v43, v43, v26, v26
  v_mul_f32 v44, v76, v44
  v_fma_f32 v45, v45, v2, v0
  v_mul_f32 v46, v78, v78
  s_waitcnt lgkmcnt(4)
  v_mfma_f32_32x32x16_bf16 v[160:175], a[228:231], a[40:43], v[160:175]
  s_add_u32 m0, s41, 0
  s_add_u32 s42, s25, 884736
  buffer_load_dwordx4 v6, s[8:11], s42 offen lds
  buffer_load_dwordx4 v7, s[8:11], s42 offen offset:1024 lds
  v_rcp_f32 v43, v43
  v_mul_f32 v45, v77, v45
  v_mfma_f32_32x32x16_bf16 v[176:191], a[228:231], a[44:47], v[176:191]
  v_exp_f32 v44, v44
  v_exp_f32 v45, v45
  v_mul_f32 v43, v75, v43
  v_fma_f32 v46, v46, v2, v0
  s_waitcnt lgkmcnt(2)
  v_mfma_f32_32x32x16_bf16 v[128:143], a[232:235], a[48:51], v[128:143]
  s_waitcnt vmcnt(16)
  ds_read_b64_tr_b16 a[224:225], v10 offset:4096
  ds_read_b64_tr_b16 a[226:227], v10 offset:4608
  v_cvt_pk_bf16_f32 v61, v42, v43
  v_fma_f32 v44, v44, v26, v26
  v_fma_f32 v45, v45, v26, v26
  v_mul_f32 v46, v78, v46
  v_mfma_f32_32x32x16_bf16 v[144:159], a[232:235], a[52:55], v[144:159]
  ds_read_b64_tr_b16 a[228:229], v11 offset:4096
  ds_read_b64_tr_b16 a[230:231], v11 offset:4608
  v_rcp_f32 v44, v44
  v_rcp_f32 v45, v45
  s_waitcnt lgkmcnt(4)
  v_mfma_f32_32x32x16_bf16 v[160:175], a[236:239], a[48:51], v[160:175]
  s_add_u32 m0, s41, 2048
  s_add_u32 s42, s25, 1032192
  buffer_load_dwordx4 v6, s[8:11], s42 offen lds
  buffer_load_dwordx4 v7, s[8:11], s42 offen offset:1024 lds
  v_mul_f32 v44, v76, v44
  v_mul_f32 v45, v77, v45
  v_mul_f32 v47, v79, v79
  v_mfma_f32_32x32x16_bf16 v[176:191], a[236:239], a[52:55], v[176:191]
  v_exp_f32 v46, v46
  v_fma_f32 v47, v47, v2, v0
  v_cvt_pk_bf16_f32 v62, v44, v45
  v_mul_f32 v32, v80, v80
  v_mul_f32 v47, v79, v47
  s_waitcnt lgkmcnt(2)
  v_mfma_f32_32x32x16_bf16 v[128:143], a[224:227], a[56:59], v[128:143]
  s_waitcnt vmcnt(16)
  ds_read_b64_tr_b16 a[232:233], v10 offset:6144
  ds_read_b64_tr_b16 a[234:235], v10 offset:6656
  v_fma_f32 v46, v46, v26, v26
  v_exp_f32 v47, v47
  v_fma_f32 v32, v32, v24, v1
  v_mfma_f32_32x32x16_bf16 v[144:159], a[224:227], a[60:63], v[144:159]
  ds_read_b64_tr_b16 a[236:237], v11 offset:6144
  ds_read_b64_tr_b16 a[238:239], v11 offset:6656
  v_rcp_f32 v46, v46
  v_fma_f32 v47, v47, v26, v26
  v_mul_f32 v32, v80, v32
  s_waitcnt lgkmcnt(4)
  v_mfma_f32_32x32x16_bf16 v[160:175], a[228:231], a[56:59], v[160:175]
  s_add_u32 m0, s41, 4096
  s_add_u32 s42, s25, 1179648
  buffer_load_dwordx4 v6, s[8:11], s42 offen lds
  buffer_load_dwordx4 v7, s[8:11], s42 offen offset:1024 lds
  v_mul_f32 v46, v78, v46
  v_rcp_f32 v47, v47
  v_mfma_f32_32x32x16_bf16 v[176:191], a[228:231], a[60:63], v[176:191]
  v_exp_f32 v32, v32
  v_mul_f32 v33, v81, v81
  v_mul_f32 v34, v82, v82
  v_mul_f32 v47, v79, v47
  v_fma_f32 v33, v33, v24, v1
  s_waitcnt lgkmcnt(2)
  v_mfma_f32_32x32x16_bf16 v[128:143], a[232:235], a[64:67], v[128:143]
  s_waitcnt vmcnt(16)
  ds_read_b64_tr_b16 a[224:225], v10 offset:8192
  ds_read_b64_tr_b16 a[226:227], v10 offset:8704
  v_cvt_pk_bf16_f32 v63, v46, v47
  ds_write_b128 v23, v[60:63] offset:1024
  v_fma_f32 v32, v32, v30, v30
  v_mul_f32 v33, v81, v33
  v_mfma_f32_32x32x16_bf16 v[144:159], a[232:235], a[68:71], v[144:159]
  ds_read_b64_tr_b16 a[228:229], v11 offset:8192
  ds_read_b64_tr_b16 a[230:231], v11 offset:8704
  v_rcp_f32 v32, v32
  v_exp_f32 v33, v33
  s_waitcnt lgkmcnt(5)
  v_mfma_f32_32x32x16_bf16 v[160:175], a[236:239], a[64:67], v[160:175]
  s_add_u32 m0, s41, 6144
  s_add_u32 s42, s26, 0
  buffer_load_dwordx4 v6, s[8:11], s42 offen lds
  buffer_load_dwordx4 v7, s[8:11], s42 offen offset:1024 lds
  v_mul_f32 v32, v80, v32
  v_fma_f32 v33, v33, v30, v30
  v_fma_f32 v34, v34, v24, v1
  v_mfma_f32_32x32x16_bf16 v[176:191], a[236:239], a[68:71], v[176:191]
  v_rcp_f32 v33, v33
  v_mul_f32 v34, v82, v34
  v_mul_f32 v35, v83, v83
  v_mul_f32 v36, v84, v84
  v_mul_f32 v37, v85, v85
  s_waitcnt lgkmcnt(3)
  v_mfma_f32_32x32x16_bf16 v[128:143], a[224:227], a[72:75], v[128:143]
  s_waitcnt vmcnt(16)
  ds_read_b64_tr_b16 a[232:233], v10 offset:10240
  ds_read_b64_tr_b16 a[234:235], v10 offset:10752
  v_mul_f32 v33, v81, v33
  v_exp_f32 v34, v34
  v_fma_f32 v35, v35, v24, v1
  v_mfma_f32_32x32x16_bf16 v[144:159], a[224:227], a[76:79], v[144:159]
  ds_read_b64_tr_b16 a[236:237], v11 offset:10240
  ds_read_b64_tr_b16 a[238:239], v11 offset:10752
  v_fma_f32 v34, v34, v30, v30
  v_mul_f32 v35, v83, v35
  v_cvt_pk_bf16_f32 v48, v32, v33
  v_fma_f32 v36, v36, v24, v1
  s_waitcnt lgkmcnt(4)
  v_mfma_f32_32x32x16_bf16 v[160:175], a[228:231], a[72:75], v[160:175]
  s_add_u32 m0, s41, 8192
  s_add_u32 s42, s26, 147456
  buffer_load_dwordx4 v6, s[8:11], s42 offen lds
  buffer_load_dwordx4 v7, s[8:11], s42 offen offset:1024 lds
  v_rcp_f32 v34, v34
  v_mul_f32 v36, v84, v36
  v_mfma_f32_32x32x16_bf16 v[176:191], a[228:231], a[76:79], v[176:191]
  v_exp_f32 v35, v35
  v_exp_f32 v36, v36
  v_mul_f32 v34, v82, v34
  v_fma_f32 v37, v37, v24, v1
  s_waitcnt lgkmcnt(2)
  v_mfma_f32_32x32x16_bf16 v[128:143], a[232:235], a[80:83], v[128:143]
  s_waitcnt vmcnt(16)
  ds_read_b64_tr_b16 a[224:225], v10 offset:12288
  ds_read_b64_tr_b16 a[226:227], v10 offset:12800
  v_fma_f32 v35, v35, v30, v30
  v_fma_f32 v36, v36, v30, v30
  v_mul_f32 v37, v85, v37
  v_mul_f32 v38, v86, v86
  v_mfma_f32_32x32x16_bf16 v[144:159], a[232:235], a[84:87], v[144:159]
  ds_read_b64_tr_b16 a[228:229], v11 offset:12288
  ds_read_b64_tr_b16 a[230:231], v11 offset:12800
  v_rcp_f32 v35, v35
  v_rcp_f32 v36, v36
  s_waitcnt lgkmcnt(4)
  v_mfma_f32_32x32x16_bf16 v[160:175], a[236:239], a[80:83], v[160:175]
  s_add_u32 m0, s41, 10240
  s_add_u32 s42, s26, 294912
  buffer_load_dwordx4 v6, s[8:11], s42 offen lds
  buffer_load_dwordx4 v7, s[8:11], s42 offen offset:1024 lds
  v_mul_f32 v35, v83, v35
  v_mul_f32 v36, v84, v36
  v_fma_f32 v38, v38, v24, v1
  v_mfma_f32_32x32x16_bf16 v[176:191], a[236:239], a[84:87], v[176:191]
  v_cvt_pk_bf16_f32 v49, v34, v35
  v_exp_f32 v37, v37
  v_mul_f32 v38, v86, v38
  v_mul_f32 v39, v87, v87
  v_mul_f32 v40, v88, v88
  s_waitcnt lgkmcnt(2)
  v_mfma_f32_32x32x16_bf16 v[128:143], a[224:227], a[88:91], v[128:143]
  s_waitcnt vmcnt(16)
  ds_read_b64_tr_b16 a[232:233], v10 offset:14336
  ds_read_b64_tr_b16 a[234:235], v10 offset:14848
  v_fma_f32 v37, v37, v30, v30
  v_exp_f32 v38, v38
  v_fma_f32 v39, v39, v24, v1
  v_mfma_f32_32x32x16_bf16 v[144:159], a[224:227], a[92:95], v[144:159]
  ds_read_b64_tr_b16 a[236:237], v11 offset:14336
  ds_read_b64_tr_b16 a[238:239], v11 offset:14848
  v_rcp_f32 v37, v37
  v_fma_f32 v38, v38, v30, v30
  v_mul_f32 v39, v87, v39
  s_waitcnt lgkmcnt(4)
  v_mfma_f32_32x32x16_bf16 v[160:175], a[228:231], a[88:91], v[160:175]
  s_add_u32 m0, s41, 12288
  s_add_u32 s42, s26, 442368
  buffer_load_dwordx4 v6, s[8:11], s42 offen lds
  buffer_load_dwordx4 v7, s[8:11], s42 offen offset:1024 lds
  v_mul_f32 v37, v85, v37
  v_rcp_f32 v38, v38
  v_mfma_f32_32x32x16_bf16 v[176:191], a[228:231], a[92:95], v[176:191]
  v_exp_f32 v39, v39
  v_cvt_pk_bf16_f32 v50, v36, v37
  v_fma_f32 v40, v40, v24, v1
  v_mul_f32 v38, v86, v38
  v_mul_f32 v41, v89, v89
  s_waitcnt lgkmcnt(2)
  v_mfma_f32_32x32x16_bf16 v[128:143], a[232:235], a[96:99], v[128:143]
  s_waitcnt vmcnt(16)
  ds_read_b64_tr_b16 a[224:225], v10 offset:16384
  ds_read_b64_tr_b16 a[226:227], v10 offset:16896
  v_fma_f32 v39, v39, v30, v30
  v_mul_f32 v40, v88, v40
  v_fma_f32 v41, v41, v24, v1
  v_mul_f32 v42, v90, v90
  v_mfma_f32_32x32x16_bf16 v[144:159], a[232:235], a[100:103], v[144:159]
  ds_read_b64_tr_b16 a[228:229], v11 offset:16384
  ds_read_b64_tr_b16 a[230:231], v11 offset:16896
  v_rcp_f32 v39, v39
  v_exp_f32 v40, v40
  s_waitcnt lgkmcnt(4)
  v_mfma_f32_32x32x16_bf16 v[160:175], a[236:239], a[96:99], v[160:175]
  s_add_u32 m0, s41, 14336
  s_add_u32 s42, s26, 589824
  buffer_load_dwordx4 v6, s[8:11], s42 offen lds
  buffer_load_dwordx4 v7, s[8:11], s42 offen offset:1024 lds
  v_mul_f32 v39, v87, v39
  v_fma_f32 v40, v40, v30, v30
  v_mul_f32 v41, v89, v41
  v_mfma_f32_32x32x16_bf16 v[176:191], a[236:239], a[100:103], v[176:191]
  v_cvt_pk_bf16_f32 v51, v38, v39
  ds_write_b128 v23, v[48:51] offset:36864
  v_rcp_f32 v40, v40
  v_exp_f32 v41, v41
  s_waitcnt lgkmcnt(3)
  v_mfma_f32_32x32x16_bf16 v[128:143], a[224:227], a[104:107], v[128:143]
  s_waitcnt vmcnt(16)
  ds_read_b64_tr_b16 a[232:233], v10 offset:18432
  ds_read_b64_tr_b16 a[234:235], v10 offset:18944
  v_mul_f32 v40, v88, v40
  v_fma_f32 v41, v41, v30, v30
  v_fma_f32 v42, v42, v24, v1
  v_mul_f32 v43, v91, v91
  v_mfma_f32_32x32x16_bf16 v[144:159], a[224:227], a[108:111], v[144:159]
  ds_read_b64_tr_b16 a[236:237], v11 offset:18432
  ds_read_b64_tr_b16 a[238:239], v11 offset:18944
  v_rcp_f32 v41, v41
  v_mul_f32 v42, v90, v42
  v_fma_f32 v43, v43, v24, v1
  s_waitcnt lgkmcnt(5)
  v_mfma_f32_32x32x16_bf16 v[160:175], a[228:231], a[104:107], v[160:175]
  s_add_u32 m0, s41, 16384
  s_add_u32 s42, s26, 737280
  buffer_load_dwordx4 v6, s[8:11], s42 offen lds
  buffer_load_dwordx4 v7, s[8:11], s42 offen offset:1024 lds
  v_mul_f32 v41, v89, v41
  v_exp_f32 v42, v42
  v_mfma_f32_32x32x16_bf16 v[176:191], a[228:231], a[108:111], v[176:191]
  v_mul_f32 v43, v91, v43
  v_cvt_pk_bf16_f32 v52, v40, v41
  v_mul_f32 v44, v92, v92
  v_fma_f32 v42, v42, v30, v30
  v_exp_f32 v43, v43
  s_waitcnt lgkmcnt(2)
  v_mfma_f32_32x32x16_bf16 v[128:143], a[232:235], a[112:115], v[128:143]
  s_waitcnt vmcnt(16)
  ds_read_b64_tr_b16 a[224:225], v10 offset:0
  ds_read_b64_tr_b16 a[226:227], v10 offset:512
  v_rcp_f32 v42, v42
  v_fma_f32 v43, v43, v30, v30
  v_fma_f32 v44, v44, v24, v1
  v_mfma_f32_32x32x16_bf16 v[144:159], a[232:235], a[116:119], v[144:159]
  ds_read_b64_tr_b16 a[228:229], v11 offset:0
  ds_read_b64_tr_b16 a[230:231], v11 offset:512
  v_mul_f32 v42, v90, v42
  v_rcp_f32 v43, v43
  v_mul_f32 v44, v92, v44
  s_waitcnt lgkmcnt(4)
  v_mfma_f32_32x32x16_bf16 v[160:175], a[236:239], a[112:115], v[160:175]
  s_add_u32 m0, s41, 18432
  s_add_u32 s42, s26, 884736
  buffer_load_dwordx4 v6, s[8:11], s42 offen lds
  buffer_load_dwordx4 v7, s[8:11], s42 offen offset:1024 lds
  v_mul_f32 v43, v91, v43
  v_exp_f32 v44, v44
  v_mfma_f32_32x32x16_bf16 v[176:191], a[236:239], a[116:119], v[176:191]
  v_cvt_pk_bf16_f32 v53, v42, v43
  v_mul_f32 v45, v93, v93
  v_mul_f32 v46, v94, v94
  v_fma_f32 v44, v44, v30, v30
  v_fma_f32 v45, v45, v24, v1
  v_fma_f32 v46, v46, v24, v1
  s_waitcnt lgkmcnt(2)
  v_mfma_f32_32x32x16_bf16 v[128:143], a[224:227], a[120:123], v[128:143]
  s_waitcnt vmcnt(16)
  ds_read_b64_tr_b16 a[232:233], v10 offset:2048
  ds_read_b64_tr_b16 a[234:235], v10 offset:2560
  v_rcp_f32 v44, v44
  v_mul_f32 v45, v93, v45
  v_mul_f32 v46, v94, v46
  v_mfma_f32_32x32x16_bf16 v[144:159], a[224:227], a[124:127], v[144:159]
  ds_read_b64_tr_b16 a[236:237], v11 offset:2048
  ds_read_b64_tr_b16 a[238:239], v11 offset:2560
  v_mul_f32 v44, v92, v44
  v_exp_f32 v45, v45
  v_mul_f32 v47, v95, v95
  s_waitcnt lgkmcnt(4)
  v_mfma_f32_32x32x16_bf16 v[160:175], a[228:231], a[120:123], v[160:175]
  s_add_u32 m0, s41, 0
  s_add_u32 s42, s26, 1032192
  buffer_load_dwordx4 v6, s[8:11], s42 offen lds
  buffer_load_dwordx4 v7, s[8:11], s42 offen offset:1024 lds
  v_fma_f32 v45, v45, v30, v30
  v_exp_f32 v46, v46
  v_mfma_f32_32x32x16_bf16 v[176:191], a[228:231], a[124:127], v[176:191]
  v_rcp_f32 v45, v45
  v_fma_f32 v47, v47, v24, v1
  v_mul_f32 v32, v96, v96
  v_fma_f32 v46, v46, v30, v30
  v_mul_f32 v47, v95, v47
  s_waitcnt lgkmcnt(2)
  v_mfma_f32_32x32x16_bf16 v[128:143], a[232:235], a[128:131], v[128:143]
  s_waitcnt vmcnt(16)
  ds_read_b64_tr_b16 a[224:225], v10 offset:4096
  ds_read_b64_tr_b16 a[226:227], v10 offset:4608
  v_mul_f32 v45, v93, v45
  v_rcp_f32 v46, v46
  v_fma_f32 v32, v32, v2, v0
  v_mfma_f32_32x32x16_bf16 v[144:159], a[232:235], a[132:135], v[144:159]
  ds_read_b64_tr_b16 a[228:229], v11 offset:4096
  ds_read_b64_tr_b16 a[230:231], v11 offset:4608
  v_mul_f32 v46, v94, v46
  v_exp_f32 v47, v47
  v_cvt_pk_bf16_f32 v54, v44, v45
  s_waitcnt lgkmcnt(4)
  v_mfma_f32_32x32x16_bf16 v[160:175], a[236:239], a[128:131], v[160:175]
  s_add_u32 m0, s41, 2048
  s_add_u32 s42, s26, 1179648
  buffer_load_dwordx4 v6, s[8:11], s42 offen lds
  buffer_load_dwordx4 v7, s[8:11], s42 offen offset:1024 lds
  v_fma_f32 v47, v47, v30, v30
  v_mul_f32 v32, v96, v32
  v_mul_f32 v33, v97, v97
  v_mfma_f32_32x32x16_bf16 v[176:191], a[236:239], a[132:135], v[176:191]
  v_rcp_f32 v47, v47
  v_exp_f32 v32, v32
  v_fma_f32 v33, v33, v2, v0
  v_mul_f32 v34, v98, v98
  s_waitcnt lgkmcnt(2)
  v_mfma_f32_32x32x16_bf16 v[128:143], a[224:227], a[136:139], v[128:143]
  s_waitcnt vmcnt(16)
  ds_read_b64_tr_b16 a[232:233], v10 offset:6144
  ds_read_b64_tr_b16 a[234:235], v10 offset:6656
  v_mul_f32 v47, v95, v47
  v_fma_f32 v32, v32, v26, v26
  v_mul_f32 v33, v97, v33
  v_cvt_pk_bf16_f32 v55, v46, v47
  v_mfma_f32_32x32x16_bf16 v[144:159], a[224:227], a[140:143], v[144:159]
  ds_read_b64_tr_b16 a[236:237], v11 offset:6144
  ds_read_b64_tr_b16 a[238:239], v11 offset:6656
  ds_write_b128 v23, v[52:55] offset:37888
  v_rcp_f32 v32, v32
  v_fma_f32 v34, v34, v2, v0
  s_waitcnt lgkmcnt(5)
  v_mfma_f32_32x32x16_bf16 v[160:175], a[228:231], a[136:139], v[160:175]
  s_add_u32 m0, s41, 4096
  s_add_u32 s42, s27, 0
  buffer_load_dwordx4 v6, s[8:11], s42 offen lds
  buffer_load_dwordx4 v7, s[8:11], s42 offen offset:1024 lds
  v_mul_f32 v32, v96, v32
  v_exp_f32 v33, v33
  v_mfma_f32_32x32x16_bf16 v[176:191], a[228:231], a[140:143], v[176:191]
  v_mul_f32 v34, v98, v34
  v_mul_f32 v35, v99, v99
  v_mul_f32 v36, v100, v100
  v_fma_f32 v33, v33, v26, v26
  v_exp_f32 v34, v34
  s_waitcnt lgkmcnt(3)
  v_mfma_f32_32x32x16_bf16 v[128:143], a[232:235], a[144:147], v[128:143]
  s_waitcnt vmcnt(16)
  ds_read_b64_tr_b16 a[224:225], v10 offset:8192
  ds_read_b64_tr_b16 a[226:227], v10 offset:8704
  v_rcp_f32 v33, v33
  v_fma_f32 v34, v34, v26, v26
  v_fma_f32 v35, v35, v2, v0
  v_mfma_f32_32x32x16_bf16 v[144:159], a[232:235], a[148:151], v[144:159]
  ds_read_b64_tr_b16 a[228:229], v11 offset:8192
  ds_read_b64_tr_b16 a[230:231], v11 offset:8704
  v_mul_f32 v33, v97, v33
  v_rcp_f32 v34, v34
  v_mul_f32 v35, v99, v35
  s_waitcnt lgkmcnt(5)
  v_mfma_f32_32x32x16_bf16 v[160:175], a[236:239], a[144:147], v[160:175]
  s_add_u32 m0, s41, 6144
  s_add_u32 s42, s27, 147456
  buffer_load_dwordx4 v6, s[8:11], s42 offen lds
  buffer_load_dwordx4 v7, s[8:11], s42 offen offset:1024 lds
  v_mul_f32 v34, v98, v34
  v_exp_f32 v35, v35
  v_mfma_f32_32x32x16_bf16 v[176:191], a[236:239], a[148:151], v[176:191]
  v_cvt_pk_bf16_f32 v56, v32, v33
  v_fma_f32 v36, v36, v2, v0
  v_mul_f32 v37, v101, v101
  v_fma_f32 v35, v35, v26, v26
  v_mul_f32 v36, v100, v36
  v_fma_f32 v37, v37, v2, v0
  s_waitcnt lgkmcnt(2)
  v_mfma_f32_32x32x16_bf16 v[128:143], a[224:227], a[152:155], v[128:143]
  s_waitcnt vmcnt(16)
  ds_read_b64_tr_b16 a[232:233], v10 offset:10240
  ds_read_b64_tr_b16 a[234:235], v10 offset:10752
  v_rcp_f32 v35, v35
  v_exp_f32 v36, v36
  v_mfma_f32_32x32x16_bf16 v[144:159], a[224:227], a[156:159], v[144:159]
  ds_read_b64_tr_b16 a[236:237], v11 offset:10240
  ds_read_b64_tr_b16 a[238:239], v11 offset:10752
  v_mul_f32 v35, v99, v35
  v_fma_f32 v36, v36, v26, v26
  v_mul_f32 v37, v101, v37
  v_cvt_pk_bf16_f32 v57, v34, v35
  s_waitcnt lgkmcnt(4)
  v_mfma_f32_32x32x16_bf16 v[160:175], a[228:231], a[152:155], v[160:175]
  s_add_u32 m0, s41, 8192
  s_add_u32 s42, s27, 294912
  buffer_load_dwordx4 v6, s[8:11], s42 offen lds
  buffer_load_dwordx4 v7, s[8:11], s42 offen offset:1024 lds
  v_rcp_f32 v36, v36
  v_mul_f32 v38, v102, v102
  v_mfma_f32_32x32x16_bf16 v[176:191], a[228:231], a[156:159], v[176:191]
  v_exp_f32 v37, v37
  v_fma_f32 v38, v38, v2, v0
  v_mul_f32 v36, v100, v36
  v_mul_f32 v39, v103, v103
  v_mul_f32 v38, v102, v38
  s_waitcnt lgkmcnt(2)
  v_mfma_f32_32x32x16_bf16 v[128:143], a[232:235], a[160:163], v[128:143]
  s_waitcnt vmcnt(16)
  ds_read_b64_tr_b16 a[224:225], v10 offset:12288
  ds_read_b64_tr_b16 a[226:227], v10 offset:12800
  v_fma_f32 v37, v37, v26, v26
  v_exp_f32 v38, v38
  v_fma_f32 v39, v39, v2, v0
  v_mfma_f32_32x32x16_bf16 v[144:159], a[232:235], a[164:167], v[144:159]
  ds_read_b64_tr_b16 a[228:229], v11 offset:12288
  ds_read_b64_tr_b16 a[230:231], v11 offset:12800
  v_rcp_f32 v37, v37
  v_fma_f32 v38, v38, v26, v26
  v_mul_f32 v39, v103, v39
  s_waitcnt lgkmcnt(4)
  v_mfma_f32_32x32x16_bf16 v[160:175], a[236:239], a[160:163], v[160:175]
  s_add_u32 m0, s41, 10240
  s_add_u32 s42, s27, 442368
  buffer_load_dwordx4 v6, s[8:11], s42 offen lds
  buffer_load_dwordx4 v7, s[8:11], s42 offen offset:1024 lds
  v_mul_f32 v37, v101, v37
  v_rcp_f32 v38, v38
  v_mfma_f32_32x32x16_bf16 v[176:191], a[236:239], a[164:167], v[176:191]
  v_exp_f32 v39, v39
  v_cvt_pk_bf16_f32 v58, v36, v37
  v_mul_f32 v40, v104, v104
  v_mul_f32 v38, v102, v38
  v_mul_f32 v41, v105, v105
  s_waitcnt lgkmcnt(2)
  v_mfma_f32_32x32x16_bf16 v[128:143], a[224:227], a[168:171], v[128:143]
  s_waitcnt vmcnt(16)
  ds_read_b64_tr_b16 a[232:233], v10 offset:14336
  ds_read_b64_tr_b16 a[234:235], v10 offset:14848
  v_fma_f32 v39, v39, v26, v26
  v_fma_f32 v40, v40, v2, v0
  v_fma_f32 v41, v41, v2, v0
  v_mul_f32 v42, v106, v106
  v_mfma_f32_32x32x16_bf16 v[144:159], a[224:227], a[172:175], v[144:159]
  ds_read_b64_tr_b16 a[236:237], v11 offset:14336
  ds_read_b64_tr_b16 a[238:239], v11 offset:14848
  v_rcp_f32 v39, v39
  v_mul_f32 v40, v104, v40
  v_mul_f32 v41, v105, v41
  s_waitcnt lgkmcnt(4)
  v_mfma_f32_32x32x16_bf16 v[160:175], a[228:231], a[168:171], v[160:175]
  s_add_u32 m0, s41, 12288
  s_add_u32 s42, s27, 589824
  buffer_load_dwordx4 v6, s[8:11], s42 offen lds
  buffer_load_dwordx4 v7, s[8:11], s42 offen offset:1024 lds
  v_mul_f32 v39, v103, v39
  v_exp_f32 v40, v40
  v_mfma_f32_32x32x16_bf16 v[176:191], a[228:231], a[172:175], v[176:191]
  v_cvt_pk_bf16_f32 v59, v38, v39
  ds_write_b128 v23, v[56:59] offset:2048
  v_exp_f32 v41, v41
  v_fma_f32 v40, v40, v26, v26
  v_fma_f32 v42, v42, v2, v0
  s_waitcnt lgkmcnt(3)
  v_mfma_f32_32x32x16_bf16 v[128:143], a[232:235], a[176:179], v[128:143]
  s_waitcnt vmcnt(16)
  ds_read_b64_tr_b16 a[224:225], v10 offset:16384
  ds_read_b64_tr_b16 a[226:227], v10 offset:16896
  v_rcp_f32 v40, v40
  v_fma_f32 v41, v41, v26, v26
  v_mul_f32 v42, v106, v42
  v_mfma_f32_32x32x16_bf16 v[144:159], a[232:235], a[180:183], v[144:159]
  ds_read_b64_tr_b16 a[228:229], v11 offset:16384
  ds_read_b64_tr_b16 a[230:231], v11 offset:16896
  v_mul_f32 v40, v104, v40
  v_rcp_f32 v41, v41
  v_mul_f32 v43, v107, v107
  s_waitcnt lgkmcnt(5)
  v_mfma_f32_32x32x16_bf16 v[160:175], a[236:239], a[176:179], v[160:175]
  s_add_u32 m0, s41, 14336
  s_add_u32 s42, s27, 737280
  buffer_load_dwordx4 v6, s[8:11], s42 offen lds
  buffer_load_dwordx4 v7, s[8:11], s42 offen offset:1024 lds
  v_mul_f32 v41, v105, v41
  v_exp_f32 v42, v42
  v_mfma_f32_32x32x16_bf16 v[176:191], a[236:239], a[180:183], v[176:191]
  v_fma_f32 v43, v43, v2, v0
  v_cvt_pk_bf16_f32 v60, v40, v41
  v_mul_f32 v44, v108, v108
  v_fma_f32 v42, v42, v26, v26
  v_mul_f32 v43, v107, v43
  v_fma_f32 v44, v44, v2, v0
  s_waitcnt lgkmcnt(2)
  v_mfma_f32_32x32x16_bf16 v[128:143], a[224:227], a[184:187], v[128:143]
  s_waitcnt vmcnt(16)
  ds_read_b64_tr_b16 a[232:233], v10 offset:18432
  ds_read_b64_tr_b16 a[234:235], v10 offset:18944
  v_rcp_f32 v42, v42
  v_exp_f32 v43, v43
  v_mfma_f32_32x32x16_bf16 v[144:159], a[224:227], a[188:191], v[144:159]
  ds_read_b64_tr_b16 a[236:237], v11 offset:18432
  ds_read_b64_tr_b16 a[238:239], v11 offset:18944
  v_mul_f32 v42, v106, v42
  v_fma_f32 v43, v43, v26, v26
  v_mul_f32 v44, v108, v44
  v_mul_f32 v45, v109, v109
  s_waitcnt lgkmcnt(4)
  v_mfma_f32_32x32x16_bf16 v[160:175], a[228:231], a[184:187], v[160:175]
  s_add_u32 m0, s41, 16384
  s_add_u32 s42, s27, 884736
  buffer_load_dwordx4 v6, s[8:11], s42 offen lds
  buffer_load_dwordx4 v7, s[8:11], s42 offen offset:1024 lds
  v_rcp_f32 v43, v43
  v_fma_f32 v45, v45, v2, v0
  v_mfma_f32_32x32x16_bf16 v[176:191], a[228:231], a[188:191], v[176:191]
  v_exp_f32 v44, v44
  v_mul_f32 v45, v109, v45
  v_mul_f32 v43, v107, v43
  v_mul_f32 v46, v110, v110
  v_mul_f32 v47, v111, v111
  s_waitcnt lgkmcnt(2)
  v_mfma_f32_32x32x16_bf16 v[128:143], a[232:235], a[192:195], v[128:143]
  s_waitcnt vmcnt(16)
  ds_read_b64_tr_b16 a[224:225], v10 offset:0
  ds_read_b64_tr_b16 a[226:227], v10 offset:512
  v_cvt_pk_bf16_f32 v61, v42, v43
  v_fma_f32 v44, v44, v26, v26
  v_exp_f32 v45, v45
  v_mfma_f32_32x32x16_bf16 v[144:159], a[232:235], a[196:199], v[144:159]
  ds_read_b64_tr_b16 a[228:229], v11 offset:0
  ds_read_b64_tr_b16 a[230:231], v11 offset:512
  v_rcp_f32 v44, v44
  v_fma_f32 v45, v45, v26, v26
  v_fma_f32 v46, v46, v2, v0
  s_waitcnt lgkmcnt(4)
  v_mfma_f32_32x32x16_bf16 v[160:175], a[236:239], a[192:195], v[160:175]
  s_add_u32 m0, s41, 18432
  s_add_u32 s42, s27, 1032192
  buffer_load_dwordx4 v6, s[8:11], s42 offen lds
  buffer_load_dwordx4 v7, s[8:11], s42 offen offset:1024 lds
  v_mul_f32 v44, v108, v44
  v_rcp_f32 v45, v45
  v_mfma_f32_32x32x16_bf16 v[176:191], a[236:239], a[196:199], v[176:191]
  v_mul_f32 v46, v110, v46
  v_fma_f32 v47, v47, v2, v0
  v_mul_f32 v32, v112, v112
  v_mul_f32 v45, v109, v45
  v_exp_f32 v46, v46
  s_waitcnt lgkmcnt(2)
  v_mfma_f32_32x32x16_bf16 v[128:143], a[224:227], a[200:203], v[128:143]
  s_waitcnt vmcnt(16)
  ds_read_b64_tr_b16 a[232:233], v10 offset:2048
  ds_read_b64_tr_b16 a[234:235], v10 offset:2560
  v_fma_f32 v46, v46, v26, v26
  v_mul_f32 v47, v111, v47
  v_cvt_pk_bf16_f32 v62, v44, v45
  v_fma_f32 v32, v32, v24, v1
  v_mfma_f32_32x32x16_bf16 v[144:159], a[224:227], a[204:207], v[144:159]
  ds_read_b64_tr_b16 a[236:237], v11 offset:2048
  ds_read_b64_tr_b16 a[238:239], v11 offset:2560
  v_rcp_f32 v46, v46
  v_exp_f32 v47, v47
  s_waitcnt lgkmcnt(4)
  v_mfma_f32_32x32x16_bf16 v[160:175], a[228:231], a[200:203], v[160:175]
  s_add_u32 m0, s41, 0
  s_add_u32 s42, s27, 1179648
  buffer_load_dwordx4 v6, s[8:11], s42 offen lds
  buffer_load_dwordx4 v7, s[8:11], s42 offen offset:1024 lds
  v_mul_f32 v46, v110, v46
  v_fma_f32 v47, v47, v26, v26
  v_mul_f32 v32, v112, v32
  v_mfma_f32_32x32x16_bf16 v[176:191], a[228:231], a[204:207], v[176:191]
  v_rcp_f32 v47, v47
  v_exp_f32 v32, v32
  v_mul_f32 v33, v113, v113
  v_mul_f32 v34, v114, v114
  s_waitcnt lgkmcnt(2)
  v_mfma_f32_32x32x16_bf16 v[128:143], a[232:235], a[208:211], v[128:143]
  s_waitcnt vmcnt(16)
  ds_read_b64_tr_b16 a[224:225], v10 offset:4096
  ds_read_b64_tr_b16 a[226:227], v10 offset:4608
  v_mul_f32 v47, v111, v47
  v_fma_f32 v32, v32, v30, v30
  v_fma_f32 v33, v33, v24, v1
  v_cvt_pk_bf16_f32 v63, v46, v47
  v_mfma_f32_32x32x16_bf16 v[144:159], a[232:235], a[212:215], v[144:159]
  ds_read_b64_tr_b16 a[228:229], v11 offset:4096
  ds_read_b64_tr_b16 a[230:231], v11 offset:4608
  ds_write_b128 v23, v[60:63] offset:3072
  v_rcp_f32 v32, v32
  v_mul_f32 v33, v113, v33
  s_waitcnt lgkmcnt(5)
  v_mfma_f32_32x32x16_bf16 v[160:175], a[236:239], a[208:211], v[160:175]
  s_add_u32 m0, s41, 2048
  s_add_u32 s42, s28, 0
  buffer_load_dwordx4 v8, s[12:15], s42 offen lds
  buffer_load_dwordx4 v9, s[12:15], s42 offen offset:1024 lds
  v_mul_f32 v32, v112, v32
  v_exp_f32 v33, v33
  v_mfma_f32_32x32x16_bf16 v[176:191], a[236:239], a[212:215], v[176:191]
  v_fma_f32 v34, v34, v24, v1
  v_mul_f32 v35, v115, v115
  v_mul_f32 v36, v116, v116
  v_fma_f32 v33, v33, v30, v30
  v_mul_f32 v34, v114, v34
  v_fma_f32 v35, v35, v24, v1
  s_waitcnt lgkmcnt(3)
  v_mfma_f32_32x32x16_bf16 v[128:143], a[224:227], a[216:219], v[128:143]
  s_waitcnt vmcnt(16)
  ds_read_b64_tr_b16 a[232:233], v10 offset:6144
  ds_read_b64_tr_b16 a[234:235], v10 offset:6656
  v_rcp_f32 v33, v33
  v_exp_f32 v34, v34
  v_mfma_f32_32x32x16_bf16 v[144:159], a[224:227], a[220:223], v[144:159]
  ds_read_b64_tr_b16 a[236:237], v11 offset:6144
  ds_read_b64_tr_b16 a[238:239], v11 offset:6656
  v_mul_f32 v33, v113, v33
  v_fma_f32 v34, v34, v30, v30
  v_mul_f32 v35, v115, v35
  v_cvt_pk_bf16_f32 v48, v32, v33
  s_waitcnt lgkmcnt(5)
  v_mfma_f32_32x32x16_bf16 v[160:175], a[228:231], a[216:219], v[160:175]
  s_add_u32 m0, s41, 4096
  s_add_u32 s42, s28, 18432
  buffer_load_dwordx4 v8, s[12:15], s42 offen lds
  buffer_load_dwordx4 v9, s[12:15], s42 offen offset:1024 lds
  v_rcp_f32 v34, v34
  v_fma_f32 v36, v36, v24, v1
  v_mfma_f32_32x32x16_bf16 v[176:191], a[228:231], a[220:223], v[176:191]
  v_exp_f32 v35, v35
  v_mul_f32 v36, v116, v36
  v_mul_f32 v34, v114, v34
  v_mul_f32 v37, v117, v117
  v_mul_f32 v38, v118, v118
  s_waitcnt lgkmcnt(2)
  v_mfma_f32_32x32x16_bf16 v[128:143], a[232:235], v[192:195], v[128:143]
  s_waitcnt vmcnt(16)
  ds_read_b64_tr_b16 a[224:225], v10 offset:8192
  ds_read_b64_tr_b16 a[226:227], v10 offset:8704
  v_fma_f32 v35, v35, v30, v30
  v_exp_f32 v36, v36
  v_fma_f32 v37, v37, v24, v1
  v_mfma_f32_32x32x16_bf16 v[144:159], a[232:235], v[196:199], v[144:159]
  ds_read_b64_tr_b16 a[228:229], v11 offset:8192
  ds_read_b64_tr_b16 a[230:231], v11 offset:8704
  v_rcp_f32 v35, v35
  v_fma_f32 v36, v36, v30, v30
  v_mul_f32 v37, v117, v37
  s_waitcnt lgkmcnt(4)
  v_mfma_f32_32x32x16_bf16 v[160:175], a[236:239], v[192:195], v[160:175]
  s_add_u32 m0, s41, 6144
  s_add_u32 s42, s28, 36864
  buffer_load_dwordx4 v8, s[12:15], s42 offen lds
  buffer_load_dwordx4 v9, s[12:15], s42 offen offset:1024 lds
  v_mul_f32 v35, v115, v35
  v_rcp_f32 v36, v36
  v_mfma_f32_32x32x16_bf16 v[176:191], a[236:239], v[196:199], v[176:191]
  v_cvt_pk_bf16_f32 v49, v34, v35
  v_exp_f32 v37, v37
  v_fma_f32 v38, v38, v24, v1
  v_mul_f32 v36, v116, v36
  v_mul_f32 v39, v119, v119
  s_waitcnt lgkmcnt(2)
  v_mfma_f32_32x32x16_bf16 v[128:143], a[224:227], v[200:203], v[128:143]
  s_waitcnt vmcnt(16)
  ds_read_b64_tr_b16 a[232:233], v10 offset:10240
  ds_read_b64_tr_b16 a[234:235], v10 offset:10752
  v_fma_f32 v37, v37, v30, v30
  v_mul_f32 v38, v118, v38
  v_fma_f32 v39, v39, v24, v1
  v_mul_f32 v40, v120, v120
  v_mfma_f32_32x32x16_bf16 v[144:159], a[224:227], v[204:207], v[144:159]
  ds_read_b64_tr_b16 a[236:237], v11 offset:10240
  ds_read_b64_tr_b16 a[238:239], v11 offset:10752
  v_rcp_f32 v37, v37
  v_exp_f32 v38, v38
  s_waitcnt lgkmcnt(4)
  v_mfma_f32_32x32x16_bf16 v[160:175], a[228:231], v[200:203], v[160:175]
  s_add_u32 m0, s41, 8192
  s_add_u32 s42, s28, 55296
  buffer_load_dwordx4 v8, s[12:15], s42 offen lds
  buffer_load_dwordx4 v9, s[12:15], s42 offen offset:1024 lds
  v_mul_f32 v37, v117, v37
  v_fma_f32 v38, v38, v30, v30
  v_mul_f32 v39, v119, v39
  v_mfma_f32_32x32x16_bf16 v[176:191], a[228:231], v[204:207], v[176:191]
  v_rcp_f32 v38, v38
  v_exp_f32 v39, v39
  v_cvt_pk_bf16_f32 v50, v36, v37
  v_fma_f32 v40, v40, v24, v1
  s_waitcnt lgkmcnt(2)
  v_mfma_f32_32x32x16_bf16 v[128:143], a[232:235], v[208:211], v[128:143]
  s_waitcnt vmcnt(16)
  ds_read_b64_tr_b16 a[224:225], v10 offset:12288
  ds_read_b64_tr_b16 a[226:227], v10 offset:12800
  v_mul_f32 v38, v118, v38
  v_fma_f32 v39, v39, v30, v30
  v_mul_f32 v40, v120, v40
  v_mul_f32 v41, v121, v121
  v_mfma_f32_32x32x16_bf16 v[144:159], a[232:235], v[212:215], v[144:159]
  ds_read_b64_tr_b16 a[228:229], v11 offset:12288
  ds_read_b64_tr_b16 a[230:231], v11 offset:12800
  v_rcp_f32 v39, v39
  v_exp_f32 v40, v40
  s_waitcnt lgkmcnt(4)
  v_mfma_f32_32x32x16_bf16 v[160:175], a[236:239], v[208:211], v[160:175]
  s_add_u32 m0, s41, 10240
  s_add_u32 s42, s32, 0
  buffer_load_dwordx4 v8, s[12:15], s42 offen lds
  buffer_load_dwordx4 v9, s[12:15], s42 offen offset:1024 lds
  v_mul_f32 v39, v119, v39
  v_fma_f32 v40, v40, v30, v30
  v_fma_f32 v41, v41, v24, v1
  v_mfma_f32_32x32x16_bf16 v[176:191], a[236:239], v[212:215], v[176:191]
  v_cvt_pk_bf16_f32 v51, v38, v39
  ds_write_b128 v23, v[48:51] offset:38912
  v_rcp_f32 v40, v40
  v_mul_f32 v41, v121, v41
  v_mul_f32 v42, v122, v122
  s_waitcnt lgkmcnt(3)
  v_mfma_f32_32x32x16_bf16 v[128:143], a[224:227], v[216:219], v[128:143]
  s_waitcnt vmcnt(16)
  ds_read_b64_tr_b16 a[232:233], v10 offset:14336
  ds_read_b64_tr_b16 a[234:235], v10 offset:14848
  v_mul_f32 v40, v120, v40
  v_exp_f32 v41, v41
  v_fma_f32 v42, v42, v24, v1
  v_mfma_f32_32x32x16_bf16 v[144:159], a[224:227], v[220:223], v[144:159]
  ds_read_b64_tr_b16 a[236:237], v11 offset:14336
  ds_read_b64_tr_b16 a[238:239], v11 offset:14848
  v_fma_f32 v41, v41, v30, v30
  v_mul_f32 v42, v122, v42
  v_mul_f32 v43, v123, v123
  v_mul_f32 v44, v124, v124
  s_waitcnt lgkmcnt(5)
  v_mfma_f32_32x32x16_bf16 v[160:175], a[228:231], v[216:219], v[160:175]
  s_add_u32 m0, s41, 12288
  s_add_u32 s42, s29, 0
  buffer_load_dwordx4 v8, s[12:15], s42 offen lds
  buffer_load_dwordx4 v9, s[12:15], s42 offen offset:1024 lds
  v_rcp_f32 v41, v41
  v_fma_f32 v43, v43, v24, v1
  v_mfma_f32_32x32x16_bf16 v[176:191], a[228:231], v[220:223], v[176:191]
  v_exp_f32 v42, v42
  v_mul_f32 v43, v123, v43
  v_mul_f32 v41, v121, v41
  v_fma_f32 v44, v44, v24, v1
  v_mul_f32 v45, v125, v125
  s_waitcnt lgkmcnt(2)
  v_mfma_f32_32x32x16_bf16 v[128:143], a[232:235], v[224:227], v[128:143]
  s_waitcnt vmcnt(16)
  ds_read_b64_tr_b16 a[224:225], v10 offset:16384
  ds_read_b64_tr_b16 a[226:227], v10 offset:16896
  v_fma_f32 v42, v42, v30, v30
  v_exp_f32 v43, v43
  v_cvt_pk_bf16_f32 v52, v40, v41
  v_mfma_f32_32x32x16_bf16 v[144:159], a[232:235], v[228:231], v[144:159]
  ds_read_b64_tr_b16 a[228:229], v11 offset:16384
  ds_read_b64_tr_b16 a[230:231], v11 offset:16896
  v_rcp_f32 v42, v42
  v_fma_f32 v43, v43, v30, v30
  v_mul_f32 v44, v124, v44
  s_waitcnt lgkmcnt(4)
  v_mfma_f32_32x32x16_bf16 v[160:175], a[236:239], v[224:227], v[160:175]
  s_add_u32 m0, s41, 14336
  s_add_u32 s42, s29, 18432
  buffer_load_dwordx4 v8, s[12:15], s42 offen lds
  buffer_load_dwordx4 v9, s[12:15], s42 offen offset:1024 lds
  v_mul_f32 v42, v122, v42
  v_rcp_f32 v43, v43
  v_mfma_f32_32x32x16_bf16 v[176:191], a[236:239], v[228:231], v[176:191]
  v_exp_f32 v44, v44
  v_fma_f32 v45, v45, v24, v1
  v_mul_f32 v46, v126, v126
  v_mul_f32 v43, v123, v43
  v_mul_f32 v45, v125, v45
  s_waitcnt lgkmcnt(2)
  v_mfma_f32_32x32x16_bf16 v[128:143], a[224:227], v[232:235], v[128:143]
  s_waitcnt vmcnt(16)
  ds_read_b64_tr_b16 a[232:233], v10 offset:18432
  ds_read_b64_tr_b16 a[234:235], v10 offset:18944
  v_cvt_pk_bf16_f32 v53, v42, v43
  v_fma_f32 v44, v44, v30, v30
  v_exp_f32 v45, v45
  v_mfma_f32_32x32x16_bf16 v[144:159], a[224:227], v[236:239], v[144:159]
  ds_read_b64_tr_b16 a[236:237], v11 offset:18432
  ds_read_b64_tr_b16 a[238:239], v11 offset:18944
  v_rcp_f32 v44, v44
  v_fma_f32 v45, v45, v30, v30
  v_fma_f32 v46, v46, v24, v1
  s_waitcnt lgkmcnt(4)
  v_mfma_f32_32x32x16_bf16 v[160:175], a[228:231], v[232:235], v[160:175]
  s_add_u32 m0, s41, 16384
  s_add_u32 s42, s29, 36864
  buffer_load_dwordx4 v8, s[12:15], s42 offen lds
  buffer_load_dwordx4 v9, s[12:15], s42 offen offset:1024 lds
  v_mul_f32 v44, v124, v44
  v_rcp_f32 v45, v45
  v_mfma_f32_32x32x16_bf16 v[176:191], a[228:231], v[236:239], v[176:191]
  v_mul_f32 v46, v126, v46
  v_mul_f32 v47, v127, v127
  v_sub_u32 v14, v18, v3
  v_mul_f32 v45, v125, v45
  v_exp_f32 v46, v46
  s_waitcnt lgkmcnt(2)
  v_mfma_f32_32x32x16_bf16 v[128:143], a[232:235], v[240:243], v[128:143]
  s_waitcnt vmcnt(16)
  ds_read_b64_tr_b16 a[224:225], v10 offset:0
  ds_read_b64_tr_b16 a[226:227], v10 offset:512
  v_fma_f32 v46, v46, v30, v30
  v_fma_f32 v47, v47, v24, v1
  v_cvt_pk_bf16_f32 v54, v44, v45
  v_add_u32 v14, 4294934528, v14
  v_mfma_f32_32x32x16_bf16 v[144:159], a[232:235], v[244:247], v[144:159]
  ds_read_b64_tr_b16 a[228:229], v11 offset:0
  ds_read_b64_tr_b16 a[230:231], v11 offset:512
  v_rcp_f32 v46, v46
  v_mul_f32 v47, v127, v47
  v_lshl_add_u32 v14, v14, 3, v3
  s_waitcnt lgkmcnt(4)
  v_mfma_f32_32x32x16_bf16 v[160:175], a[236:239], v[240:243], v[160:175]
  s_add_u32 m0, s41, 18432
  s_add_u32 s42, s29, 55296
  buffer_load_dwordx4 v8, s[12:15], s42 offen lds
  buffer_load_dwordx4 v9, s[12:15], s42 offen offset:1024 lds
  v_mul_f32 v46, v126, v46
  v_exp_f32 v47, v47
  v_mfma_f32_32x32x16_bf16 v[176:191], a[236:239], v[244:247], v[176:191]
  v_sub_u32 v15, v19, v3
  v_add_u32 v15, 4294934528, v15
  v_lshl_add_u32 v15, v15, 3, v3
  v_fma_f32 v47, v47, v30, v30
  v_sub_u32 v16, v20, v3
  v_add_u32 v16, 4294934528, v16
  s_waitcnt lgkmcnt(2)
  v_mfma_f32_32x32x16_bf16 v[128:143], a[224:227], v[248:251], v[128:143]
  s_waitcnt vmcnt(16)
  ds_read_b64_tr_b16 a[232:233], v12 offset:2048
  ds_read_b64_tr_b16 a[234:235], v12 offset:3072
  v_rcp_f32 v47, v47
  v_lshl_add_u32 v16, v16, 3, v3
  v_sub_u32 v17, v21, v3
  v_mfma_f32_32x32x16_bf16 v[144:159], a[224:227], v[252:255], v[144:159]
  ds_read_b64_tr_b16 a[236:237], v13 offset:2048
  ds_read_b64_tr_b16 a[238:239], v13 offset:3072
  v_mul_f32 v47, v127, v47
  v_add_u32 v17, 4294934528, v17
  v_lshl_add_u32 v17, v17, 3, v3
  v_cvt_pk_bf16_f32 v55, v46, v47
  s_waitcnt lgkmcnt(4)
  v_mfma_f32_32x32x16_bf16 v[160:175], a[228:231], v[248:251], v[160:175]
  s_add_u32 m0, s41, 0
  s_add_u32 s42, s33, 0
  buffer_load_dwordx4 v8, s[12:15], s42 offen lds
  buffer_load_dwordx4 v9, s[12:15], s42 offen offset:1024 lds
  ds_write_b128 v23, v[52:55] offset:39936
  s_waitcnt lgkmcnt(0)
  s_barrier
  v_mfma_f32_32x32x16_bf16 v[176:191], a[228:231], v[252:255], v[176:191]
  ds_read_b128 a[0:3], v14 offset:0
  ds_read_b128 a[4:7], v14 offset:36864
  ds_read_b128 a[8:11], v14 offset:1024
  ds_read_b128 a[12:15], v14 offset:37888
  s_waitcnt lgkmcnt(3)
  v_mfma_f32_32x32x16_bf16 v[64:79], a[232:235], a[0:3], 0
  s_waitcnt vmcnt(16)
  ds_read_b64_tr_b16 a[224:225], v12 offset:4096
  ds_read_b64_tr_b16 a[226:227], v12 offset:5120
  ds_read_b128 a[16:19], v14 offset:2048
  ds_read_b128 a[20:23], v14 offset:38912
  ds_read_b128 a[24:27], v14 offset:3072
  ds_read_b128 a[28:31], v14 offset:39936
  s_waitcnt lgkmcnt(8)
  v_mfma_f32_32x32x16_bf16 v[80:95], a[232:235], a[4:7], 0
  ds_read_b64_tr_b16 a[228:229], v13 offset:4096
  ds_read_b64_tr_b16 a[230:231], v13 offset:5120
  ds_read_b128 a[32:35], v18 offset:0
  ds_read_b128 a[36:39], v18 offset:36864
  ds_read_b128 a[40:43], v15 offset:0
  ds_read_b128 a[44:47], v15 offset:36864
  v_mfma_f32_32x32x16_bf16 v[96:111], a[236:239], a[0:3], 0
  s_add_u32 m0, s41, 2048
  s_add_u32 s42, s30, 0
  buffer_load_dwordx4 v8, s[12:15], s42 offen lds
  buffer_load_dwordx4 v9, s[12:15], s42 offen offset:1024 lds
  ds_read_b128 a[48:51], v15 offset:1024
  ds_read_b128 a[52:55], v15 offset:37888
  ds_read_b128 a[56:59], v15 offset:2048
  v_mfma_f32_32x32x16_bf16 v[112:127], a[236:239], a[4:7], 0
  ds_read_b128 a[60:63], v15 offset:38912
  ds_read_b128 a[64:67], v15 offset:3072
  ds_read_b128 a[68:71], v15 offset:39936
  ds_read_b128 a[72:75], v19 offset:0
  ds_read_b128 a[76:79], v19 offset:36864
  ds_read_b128 a[80:83], v16 offset:0
  s_waitcnt lgkmcnt(15)
  v_mfma_f32_32x32x16_bf16 v[64:79], a[224:227], a[8:11], v[64:79]
  s_waitcnt vmcnt(16)
  ds_read_b64_tr_b16 a[232:233], v12 offset:6144
  ds_read_b64_tr_b16 a[234:235], v12 offset:7168
  ds_read_b128 a[84:87], v16 offset:36864
  ds_read_b128 a[88:91], v16 offset:1024
  ds_read_b128 a[92:95], v16 offset:37888
  ds_read_b128 a[96:99], v16 offset:2048
  v_mfma_f32_32x32x16_bf16 v[80:95], a[224:227], a[12:15], v[80:95]
  ds_read_b64_tr_b16 a[236:237], v13 offset:6144
  ds_read_b64_tr_b16 a[238:239], v13 offset:7168
  ds_read_b128 a[100:103], v16 offset:38912
  ds_read_b128 a[104:107], v16 offset:3072
  ds_read_b128 a[108:111], v16 offset:39936
  ds_read_b128 a[112:115], v20 offset:0
  s_waitcnt lgkmcnt(15)
  v_mfma_f32_32x32x16_bf16 v[96:111], a[228:231], a[8:11], v[96:111]
  s_add_u32 m0, s41, 4096
  s_add_u32 s42, s30, 18432
  buffer_load_dwordx4 v8, s[12:15], s42 offen lds
  buffer_load_dwordx4 v9, s[12:15], s42 offen offset:1024 lds
  ds_read_b128 a[116:119], v20 offset:36864
  ds_read_b128 a[120:123], v17 offset:0
  ds_read_b128 a[124:127], v17 offset:36864
  v_mfma_f32_32x32x16_bf16 v[112:127], a[228:231], a[12:15], v[112:127]
  ds_read_b128 a[128:131], v17 offset:1024
  ds_read_b128 a[132:135], v17 offset:37888
  ds_read_b128 a[136:139], v17 offset:2048
  ds_read_b128 a[140:143], v17 offset:38912
  ds_read_b128 a[144:147], v17 offset:3072
  ds_read_b128 a[148:151], v17 offset:39936
  s_waitcnt lgkmcnt(15)
  v_mfma_f32_32x32x16_bf16 v[64:79], a[232:235], a[16:19], v[64:79]
  s_waitcnt vmcnt(16)
  ds_read_b64_tr_b16 a[224:225], v12 offset:8192
  ds_read_b64_tr_b16 a[226:227], v12 offset:9216
  ds_read_b128 a[152:155], v21 offset:0
  ds_read_b128 a[156:159], v21 offset:36864
  v_mul_f32 v32, v128, v128
  v_mul_f32 v33, v129, v129
  v_mfma_f32_32x32x16_bf16 v[80:95], a[232:235], a[20:23], v[80:95]
  ds_read_b64_tr_b16 a[228:229], v13 offset:8192
  ds_read_b64_tr_b16 a[230:231], v13 offset:9216
  v_fma_f32 v32, v32, v2, v0
  v_fma_f32 v33, v33, v2, v0
  v_mul_f32 v34, v130, v130
  v_mul_f32 v32, v128, v32
  s_waitcnt lgkmcnt(15)
  v_mfma_f32_32x32x16_bf16 v[96:111], a[236:239], a[16:19], v[96:111]
  s_add_u32 m0, s41, 6144
  s_add_u32 s42, s30, 36864
  buffer_load_dwordx4 v8, s[12:15], s42 offen lds
  buffer_load_dwordx4 v9, s[12:15], s42 offen offset:1024 lds
  v_exp_f32 v32, v32
  v_mul_f32 v33, v129, v33
  v_mfma_f32_32x32x16_bf16 v[112:127], a[236:239], a[20:23], v[112:127]
  v_fma_f32 v34, v34, v2, v0
  v_exp_f32 v33, v33
  v_fma_f32 v32, v32, v26, v26
  v_mul_f32 v34, v130, v34
  v_mul_f32 v35, v131, v131
  s_waitcnt lgkmcnt(4)
  v_mfma_f32_32x32x16_bf16 v[64:79], a[224:227], a[24:27], v[64:79]
  s_waitcnt vmcnt(16)
  ds_read_b64_tr_b16 a[232:233], v12 offset:10240
  ds_read_b64_tr_b16 a[234:235], v12 offset:11264
  v_rcp_f32 v32, v32
  v_fma_f32 v33, v33, v26, v26
  v_fma_f32 v35, v35, v2, v0
  v_mfma_f32_32x32x16_bf16 v[80:95], a[224:227], a[28:31], v[80:95]
  ds_read_b64_tr_b16 a[236:237], v13 offset:10240
  ds_read_b64_tr_b16 a[238:239], v13 offset:11264
  v_mul_f32 v32, v128, v32
  v_rcp_f32 v33, v33
  v_mul_f32 v35, v131, v35
  s_waitcnt lgkmcnt(4)
  v_mfma_f32_32x32x16_bf16 v[96:111], a[228:231], a[24:27], v[96:111]
  s_add_u32 m0, s41, 8192
  s_add_u32 s42, s30, 55296
  buffer_load_dwordx4 v8, s[12:15], s42 offen lds
  buffer_load_dwordx4 v9, s[12:15], s42 offen offset:1024 lds
  v_mul_f32 v33, v129, v33
  v_exp_f32 v34, v34
  v_mfma_f32_32x32x16_bf16 v[112:127], a[228:231], a[28:31], v[112:127]
  v_exp_f32 v35, v35
  v_cvt_pk_bf16_f32 v56, v32, v33
  v_mul_f32 v36, v132, v132
  v_fma_f32 v34, v34, v26, v26
  v_mul_f32 v37, v133, v133
  s_waitcnt lgkmcnt(2)
  v_mfma_f32_32x32x16_bf16 v[64:79], a[232:235], a[32:35], v[64:79]
  s_waitcnt vmcnt(16)
  ds_read_b64_tr_b16 a[224:225], v12 offset:12288
  ds_read_b64_tr_b16 a[226:227], v12 offset:13312
  v_rcp_f32 v34, v34
  v_fma_f32 v35, v35, v26, v26
  v_fma_f32 v36, v36, v2, v0
  v_mfma_f32_32x32x16_bf16 v[80:95], a[232:235], a[36:39], v[80:95]
  ds_read_b64_tr_b16 a[228:229], v13 offset:12288
  ds_read_b64_tr_b16 a[230:231], v13 offset:13312
  v_mul_f32 v34, v130, v34
  v_rcp_f32 v35, v35
  v_mul_f32 v36, v132, v36
  s_waitcnt lgkmcnt(4)
  v_mfma_f32_32x32x16_bf16 v[96:111], a[236:239], a[32:35], v[96:111]
  s_add_u32 m0, s41, 10240
  s_add_u32 s42, s34, 0
  buffer_load_dwordx4 v8, s[12:15], s42 offen lds
  buffer_load_dwordx4 v9, s[12:15], s42 offen offset:1024 lds
  v_mul_f32 v35, v131, v35
  v_exp_f32 v36, v36
  v_mfma_f32_32x32x16_bf16 v[112:127], a[236:239], a[36:39], v[112:127]
  v_cvt_pk_bf16_f32 v57, v34, v35
  v_fma_f32 v37, v37, v2, v0
  v_mul_f32 v38, v134, v134
  v_fma_f32 v36, v36, v26, v26
  v_mul_f32 v37, v133, v37
  v_fma_f32 v38, v38, v2, v0
  s_waitcnt lgkmcnt(2)
  v_mfma_f32_32x32x16_bf16 v[64:79], a[224:227], a[40:43], v[64:79]
  s_waitcnt vmcnt(16)
  ds_read_b64_tr_b16 a[232:233], v12 offset:14336
  ds_read_b64_tr_b16 a[234:235], v12 offset:15360
  v_rcp_f32 v36, v36
  v_exp_f32 v37, v37
  v_mfma_f32_32x32x16_bf16 v[80:95], a[224:227], a[44:47], v[80:95]
  ds_read_b64_tr_b16 a[236:237], v13 offset:14336
  ds_read_b64_tr_b16 a[238:239], v13 offset:15360
  v_mul_f32 v36, v132, v36
  v_fma_f32 v37, v37, v26, v26
  v_mul_f32 v38, v134, v38
  v_mul_f32 v39, v135, v135
  s_waitcnt lgkmcnt(4)
  v_mfma_f32_32x32x16_bf16 v[96:111], a[228:231], a[40:43], v[96:111]
  s_add_u32 m0, s41, 12288
  s_add_u32 s42, s31, 0
  buffer_load_dwordx4 v8, s[12:15], s42 offen lds
  buffer_load_dwordx4 v9, s[12:15], s42 offen offset:1024 lds
  v_rcp_f32 v37, v37
  v_fma_f32 v39, v39, v2, v0
  v_mfma_f32_32x32x16_bf16 v[112:127], a[228:231], a[44:47], v[112:127]
  v_exp_f32 v38, v38
  v_mul_f32 v39, v135, v39
  v_mul_f32 v37, v133, v37
  v_mul_f32 v40, v136, v136
  v_mul_f32 v41, v137, v137
  s_waitcnt lgkmcnt(2)
  v_mfma_f32_32x32x16_bf16 v[64:79], a[232:235], a[48:51], v[64:79]
  s_waitcnt vmcnt(16)
  ds_read_b64_tr_b16 a[224:225], v12 offset:16384
  ds_read_b64_tr_b16 a[226:227], v12 offset:17408
  v_fma_f32 v38, v38, v26, v26
  v_exp_f32 v39, v39
  v_cvt_pk_bf16_f32 v58, v36, v37
  v_mfma_f32_32x32x16_bf16 v[80:95], a[232:235], a[52:55], v[80:95]
  ds_read_b64_tr_b16 a[228:229], v13 offset:16384
  ds_read_b64_tr_b16 a[230:231], v13 offset:17408
  v_rcp_f32 v38, v38
  v_fma_f32 v39, v39, v26, v26
  v_fma_f32 v40, v40, v2, v0
  s_waitcnt lgkmcnt(4)
  v_mfma_f32_32x32x16_bf16 v[96:111], a[236:239], a[48:51], v[96:111]
  s_add_u32 m0, s41, 14336
  s_add_u32 s42, s31, 18432
  buffer_load_dwordx4 v8, s[12:15], s42 offen lds
  buffer_load_dwordx4 v9, s[12:15], s42 offen offset:1024 lds
  v_mul_f32 v38, v134, v38
  v_rcp_f32 v39, v39
  v_mfma_f32_32x32x16_bf16 v[112:127], a[236:239], a[52:55], v[112:127]
  v_mul_f32 v40, v136, v40
  v_fma_f32 v41, v41, v2, v0
  v_mul_f32 v42, v138, v138
  v_mul_f32 v39, v135, v39
  v_exp_f32 v40, v40
  s_waitcnt lgkmcnt(2)
  v_mfma_f32_32x32x16_bf16 v[64:79], a[224:227], a[56:59], v[64:79]
  s_waitcnt vmcnt(16)
  ds_read_b64_tr_b16 a[232:233], v12 offset:18432
  ds_read_b64_tr_b16 a[234:235], v12 offset:19456
  v_cvt_pk_bf16_f32 v59, v38, v39
  ds_write_b128 v23, v[56:59] offset:4096
  v_fma_f32 v40, v40, v26, v26
  v_mul_f32 v41, v137, v41
  v_mfma_f32_32x32x16_bf16 v[80:95], a[224:227], a[60:63], v[80:95]
  ds_read_b64_tr_b16 a[236:237], v13 offset:18432
  ds_read_b64_tr_b16 a[238:239], v13 offset:19456
  v_rcp_f32 v40, v40
  v_exp_f32 v41, v41
  s_waitcnt lgkmcnt(5)
  v_mfma_f32_32x32x16_bf16 v[96:111], a[228:231], a[56:59], v[96:111]
  s_add_u32 m0, s41, 16384
  s_add_u32 s42, s31, 36864
  buffer_load_dwordx4 v8, s[12:15], s42 offen lds
  buffer_load_dwordx4 v9, s[12:15], s42 offen offset:1024 lds
  v_mul_f32 v40, v136, v40
  v_fma_f32 v41, v41, v26, v26
  v_fma_f32 v42, v42, v2, v0
  v_mfma_f32_32x32x16_bf16 v[112:127], a[228:231], a[60:63], v[112:127]
  v_rcp_f32 v41, v41
  v_mul_f32 v42, v138, v42
  v_mul_f32 v43, v139, v139
  v_mul_f32 v44, v140, v140
  v_mul_f32 v45, v141, v141
  s_waitcnt lgkmcnt(3)
  v_mfma_f32_32x32x16_bf16 v[64:79], a[232:235], a[64:67], v[64:79]
  s_waitcnt vmcnt(16)
  ds_read_b64_tr_b16 a[224:225], v12 offset:0
  ds_read_b64_tr_b16 a[226:227], v12 offset:1024
  v_mul_f32 v41, v137, v41
  v_exp_f32 v42, v42
  v_fma_f32 v43, v43, v2, v0
  v_mfma_f32_32x32x16_bf16 v[80:95], a[232:235], a[68:71], v[80:95]
  ds_read_b64_tr_b16 a[228:229], v13 offset:0
  ds_read_b64_tr_b16 a[230:231], v13 offset:1024
  v_fma_f32 v42, v42, v26, v26
  v_mul_f32 v43, v139, v43
  v_cvt_pk_bf16_f32 v60, v40, v41
  v_fma_f32 v44, v44, v2, v0
  s_waitcnt lgkmcnt(4)
  v_mfma_f32_32x32x16_bf16 v[96:111], a[236:239], a[64:67], v[96:111]
  s_add_u32 m0, s41, 18432
  s_add_u32 s42, s31, 55296
  buffer_load_dwordx4 v8, s[12:15], s42 offen lds
  buffer_load_dwordx4 v9, s[12:15], s42 offen offset:1024 lds
  v_rcp_f32 v42, v42
  v_mul_f32 v44, v140, v44
  v_mfma_f32_32x32x16_bf16 v[112:127], a[236:239], a[68:71], v[112:127]
  v_exp_f32 v43, v43
  v_exp_f32 v44, v44
  v_mul_f32 v42, v138, v42
  v_fma_f32 v45, v45, v2, v0
  s_waitcnt lgkmcnt(2)
  v_mfma_f32_32x32x16_bf16 v[64:79], a[224:227], a[72:75], v[64:79]
  s_waitcnt vmcnt(16)
  ds_read_b64_tr_b16 a[232:233], v12 offset:2048
  ds_read_b64_tr_b16 a[234:235], v12 offset:3072
  v_fma_f32 v43, v43, v26, v26
  v_fma_f32 v44, v44, v26, v26
  v_mul_f32 v45, v141, v45
  v_mul_f32 v46, v142, v142
  v_mfma_f32_32x32x16_bf16 v[80:95], a[224:227], a[76:79], v[80:95]
  ds_read_b64_tr_b16 a[236:237], v13 offset:2048
  ds_read_b64_tr_b16 a[238:239], v13 offset:3072
  v_rcp_f32 v43, v43
  v_rcp_f32 v44, v44
  s_waitcnt lgkmcnt(4)
  v_mfma_f32_32x32x16_bf16 v[96:111], a[228:231], a[72:75], v[96:111]
  s_add_u32 m0, s41, 0
  s_add_u32 s42, s35, 0
  buffer_load_dwordx4 v8, s[12:15], s42 offen lds
  buffer_load_dwordx4 v9, s[12:15], s42 offen offset:1024 lds
  v_mul_f32 v43, v139, v43
  v_mul_f32 v44, v140, v44
  v_fma_f32 v46, v46, v2, v0
  v_mfma_f32_32x32x16_bf16 v[112:127], a[228:231], a[76:79], v[112:127]
  v_cvt_pk_bf16_f32 v61, v42, v43
  v_exp_f32 v45, v45
  v_mul_f32 v46, v142, v46
  v_mul_f32 v47, v143, v143
  v_mul_f32 v32, v144, v144
  s_waitcnt lgkmcnt(2)
  v_mfma_f32_32x32x16_bf16 v[64:79], a[232:235], a[80:83], v[64:79]
  s_waitcnt vmcnt(16)
  ds_read_b64_tr_b16 a[224:225], v12 offset:4096
  ds_read_b64_tr_b16 a[226:227], v12 offset:5120
  v_fma_f32 v45, v45, v26, v26
  v_exp_f32 v46, v46
  v_fma_f32 v47, v47, v2, v0
  v_mfma_f32_32x32x16_bf16 v[80:95], a[232:235], a[84:87], v[80:95]
  ds_read_b64_tr_b16 a[228:229], v13 offset:4096
  ds_read_b64_tr_b16 a[230:231], v13 offset:5120
  v_rcp_f32 v45, v45
  v_fma_f32 v46, v46, v26, v26
  v_mul_f32 v47, v143, v47
  s_waitcnt lgkmcnt(4)
  v_mfma_f32_32x32x16_bf16 v[96:111], a[236:239], a[80:83], v[96:111]
  s_add_u32 m0, s41, 2048
  s_add_u32 s42, s28, 128
  buffer_load_dwordx4 v8, s[12:15], s42 offen lds
  buffer_load_dwordx4 v9, s[12:15], s42 offen offset:1024 lds
  v_mul_f32 v45, v141, v45
  v_rcp_f32 v46, v46
  v_mfma_f32_32x32x16_bf16 v[112:127], a[236:239], a[84:87], v[112:127]
  v_exp_f32 v47, v47
  v_cvt_pk_bf16_f32 v62, v44, v45
  v_fma_f32 v32, v32, v24, v1
  v_mul_f32 v46, v142, v46
  v_mul_f32 v33, v145, v145
  s_waitcnt lgkmcnt(2)
  v_mfma_f32_32x32x16_bf16 v[64:79], a[224:227], a[88:91], v[64:79]
  s_waitcnt vmcnt(16)
  ds_read_b64_tr_b16 a[232:233], v12 offset:6144
  ds_read_b64_tr_b16 a[234:235], v12 offset:7168
  v_fma_f32 v47, v47, v26, v26
  v_mul_f32 v32, v144, v32
  v_fma_f32 v33, v33, v24, v1
  v_mul_f32 v34, v146, v146
  v_mfma_f32_32x32x16_bf16 v[80:95], a[224:227], a[92:95], v[80:95]
  ds_read_b64_tr_b16 a[236:237], v13 offset:6144
  ds_read_b64_tr_b16 a[238:239], v13 offset:7168
  v_rcp_f32 v47, v47
  v_exp_f32 v32, v32
  s_waitcnt lgkmcnt(4)
  v_mfma_f32_32x32x16_bf16 v[96:111], a[228:231], a[88:91], v[96:111]
  s_add_u32 m0, s41, 4096
  s_add_u32 s42, s28, 18560
  buffer_load_dwordx4 v8, s[12:15], s42 offen lds
  buffer_load_dwordx4 v9, s[12:15], s42 offen offset:1024 lds
  v_mul_f32 v47, v143, v47
  v_fma_f32 v32, v32, v30, v30
  v_mul_f32 v33, v145, v33
  v_mfma_f32_32x32x16_bf16 v[112:127], a[228:231], a[92:95], v[112:127]
  v_cvt_pk_bf16_f32 v63, v46, v47
  ds_write_b128 v23, v[60:63] offset:5120
  v_rcp_f32 v32, v32
  v_exp_f32 v33, v33
  s_waitcnt lgkmcnt(3)
  v_mfma_f32_32x32x16_bf16 v[64:79], a[232:235], a[96:99], v[64:79]
  s_waitcnt vmcnt(16)
  ds_read_b64_tr_b16 a[224:225], v12 offset:8192
  ds_read_b64_tr_b16 a[226:227], v12 offset:9216
  v_mul_f32 v32, v144, v32
  v_fma_f32 v33, v33, v30, v30
  v_fma_f32 v34, v34, v24, v1
  v_mul_f32 v35, v147, v147
  v_mfma_f32_32x32x16_bf16 v[80:95], a[232:235], a[100:103], v[80:95]
  ds_read_b64_tr_b16 a[228:229], v13 offset:8192
  ds_read_b64_tr_b16 a[230:231], v13 offset:9216
  v_rcp_f32 v33, v33
  v_mul_f32 v34, v146, v34
  v_fma_f32 v35, v35, v24, v1
  s_waitcnt lgkmcnt(5)
  v_mfma_f32_32x32x16_bf16 v[96:111], a[236:239], a[96:99], v[96:111]
  s_add_u32 m0, s41, 6144
  s_add_u32 s42, s28, 36992
  buffer_load_dwordx4 v8, s[12:15], s42 offen lds
  buffer_load_dwordx4 v9, s[12:15], s42 offen offset:1024 lds
  v_mul_f32 v33, v145, v33
  v_exp_f32 v34, v34
  v_mfma_f32_32x32x16_bf16 v[112:127], a[236:239], a[100:103], v[112:127]
  v_mul_f32 v35, v147, v35
  v_cvt_pk_bf16_f32 v48, v32, v33
  v_mul_f32 v36, v148, v148
  v_fma_f32 v34, v34, v30, v30
  v_exp_f32 v35, v35
  s_waitcnt lgkmcnt(2)
  v_mfma_f32_32x32x16_bf16 v[64:79], a[224:227], a[104:107], v[64:79]
  s_waitcnt vmcnt(16)
  ds_read_b64_tr_b16 a[232:233], v12 offset:10240
  ds_read_b64_tr_b16 a[234:235], v12 offset:11264
  v_rcp_f32 v34, v34
  v_fma_f32 v35, v35, v30, v30
  v_fma_f32 v36, v36, v24, v1
  v_mfma_f32_32x32x16_bf16 v[80:95], a[224:227], a[108:111], v[80:95]
  ds_read_b64_tr_b16 a[236:237], v13 offset:10240
  ds_read_b64_tr_b16 a[238:239], v13 offset:11264
  v_mul_f32 v34, v146, v34
  v_rcp_f32 v35, v35
  v_mul_f32 v36, v148, v36
  s_waitcnt lgkmcnt(4)
  v_mfma_f32_32x32x16_bf16 v[96:111], a[228:231], a[104:107], v[96:111]
  s_add_u32 m0, s41, 8192
  s_add_u32 s42, s28, 55424
  buffer_load_dwordx4 v8, s[12:15], s42 offen lds
  buffer_load_dwordx4 v9, s[12:15], s42 offen offset:1024 lds
  v_mul_f32 v35, v147, v35
  v_exp_f32 v36, v36
  v_mfma_f32_32x32x16_bf16 v[112:127], a[228:231], a[108:111], v[112:127]
  v_cvt_pk_bf16_f32 v49, v34, v35
  v_mul_f32 v37, v149, v149
  v_mul_f32 v38, v150, v150
  v_fma_f32 v36, v36, v30, v30
  v_fma_f32 v37, v37, v24, v1
  v_fma_f32 v38, v38, v24, v1
  s_waitcnt lgkmcnt(2)
  v_mfma_f32_32x32x16_bf16 v[64:79], a[232:235], a[112:115], v[64:79]
  s_waitcnt vmcnt(16)
  ds_read_b64_tr_b16 a[224:225], v12 offset:12288
  ds_read_b64_tr_b16 a[226:227], v12 offset:13312
  v_rcp_f32 v36, v36
  v_mul_f32 v37, v149, v37
  v_mul_f32 v38, v150, v38
  v_mfma_f32_32x32x16_bf16 v[80:95], a[232:235], a[116:119], v[80:95]
  ds_read_b64_tr_b16 a[228:229], v13 offset:12288
  ds_read_b64_tr_b16 a[230:231], v13 offset:13312
  v_mul_f32 v36, v148, v36
  v_exp_f32 v37, v37
  v_mul_f32 v39, v151, v151
  s_waitcnt lgkmcnt(4)
  v_mfma_f32_32x32x16_bf16 v[96:111], a[236:239], a[112:115], v[96:111]
  s_add_u32 m0, s41, 10240
  s_add_u32 s42, s32, 128
  buffer_load_dwordx4 v8, s[12:15], s42 offen lds
  buffer_load_dwordx4 v9, s[12:15], s42 offen offset:1024 lds
  v_fma_f32 v37, v37, v30, v30
  v_exp_f32 v38, v38
  v_mfma_f32_32x32x16_bf16 v[112:127], a[236:239], a[116:119], v[112:127]
  v_rcp_f32 v37, v37
  v_fma_f32 v39, v39, v24, v1
  v_mul_f32 v40, v152, v152
  v_fma_f32 v38, v38, v30, v30
  v_mul_f32 v39, v151, v39
  s_waitcnt lgkmcnt(2)
  v_mfma_f32_32x32x16_bf16 v[64:79], a[224:227], a[120:123], v[64:79]
  s_waitcnt vmcnt(16)
  ds_read_b64_tr_b16 a[232:233], v12 offset:14336
  ds_read_b64_tr_b16 a[234:235], v12 offset:15360
  v_mul_f32 v37, v149, v37
  v_rcp_f32 v38, v38
  v_fma_f32 v40, v40, v24, v1
  v_mfma_f32_32x32x16_bf16 v[80:95], a[224:227], a[124:127], v[80:95]
  ds_read_b64_tr_b16 a[236:237], v13 offset:14336
  ds_read_b64_tr_b16 a[238:239], v13 offset:15360
  v_mul_f32 v38, v150, v38
  v_exp_f32 v39, v39
  v_cvt_pk_bf16_f32 v50, v36, v37
  s_waitcnt lgkmcnt(4)
  v_mfma_f32_32x32x16_bf16 v[96:111], a[228:231], a[120:123], v[96:111]
  s_add_u32 m0, s41, 12288
  s_add_u32 s42, s29, 128
  buffer_load_dwordx4 v8, s[12:15], s42 offen lds
  buffer_load_dwordx4 v9, s[12:15], s42 offen offset:1024 lds
  v_fma_f32 v39, v39, v30, v30
  v_mul_f32 v40, v152, v40
  v_mul_f32 v41, v153, v153
  v_mfma_f32_32x32x16_bf16 v[112:127], a[228:231], a[124:127], v[112:127]
  v_rcp_f32 v39, v39
  v_exp_f32 v40, v40
  v_fma_f32 v41, v41, v24, v1
  v_mul_f32 v42, v154, v154
  s_waitcnt lgkmcnt(2)
  v_mfma_f32_32x32x16_bf16 v[64:79], a[232:235], a[128:131], v[64:79]
  s_waitcnt vmcnt(16)
  ds_read_b64_tr_b16 a[224:225], v12 offset:16384
  ds_read_b64_tr_b16 a[226:227], v12 offset:17408
  v_mul_f32 v39, v151, v39
  v_fma_f32 v40, v40, v30, v30
  v_mul_f32 v41, v153, v41
  v_cvt_pk_bf16_f32 v51, v38, v39
  v_mfma_f32_32x32x16_bf16 v[80:95], a[232:235], a[132:135], v[80:95]
  ds_read_b64_tr_b16 a[228:229], v13 offset:16384
  ds_read_b64_tr_b16 a[230:231], v13 offset:17408
  ds_write_b128 v23, v[48:51] offset:40960
  v_rcp_f32 v40, v40
  v_fma_f32 v42, v42, v24, v1
  s_waitcnt lgkmcnt(5)
  v_mfma_f32_32x32x16_bf16 v[96:111], a[236:239], a[128:131], v[96:111]
  s_add_u32 m0, s41, 14336
  s_add_u32 s42, s29, 18560
  buffer_load_dwordx4 v8, s[12:15], s42 offen lds
  buffer_load_dwordx4 v9, s[12:15], s42 offen offset:1024 lds
  v_mul_f32 v40, v152, v40
  v_exp_f32 v41, v41
  v_mfma_f32_32x32x16_bf16 v[112:127], a[236:239], a[132:135], v[112:127]
  v_mul_f32 v42, v154, v42
  v_mul_f32 v43, v155, v155
  v_mul_f32 v44, v156, v156
  v_fma_f32 v41, v41, v30, v30
  v_exp_f32 v42, v42
  s_waitcnt lgkmcnt(3)
  v_mfma_f32_32x32x16_bf16 v[64:79], a[224:227], a[136:139], v[64:79]
  s_waitcnt vmcnt(16)
  ds_read_b64_tr_b16 a[232:233], v12 offset:18432
  ds_read_b64_tr_b16 a[234:235], v12 offset:19456
  v_rcp_f32 v41, v41
  v_fma_f32 v42, v42, v30, v30
  v_fma_f32 v43, v43, v24, v1
  v_mfma_f32_32x32x16_bf16 v[80:95], a[224:227], a[140:143], v[80:95]
  ds_read_b64_tr_b16 a[236:237], v13 offset:18432
  ds_read_b64_tr_b16 a[238:239], v13 offset:19456
  v_mul_f32 v41, v153, v41
  v_rcp_f32 v42, v42
  v_mul_f32 v43, v155, v43
  s_waitcnt lgkmcnt(5)
  v_mfma_f32_32x32x16_bf16 v[96:111], a[228:231], a[136:139], v[96:111]
  s_add_u32 m0, s41, 16384
  s_add_u32 s42, s29, 36992
  buffer_load_dwordx4 v8, s[12:15], s42 offen lds
  buffer_load_dwordx4 v9, s[12:15], s42 offen offset:1024 lds
  v_mul_f32 v42, v154, v42
  v_exp_f32 v43, v43
  v_mfma_f32_32x32x16_bf16 v[112:127], a[228:231], a[140:143], v[112:127]
  v_cvt_pk_bf16_f32 v52, v40, v41
  v_fma_f32 v44, v44, v24, v1
  v_mul_f32 v45, v157, v157
  v_fma_f32 v43, v43, v30, v30
  v_mul_f32 v44, v156, v44
  v_fma_f32 v45, v45, v24, v1
  s_waitcnt lgkmcnt(2)
  v_mfma_f32_32x32x16_bf16 v[64:79], a[232:235], a[144:147], v[64:79]
  s_waitcnt vmcnt(16)
  ds_read_b64_tr_b16 a[224:225], v12 offset:0
  ds_read_b64_tr_b16 a[226:227], v12 offset:1024
  v_rcp_f32 v43, v43
  v_exp_f32 v44, v44
  v_mfma_f32_32x32x16_bf16 v[80:95], a[232:235], a[148:151], v[80:95]
  ds_read_b64_tr_b16 a[228:229], v13 offset:0
  ds_read_b64_tr_b16 a[230:231], v13 offset:1024
  v_mul_f32 v43, v155, v43
  v_fma_f32 v44, v44, v30, v30
  v_mul_f32 v45, v157, v45
  v_cvt_pk_bf16_f32 v53, v42, v43
  s_waitcnt lgkmcnt(4)
  v_mfma_f32_32x32x16_bf16 v[96:111], a[236:239], a[144:147], v[96:111]
  s_add_u32 m0, s41, 18432
  s_add_u32 s42, s29, 55424
  buffer_load_dwordx4 v8, s[12:15], s42 offen lds
  buffer_load_dwordx4 v9, s[12:15], s42 offen offset:1024 lds
  v_rcp_f32 v44, v44
  v_mul_f32 v46, v158, v158
  v_mfma_f32_32x32x16_bf16 v[112:127], a[236:239], a[148:151], v[112:127]
  v_exp_f32 v45, v45
  v_fma_f32 v46, v46, v24, v1
  v_mul_f32 v44, v156, v44
  v_mul_f32 v47, v159, v159
  v_mul_f32 v46, v158, v46
  s_waitcnt lgkmcnt(2)
  v_mfma_f32_32x32x16_bf16 v[64:79], a[224:227], a[152:155], v[64:79]
  s_waitcnt vmcnt(16)
  ds_read_b64_tr_b16 a[232:233], v12 offset:2048
  ds_read_b64_tr_b16 a[234:235], v12 offset:3072
  v_fma_f32 v45, v45, v30, v30
  v_exp_f32 v46, v46
  v_fma_f32 v47, v47, v24, v1
  v_mfma_f32_32x32x16_bf16 v[80:95], a[224:227], a[156:159], v[80:95]
  ds_read_b64_tr_b16 a[236:237], v13 offset:2048
  ds_read_b64_tr_b16 a[238:239], v13 offset:3072
  v_rcp_f32 v45, v45
  v_fma_f32 v46, v46, v30, v30
  v_mul_f32 v47, v159, v47
  s_waitcnt lgkmcnt(4)
  v_mfma_f32_32x32x16_bf16 v[96:111], a[228:231], a[152:155], v[96:111]
  s_add_u32 m0, s41, 0
  s_add_u32 s42, s33, 128
  buffer_load_dwordx4 v8, s[12:15], s42 offen lds
  buffer_load_dwordx4 v9, s[12:15], s42 offen offset:1024 lds
  v_mul_f32 v45, v157, v45
  v_rcp_f32 v46, v46
  v_mfma_f32_32x32x16_bf16 v[112:127], a[228:231], a[156:159], v[112:127]
  v_exp_f32 v47, v47
  v_cvt_pk_bf16_f32 v54, v44, v45
  s_waitcnt lgkmcnt(2)
  v_mfma_f32_32x32x16_bf16 v[192:207], a[232:235], a[0:3], 0
  s_waitcnt vmcnt(16)
  ds_read_b64_tr_b16 a[224:225], v12 offset:4096
  ds_read_b64_tr_b16 a[226:227], v12 offset:5120
  v_mul_f32 v46, v158, v46
  v_fma_f32 v47, v47, v30, v30
  v_mfma_f32_32x32x16_bf16 v[208:223], a[232:235], a[4:7], 0
  ds_read_b64_tr_b16 a[228:229], v13 offset:4096
  ds_read_b64_tr_b16 a[230:231], v13 offset:5120
  v_rcp_f32 v47, v47
  s_waitcnt lgkmcnt(4)
  v_mfma_f32_32x32x16_bf16 v[224:239], a[236:239], a[0:3], 0
  s_add_u32 m0, s41, 2048
  s_add_u32 s42, s30, 128
  buffer_load_dwordx4 v8, s[12:15], s42 offen lds
  buffer_load_dwordx4 v9, s[12:15], s42 offen offset:1024 lds
  v_mul_f32 v47, v159, v47
  v_mfma_f32_32x32x16_bf16 v[240:255], a[236:239], a[4:7], 0
  s_waitcnt lgkmcnt(2)
  v_mfma_f32_32x32x16_bf16 v[192:207], a[224:227], a[8:11], v[192:207]
  s_waitcnt vmcnt(16)
  ds_read_b64_tr_b16 a[232:233], v12 offset:6144
  ds_read_b64_tr_b16 a[234:235], v12 offset:7168
  v_cvt_pk_bf16_f32 v55, v46, v47
  ds_write_b128 v23, v[52:55] offset:41984
  s_waitcnt lgkmcnt(0)
  s_barrier
  v_mfma_f32_32x32x16_bf16 v[208:223], a[224:227], a[12:15], v[208:223]
  ds_read_b64_tr_b16 a[236:237], v13 offset:6144
  ds_read_b64_tr_b16 a[238:239], v13 offset:7168
  ds_read_b128 a[160:163], v14 offset:4096
  ds_read_b128 a[164:167], v14 offset:40960
  ds_read_b128 a[168:171], v14 offset:5120
  ds_read_b128 a[172:175], v14 offset:41984
  v_mfma_f32_32x32x16_bf16 v[224:239], a[228:231], a[8:11], v[224:239]
  s_add_u32 m0, s41, 4096
  s_add_u32 s42, s30, 18560
  buffer_load_dwordx4 v8, s[12:15], s42 offen lds
  buffer_load_dwordx4 v9, s[12:15], s42 offen offset:1024 lds
  ds_read_b128 a[176:179], v15 offset:4096
  ds_read_b128 a[180:183], v15 offset:40960
  ds_read_b128 a[184:187], v15 offset:5120
  v_mfma_f32_32x32x16_bf16 v[240:255], a[228:231], a[12:15], v[240:255]
  ds_read_b128 a[188:191], v15 offset:41984
  ds_read_b128 a[192:195], v16 offset:4096
  ds_read_b128 a[196:199], v16 offset:40960
  ds_read_b128 a[200:203], v16 offset:5120
  ds_read_b128 a[204:207], v16 offset:41984
  ds_read_b128 a[208:211], v17 offset:4096
  v_mfma_f32_32x32x16_bf16 v[192:207], a[232:235], a[16:19], v[192:207]
  s_waitcnt vmcnt(16)
  ds_read_b64_tr_b16 a[224:225], v12 offset:8192
  ds_read_b64_tr_b16 a[226:227], v12 offset:9216
  ds_read_b128 a[212:215], v17 offset:40960
  ds_read_b128 a[216:219], v17 offset:5120
  ds_read_b128 a[220:223], v17 offset:41984
  v_mul_f32 v32, v160, v160
  v_mfma_f32_32x32x16_bf16 v[208:223], a[232:235], a[20:23], v[208:223]
  ds_read_b64_tr_b16 a[228:229], v13 offset:8192
  ds_read_b64_tr_b16 a[230:231], v13 offset:9216
  v_fma_f32 v32, v32, v2, v0
  v_mul_f32 v33, v161, v161
  v_mul_f32 v34, v162, v162
  v_mul_f32 v32, v160, v32
  s_waitcnt lgkmcnt(15)
  v_mfma_f32_32x32x16_bf16 v[224:239], a[236:239], a[16:19], v[224:239]
  s_add_u32 m0, s41, 6144
  s_add_u32 s42, s30, 36992
  buffer_load_dwordx4 v8, s[12:15], s42 offen lds
  buffer_load_dwordx4 v9, s[12:15], s42 offen offset:1024 lds
  v_exp_f32 v32, v32
  v_fma_f32 v33, v33, v2, v0
  v_mfma_f32_32x32x16_bf16 v[240:255], a[236:239], a[20:23], v[240:255]
  v_fma_f32 v34, v34, v2, v0
  v_mul_f32 v33, v161, v33
  v_fma_f32 v32, v32, v26, v26
  v_mul_f32 v34, v162, v34
  v_exp_f32 v33, v33
  s_waitcnt lgkmcnt(5)
  v_mfma_f32_32x32x16_bf16 v[192:207], a[224:227], a[24:27], v[192:207]
  s_waitcnt vmcnt(16)
  ds_read_b64_tr_b16 a[232:233], v12 offset:10240
  ds_read_b64_tr_b16 a[234:235], v12 offset:11264
  v_rcp_f32 v32, v32
  v_fma_f32 v33, v33, v26, v26
  v_mul_f32 v35, v163, v163
  v_mfma_f32_32x32x16_bf16 v[208:223], a[224:227], a[28:31], v[208:223]
  ds_read_b64_tr_b16 a[236:237], v13 offset:10240
  ds_read_b64_tr_b16 a[238:239], v13 offset:11264
  v_mul_f32 v32, v160, v32
  v_rcp_f32 v33, v33
  v_fma_f32 v35, v35, v2, v0
  s_waitcnt lgkmcnt(4)
  v_mfma_f32_32x32x16_bf16 v[224:239], a[228:231], a[24:27], v[224:239]
  s_add_u32 m0, s41, 8192
  s_add_u32 s42, s30, 55424
  buffer_load_dwordx4 v8, s[12:15], s42 offen lds
  buffer_load_dwordx4 v9, s[12:15], s42 offen offset:1024 lds
  v_mul_f32 v33, v161, v33
  v_exp_f32 v34, v34
  v_mfma_f32_32x32x16_bf16 v[240:255], a[228:231], a[28:31], v[240:255]
  v_mul_f32 v35, v163, v35
  v_cvt_pk_bf16_f32 v56, v32, v33
  v_mul_f32 v36, v164, v164
  v_fma_f32 v34, v34, v26, v26
  v_exp_f32 v35, v35
  s_waitcnt lgkmcnt(2)
  v_mfma_f32_32x32x16_bf16 v[192:207], a[232:235], a[32:35], v[192:207]
  s_waitcnt vmcnt(16)
  ds_read_b64_tr_b16 a[224:225], v12 offset:12288
  ds_read_b64_tr_b16 a[226:227], v12 offset:13312
  v_rcp_f32 v34, v34
  v_fma_f32 v35, v35, v26, v26
  v_fma_f32 v36, v36, v2, v0
  v_mfma_f32_32x32x16_bf16 v[208:223], a[232:235], a[36:39], v[208:223]
  ds_read_b64_tr_b16 a[228:229], v13 offset:12288
  ds_read_b64_tr_b16 a[230:231], v13 offset:13312
  v_mul_f32 v34, v162, v34
  v_rcp_f32 v35, v35
  v_mul_f32 v36, v164, v36
  s_waitcnt lgkmcnt(4)
  v_mfma_f32_32x32x16_bf16 v[224:239], a[236:239], a[32:35], v[224:239]
  s_add_u32 m0, s41, 10240
  s_add_u32 s42, s56, 0
  buffer_load_dwordx4 v8, s[12:15], s42 offen lds
  buffer_load_dwordx4 v9, s[12:15], s42 offen offset:1024 lds
  v_mul_f32 v35, v163, v35
  v_exp_f32 v36, v36
  v_mfma_f32_32x32x16_bf16 v[240:255], a[236:239], a[36:39], v[240:255]
  v_cvt_pk_bf16_f32 v57, v34, v35
  v_mul_f32 v37, v165, v165
  v_mul_f32 v38, v166, v166
  v_fma_f32 v36, v36, v26, v26
  v_fma_f32 v37, v37, v2, v0
  v_fma_f32 v38, v38, v2, v0
  s_waitcnt lgkmcnt(2)
  v_mfma_f32_32x32x16_bf16 v[192:207], a[224:227], a[40:43], v[192:207]
  s_waitcnt vmcnt(16)
  ds_read_b64_tr_b16 a[232:233], v12 offset:14336
  ds_read_b64_tr_b16 a[234:235], v12 offset:15360
  v_rcp_f32 v36, v36
  v_mul_f32 v37, v165, v37
  v_mul_f32 v38, v166, v38
  v_mfma_f32_32x32x16_bf16 v[208:223], a[224:227], a[44:47], v[208:223]
  ds_read_b64_tr_b16 a[236:237], v13 offset:14336
  ds_read_b64_tr_b16 a[238:239], v13 offset:15360
  v_mul_f32 v36, v164, v36
  v_exp_f32 v37, v37
  v_mul_f32 v39, v167, v167
  s_waitcnt lgkmcnt(4)
  v_mfma_f32_32x32x16_bf16 v[224:239], a[228:231], a[40:43], v[224:239]
  s_add_u32 m0, s41, 12288
  s_add_u32 s42, s56, 18432
  buffer_load_dwordx4 v8, s[12:15], s42 offen lds
  buffer_load_dwordx4 v9, s[12:15], s42 offen offset:1024 lds
  v_fma_f32 v37, v37, v26, v26
  v_exp_f32 v38, v38
  v_mfma_f32_32x32x16_bf16 v[240:255], a[228:231], a[44:47], v[240:255]
  v_rcp_f32 v37, v37
  v_fma_f32 v39, v39, v2, v0
  v_mul_f32 v40, v168, v168
  v_fma_f32 v38, v38, v26, v26
  v_mul_f32 v39, v167, v39
  s_waitcnt lgkmcnt(2)
  v_mfma_f32_32x32x16_bf16 v[192:207], a[232:235], a[48:51], v[192:207]
  s_waitcnt vmcnt(16)
  ds_read_b64_tr_b16 a[224:225], v12 offset:16384
  ds_read_b64_tr_b16 a[226:227], v12 offset:17408
  v_mul_f32 v37, v165, v37
  v_rcp_f32 v38, v38
  v_fma_f32 v40, v40, v2, v0
  v_mfma_f32_32x32x16_bf16 v[208:223], a[232:235], a[52:55], v[208:223]
  ds_read_b64_tr_b16 a[228:229], v13 offset:16384
  ds_read_b64_tr_b16 a[230:231], v13 offset:17408
  v_mul_f32 v38, v166, v38
  v_exp_f32 v39, v39
  v_cvt_pk_bf16_f32 v58, v36, v37
  s_waitcnt lgkmcnt(4)
  v_mfma_f32_32x32x16_bf16 v[224:239], a[236:239], a[48:51], v[224:239]
  s_add_u32 m0, s41, 14336
  s_add_u32 s42, s57, 0
  buffer_load_dwordx4 v8, s[12:15], s42 offen lds
  buffer_load_dwordx4 v9, s[12:15], s42 offen offset:1024 lds
  v_fma_f32 v39, v39, v26, v26
  v_mul_f32 v40, v168, v40
  v_mul_f32 v41, v169, v169
  v_mfma_f32_32x32x16_bf16 v[240:255], a[236:239], a[52:55], v[240:255]
  v_rcp_f32 v39, v39
  v_exp_f32 v40, v40
  v_fma_f32 v41, v41, v2, v0
  v_mul_f32 v42, v170, v170
  s_waitcnt lgkmcnt(2)
  v_mfma_f32_32x32x16_bf16 v[192:207], a[224:227], a[56:59], v[192:207]
  s_waitcnt vmcnt(16)
  ds_read_b64_tr_b16 a[232:233], v12 offset:18432
  ds_read_b64_tr_b16 a[234:235], v12 offset:19456
  v_mul_f32 v39, v167, v39
  v_fma_f32 v40, v40, v26, v26
  v_mul_f32 v41, v169, v41
  v_cvt_pk_bf16_f32 v59, v38, v39
  v_mfma_f32_32x32x16_bf16 v[208:223], a[224:227], a[60:63], v[208:223]
  ds_read_b64_tr_b16 a[236:237], v13 offset:18432
  ds_read_b64_tr_b16 a[238:239], v13 offset:19456
  ds_write_b128 v23, v[56:59] offset:6144
  v_rcp_f32 v40, v40
  v_fma_f32 v42, v42, v2, v0
  s_waitcnt lgkmcnt(5)
  v_mfma_f32_32x32x16_bf16 v[224:239], a[228:231], a[56:59], v[224:239]
  s_add_u32 m0, s41, 16384
  s_add_u32 s42, s57, 18432
  buffer_load_dwordx4 v8, s[12:15], s42 offen lds
  buffer_load_dwordx4 v9, s[12:15], s42 offen offset:1024 lds
  v_mul_f32 v40, v168, v40
  v_exp_f32 v41, v41
  v_mfma_f32_32x32x16_bf16 v[240:255], a[228:231], a[60:63], v[240:255]
  v_mul_f32 v42, v170, v42
  v_mul_f32 v43, v171, v171
  v_mul_f32 v44, v172, v172
  v_fma_f32 v41, v41, v26, v26
  v_exp_f32 v42, v42
  s_waitcnt lgkmcnt(3)
  v_mfma_f32_32x32x16_bf16 v[192:207], a[232:235], a[64:67], v[192:207]
  s_waitcnt vmcnt(16)
  ds_read_b64_tr_b16 a[224:225], v12 offset:0
  ds_read_b64_tr_b16 a[226:227], v12 offset:1024
  v_rcp_f32 v41, v41
  v_fma_f32 v42, v42, v26, v26
  v_fma_f32 v43, v43, v2, v0
  v_mfma_f32_32x32x16_bf16 v[208:223], a[232:235], a[68:71], v[208:223]
  ds_read_b64_tr_b16 a[228:229], v13 offset:0
  ds_read_b64_tr_b16 a[230:231], v13 offset:1024
  v_mul_f32 v41, v169, v41
  v_rcp_f32 v42, v42
  v_mul_f32 v43, v171, v43
  s_waitcnt lgkmcnt(5)
  v_mfma_f32_32x32x16_bf16 v[224:239], a[236:239], a[64:67], v[224:239]
  s_add_u32 m0, s41, 18432
  s_add_u32 s42, s58, 0
  buffer_load_dwordx4 v8, s[12:15], s42 offen lds
  buffer_load_dwordx4 v9, s[12:15], s42 offen offset:1024 lds
  v_mul_f32 v42, v170, v42
  v_exp_f32 v43, v43
  v_mfma_f32_32x32x16_bf16 v[240:255], a[236:239], a[68:71], v[240:255]
  v_cvt_pk_bf16_f32 v60, v40, v41
  v_fma_f32 v44, v44, v2, v0
  v_mul_f32 v45, v173, v173
  v_fma_f32 v43, v43, v26, v26
  v_mul_f32 v44, v172, v44
  v_fma_f32 v45, v45, v2, v0
  s_waitcnt lgkmcnt(2)
  v_mfma_f32_32x32x16_bf16 v[192:207], a[224:227], a[72:75], v[192:207]
  s_waitcnt vmcnt(16)
  ds_read_b64_tr_b16 a[232:233], v12 offset:2048
  ds_read_b64_tr_b16 a[234:235], v12 offset:3072
  v_rcp_f32 v43, v43
  v_exp_f32 v44, v44
  v_mfma_f32_32x32x16_bf16 v[208:223], a[224:227], a[76:79], v[208:223]
  ds_read_b64_tr_b16 a[236:237], v13 offset:2048
  ds_read_b64_tr_b16 a[238:239], v13 offset:3072
  v_mul_f32 v43, v171, v43
  v_fma_f32 v44, v44, v26, v26
  v_mul_f32 v45, v173, v45
  v_cvt_pk_bf16_f32 v61, v42, v43
  s_waitcnt lgkmcnt(4)
  v_mfma_f32_32x32x16_bf16 v[224:239], a[228:231], a[72:75], v[224:239]
  s_add_u32 m0, s41, 0
  s_add_u32 s42, s58, 18432
  buffer_load_dwordx4 v8, s[12:15], s42 offen lds
  buffer_load_dwordx4 v9, s[12:15], s42 offen offset:1024 lds
  v_rcp_f32 v44, v44
  v_mul_f32 v46, v174, v174
  v_mfma_f32_32x32x16_bf16 v[240:255], a[228:231], a[76:79], v[240:255]
  v_exp_f32 v45, v45
  v_fma_f32 v46, v46, v2, v0
  v_mul_f32 v44, v172, v44
  v_mul_f32 v47, v175, v175
  v_mul_f32 v46, v174, v46
  s_waitcnt lgkmcnt(2)
  v_mfma_f32_32x32x16_bf16 v[192:207], a[232:235], a[80:83], v[192:207]
  s_waitcnt vmcnt(16)
  ds_read_b64_tr_b16 a[224:225], v12 offset:4096
  ds_read_b64_tr_b16 a[226:227], v12 offset:5120
  v_fma_f32 v45, v45, v26, v26
  v_exp_f32 v46, v46
  v_fma_f32 v47, v47, v2, v0
  v_mfma_f32_32x32x16_bf16 v[208:223], a[232:235], a[84:87], v[208:223]
  ds_read_b64_tr_b16 a[228:229], v13 offset:4096
  ds_read_b64_tr_b16 a[230:231], v13 offset:5120
  v_rcp_f32 v45, v45
  v_fma_f32 v46, v46, v26, v26
  v_mul_f32 v47, v175, v47
  s_waitcnt lgkmcnt(4)
  v_mfma_f32_32x32x16_bf16 v[224:239], a[236:239], a[80:83], v[224:239]
  s_add_u32 m0, s41, 2048
  s_add_u32 s42, s59, 0
  buffer_load_dwordx4 v8, s[12:15], s42 offen lds
  buffer_load_dwordx4 v9, s[12:15], s42 offen offset:1024 lds
  v_mul_f32 v45, v173, v45
  v_rcp_f32 v46, v46
  v_mfma_f32_32x32x16_bf16 v[240:255], a[236:239], a[84:87], v[240:255]
  v_exp_f32 v47, v47
  v_cvt_pk_bf16_f32 v62, v44, v45
  v_mul_f32 v32, v176, v176
  v_mul_f32 v46, v174, v46
  v_mul_f32 v33, v177, v177
  s_waitcnt lgkmcnt(2)
  v_mfma_f32_32x32x16_bf16 v[192:207], a[224:227], a[88:91], v[192:207]
  s_waitcnt vmcnt(16)
  ds_read_b64_tr_b16 a[232:233], v12 offset:6144
  ds_read_b64_tr_b16 a[234:235], v12 offset:7168
  v_fma_f32 v47, v47, v26, v26
  v_fma_f32 v32, v32, v24, v1
  v_fma_f32 v33, v33, v24, v1
  v_mul_f32 v34, v178, v178
  v_mfma_f32_32x32x16_bf16 v[208:223], a[224:227], a[92:95], v[208:223]
  ds_read_b64_tr_b16 a[236:237], v13 offset:6144
  ds_read_b64_tr_b16 a[238:239], v13 offset:7168
  v_rcp_f32 v47, v47
  v_mul_f32 v32, v176, v32
  v_mul_f32 v33, v177, v33
  s_waitcnt lgkmcnt(4)
  v_mfma_f32_32x32x16_bf16 v[224:239], a[228:231], a[88:91], v[224:239]
  s_add_u32 m0, s41, 4096
  s_add_u32 s42, s59, 18432
  buffer_load_dwordx4 v8, s[12:15], s42 offen lds
  buffer_load_dwordx4 v9, s[12:15], s42 offen offset:1024 lds
  v_mul_f32 v47, v175, v47
  v_exp_f32 v32, v32
  v_mfma_f32_32x32x16_bf16 v[240:255], a[228:231], a[92:95], v[240:255]
  v_cvt_pk_bf16_f32 v63, v46, v47
  ds_write_b128 v23, v[60:63] offset:7168
  v_exp_f32 v33, v33
  v_fma_f32 v32, v32, v30, v30
  v_fma_f32 v34, v34, v24, v1
  s_waitcnt lgkmcnt(3)
  v_mfma_f32_32x32x16_bf16 v[192:207], a[232:235], a[96:99], v[192:207]
  s_waitcnt vmcnt(16)
  ds_read_b64_tr_b16 a[224:225], v12 offset:8192
  ds_read_b64_tr_b16 a[226:227], v12 offset:9216
  v_rcp_f32 v32, v32
  v_fma_f32 v33, v33, v30, v30
  v_mul_f32 v34, v178, v34
  v_mfma_f32_32x32x16_bf16 v[208:223], a[232:235], a[100:103], v[208:223]
  ds_read_b64_tr_b16 a[228:229], v13 offset:8192
  ds_read_b64_tr_b16 a[230:231], v13 offset:9216
  v_mul_f32 v32, v176, v32
  v_rcp_f32 v33, v33
  v_mul_f32 v35, v179, v179
  s_waitcnt lgkmcnt(5)
  v_mfma_f32_32x32x16_bf16 v[224:239], a[236:239], a[96:99], v[224:239]
  s_add_u32 m0, s41, 6144
  s_add_u32 s42, s56, 36864
  buffer_load_dwordx4 v8, s[12:15], s42 offen lds
  buffer_load_dwordx4 v9, s[12:15], s42 offen offset:1024 lds
  v_mul_f32 v33, v177, v33
  v_exp_f32 v34, v34
  v_mfma_f32_32x32x16_bf16 v[240:255], a[236:239], a[100:103], v[240:255]
  v_fma_f32 v35, v35, v24, v1
  v_cvt_pk_bf16_f32 v48, v32, v33
  v_mul_f32 v36, v180, v180
  v_fma_f32 v34, v34, v30, v30
  v_mul_f32 v35, v179, v35
  v_fma_f32 v36, v36, v24, v1
  s_waitcnt lgkmcnt(2)
  v_mfma_f32_32x32x16_bf16 v[192:207], a[224:227], a[104:107], v[192:207]
  s_waitcnt vmcnt(16)
  ds_read_b64_tr_b16 a[232:233], v12 offset:10240
  ds_read_b64_tr_b16 a[234:235], v12 offset:11264
  v_rcp_f32 v34, v34
  v_exp_f32 v35, v35
  v_mfma_f32_32x32x16_bf16 v[208:223], a[224:227], a[108:111], v[208:223]
  ds_read_b64_tr_b16 a[236:237], v13 offset:10240
  ds_read_b64_tr_b16 a[238:239], v13 offset:11264
  v_mul_f32 v34, v178, v34
  v_fma_f32 v35, v35, v30, v30
  v_mul_f32 v36, v180, v36
  v_mul_f32 v37, v181, v181
  s_waitcnt lgkmcnt(4)
  v_mfma_f32_32x32x16_bf16 v[224:239], a[228:231], a[104:107], v[224:239]
  s_add_u32 m0, s41, 8192
  s_add_u32 s42, s56, 55296
  buffer_load_dwordx4 v8, s[12:15], s42 offen lds
  buffer_load_dwordx4 v9, s[12:15], s42 offen offset:1024 lds
  v_rcp_f32 v35, v35
  v_fma_f32 v37, v37, v24, v1
  v_mfma_f32_32x32x16_bf16 v[240:255], a[228:231], a[108:111], v[240:255]
  v_exp_f32 v36, v36
  v_mul_f32 v37, v181, v37
  v_mul_f32 v35, v179, v35
  v_mul_f32 v38, v182, v182
  v_mul_f32 v39, v183, v183
  s_waitcnt lgkmcnt(2)
  v_mfma_f32_32x32x16_bf16 v[64:79], a[232:235], a[160:163], v[64:79]
  s_waitcnt vmcnt(16)
  ds_read_b64_tr_b16 a[224:225], v12 offset:12288
  ds_read_b64_tr_b16 a[226:227], v12 offset:13312
  v_cvt_pk_bf16_f32 v49, v34, v35
  v_fma_f32 v36, v36, v30, v30
  v_exp_f32 v37, v37
  v_mfma_f32_32x32x16_bf16 v[80:95], a[232:235], a[164:167], v[80:95]
  ds_read_b64_tr_b16 a[228:229], v13 offset:12288
  ds_read_b64_tr_b16 a[230:231], v13 offset:13312
  v_rcp_f32 v36, v36
  v_fma_f32 v37, v37, v30, v30
  v_fma_f32 v38, v38, v24, v1
  s_waitcnt lgkmcnt(4)
  v_mfma_f32_32x32x16_bf16 v[96:111], a[236:239], a[160:163], v[96:111]
  s_add_u32 m0, s41, 10240
  s_add_u32 s42, s57, 36864
  buffer_load_dwordx4 v8, s[12:15], s42 offen lds
  buffer_load_dwordx4 v9, s[12:15], s42 offen offset:1024 lds
  v_mul_f32 v36, v180, v36
  v_rcp_f32 v37, v37
  v_mfma_f32_32x32x16_bf16 v[112:127], a[236:239], a[164:167], v[112:127]
  v_mul_f32 v38, v182, v38
  v_fma_f32 v39, v39, v24, v1
  v_mul_f32 v40, v184, v184
  v_mul_f32 v37, v181, v37
  v_exp_f32 v38, v38
  s_waitcnt lgkmcnt(2)
  v_mfma_f32_32x32x16_bf16 v[64:79], a[224:227], a[168:171], v[64:79]
  s_waitcnt vmcnt(16)
  ds_read_b64_tr_b16 a[232:233], v12 offset:14336
  ds_read_b64_tr_b16 a[234:235], v12 offset:15360
  v_fma_f32 v38, v38, v30, v30
  v_mul_f32 v39, v183, v39
  v_cvt_pk_bf16_f32 v50, v36, v37
  v_fma_f32 v40, v40, v24, v1
  v_mfma_f32_32x32x16_bf16 v[80:95], a[224:227], a[172:175], v[80:95]
  ds_read_b64_tr_b16 a[236:237], v13 offset:14336
  ds_read_b64_tr_b16 a[238:239], v13 offset:15360
  v_rcp_f32 v38, v38
  v_exp_f32 v39, v39
  s_waitcnt lgkmcnt(4)
  v_mfma_f32_32x32x16_bf16 v[96:111], a[228:231], a[168:171], v[96:111]
  s_add_u32 m0, s41, 12288
  s_add_u32 s42, s57, 55296
  buffer_load_dwordx4 v8, s[12:15], s42 offen lds
  buffer_load_dwordx4 v9, s[12:15], s42 offen offset:1024 lds
  v_mul_f32 v38, v182, v38
  v_fma_f32 v39, v39, v30, v30
  v_mul_f32 v40, v184, v40
  v_mfma_f32_32x32x16_bf16 v[112:127], a[228:231], a[172:175], v[112:127]
  v_rcp_f32 v39, v39
  v_exp_f32 v40, v40
  v_mul_f32 v41, v185, v185
  v_mul_f32 v42, v186, v186
  s_waitcnt lgkmcnt(2)
  v_mfma_f32_32x32x16_bf16 v[64:79], a[232:235], a[176:179], v[64:79]
  s_waitcnt vmcnt(16)
  ds_read_b64_tr_b16 a[224:225], v12 offset:16384
  ds_read_b64_tr_b16 a[226:227], v12 offset:17408
  v_mul_f32 v39, v183, v39
  v_fma_f32 v40, v40, v30, v30
  v_fma_f32 v41, v41, v24, v1
  v_cvt_pk_bf16_f32 v51, v38, v39
  v_mfma_f32_32x32x16_bf16 v[80:95], a[232:235], a[180:183], v[80:95]
  ds_read_b64_tr_b16 a[228:229], v13 offset:16384
  ds_read_b64_tr_b16 a[230:231], v13 offset:17408
  ds_write_b128 v23, v[48:51] offset:43008
  v_rcp_f32 v40, v40
  v_mul_f32 v41, v185, v41
  s_waitcnt lgkmcnt(5)
  v_mfma_f32_32x32x16_bf16 v[96:111], a[236:239], a[176:179], v[96:111]
  s_add_u32 m0, s41, 14336
  s_add_u32 s42, s58, 36864
  buffer_load_dwordx4 v8, s[12:15], s42 offen lds
  buffer_load_dwordx4 v9, s[12:15], s42 offen offset:1024 lds
  v_mul_f32 v40, v184, v40
  v_exp_f32 v41, v41
  v_mfma_f32_32x32x16_bf16 v[112:127], a[236:239], a[180:183], v[112:127]
  v_fma_f32 v42, v42, v24, v1
  v_mul_f32 v43, v187, v187
  v_mul_f32 v44, v188, v188
  v_fma_f32 v41, v41, v30, v30
  v_mul_f32 v42, v186, v42
  v_fma_f32 v43, v43, v24, v1
  s_waitcnt lgkmcnt(3)
  v_mfma_f32_32x32x16_bf16 v[64:79], a[224:227], a[184:187], v[64:79]
  s_waitcnt vmcnt(16)
  ds_read_b64_tr_b16 a[232:233], v12 offset:18432
  ds_read_b64_tr_b16 a[234:235], v12 offset:19456
  v_rcp_f32 v41, v41
  v_exp_f32 v42, v42
  v_mfma_f32_32x32x16_bf16 v[80:95], a[224:227], a[188:191], v[80:95]
  ds_read_b64_tr_b16 a[236:237], v13 offset:18432
  ds_read_b64_tr_b16 a[238:239], v13 offset:19456
  v_mul_f32 v41, v185, v41
  v_fma_f32 v42, v42, v30, v30
  v_mul_f32 v43, v187, v43
  v_cvt_pk_bf16_f32 v52, v40, v41
  s_waitcnt lgkmcnt(5)
  v_mfma_f32_32x32x16_bf16 v[96:111], a[228:231], a[184:187], v[96:111]
  s_add_u32 m0, s41, 16384
  s_add_u32 s42, s58, 55296
  buffer_load_dwordx4 v8, s[12:15], s42 offen lds
  buffer_load_dwordx4 v9, s[12:15], s42 offen offset:1024 lds
  v_rcp_f32 v42, v42
  v_fma_f32 v44, v44, v24, v1
  v_mfma_f32_32x32x16_bf16 v[112:127], a[228:231], a[188:191], v[112:127]
  v_exp_f32 v43, v43
  v_mul_f32 v44, v188, v44
  v_mul_f32 v42, v186, v42
  v_mul_f32 v45, v189, v189
  v_mul_f32 v46, v190, v190
  s_waitcnt lgkmcnt(2)
  v_mfma_f32_32x32x16_bf16 v[64:79], a[232:235], a[192:195], v[64:79]
  s_waitcnt vmcnt(16)
  ds_read_b64_tr_b16 a[224:225], v12 offset:0
  ds_read_b64_tr_b16 a[226:227], v12 offset:1024
  v_fma_f32 v43, v43, v30, v30
  v_exp_f32 v44, v44
  v_fma_f32 v45, v45, v24, v1
  v_mfma_f32_32x32x16_bf16 v[80:95], a[232:235], a[196:199], v[80:95]
  ds_read_b64_tr_b16 a[228:229], v13 offset:0
  ds_read_b64_tr_b16 a[230:231], v13 offset:1024
  v_rcp_f32 v43, v43
  v_fma_f32 v44, v44, v30, v30
  v_mul_f32 v45, v189, v45
  s_waitcnt lgkmcnt(4)
  v_mfma_f32_32x32x16_bf16 v[96:111], a[236:239], a[192:195], v[96:111]
  s_add_u32 m0, s41, 18432
  s_add_u32 s42, s59, 36864
  buffer_load_dwordx4 v8, s[12:15], s42 offen lds
  buffer_load_dwordx4 v9, s[12:15], s42 offen offset:1024 lds
  v_mul_f32 v43, v187, v43
  v_rcp_f32 v44, v44
  v_mfma_f32_32x32x16_bf16 v[112:127], a[236:239], a[196:199], v[112:127]
  v_cvt_pk_bf16_f32 v53, v42, v43
  v_exp_f32 v45, v45
  v_fma_f32 v46, v46, v24, v1
  v_mul_f32 v44, v188, v44
  v_mul_f32 v47, v191, v191
  s_waitcnt lgkmcnt(2)
  v_mfma_f32_32x32x16_bf16 v[64:79], a[224:227], a[200:203], v[64:79]
  s_waitcnt vmcnt(16)
  ds_read_b64_tr_b16 a[232:233], v12 offset:2048
  ds_read_b64_tr_b16 a[234:235], v12 offset:3072
  v_fma_f32 v45, v45, v30, v30
  v_mul_f32 v46, v190, v46
  v_fma_f32 v47, v47, v24, v1
  v_mfma_f32_32x32x16_bf16 v[80:95], a[224:227], a[204:207], v[80:95]
  ds_read_b64_tr_b16 a[236:237], v13 offset:2048
  ds_read_b64_tr_b16 a[238:239], v13 offset:3072
  v_rcp_f32 v45, v45
  v_exp_f32 v46, v46
  s_waitcnt lgkmcnt(4)
  v_mfma_f32_32x32x16_bf16 v[96:111], a[228:231], a[200:203], v[96:111]
  s_add_u32 m0, s41, 0
  s_add_u32 s42, s59, 55296
  buffer_load_dwordx4 v8, s[12:15], s42 offen lds
  buffer_load_dwordx4 v9, s[12:15], s42 offen offset:1024 lds
  v_mul_f32 v45, v189, v45
  v_fma_f32 v46, v46, v30, v30
  v_mul_f32 v47, v191, v47
  v_mfma_f32_32x32x16_bf16 v[112:127], a[228:231], a[204:207], v[112:127]
  v_rcp_f32 v46, v46
  v_exp_f32 v47, v47
  v_cvt_pk_bf16_f32 v54, v44, v45
  s_waitcnt lgkmcnt(2)
  v_mfma_f32_32x32x16_bf16 v[64:79], a[232:235], a[208:211], v[64:79]
  s_waitcnt vmcnt(16)
  ds_read_b64_tr_b16 a[224:225], v12 offset:4096
  ds_read_b64_tr_b16 a[226:227], v12 offset:5120
  v_mul_f32 v46, v190, v46
  v_fma_f32 v47, v47, v30, v30
  v_mfma_f32_32x32x16_bf16 v[80:95], a[232:235], a[212:215], v[80:95]
  ds_read_b64_tr_b16 a[228:229], v13 offset:4096
  ds_read_b64_tr_b16 a[230:231], v13 offset:5120
  v_rcp_f32 v47, v47
  s_waitcnt lgkmcnt(4)
  v_mfma_f32_32x32x16_bf16 v[96:111], a[236:239], a[208:211], v[96:111]
  s_add_u32 m0, s41, 2048
  s_add_u32 s42, s34, 128
  buffer_load_dwordx4 v8, s[12:15], s42 offen lds
  buffer_load_dwordx4 v9, s[12:15], s42 offen offset:1024 lds
  v_mul_f32 v47, v191, v47
  v_mfma_f32_32x32x16_bf16 v[112:127], a[236:239], a[212:215], v[112:127]
  s_waitcnt lgkmcnt(2)
  v_mfma_f32_32x32x16_bf16 v[64:79], a[224:227], a[216:219], v[64:79]
  s_waitcnt vmcnt(16)
  ds_read_b64_tr_b16 a[232:233], v12 offset:6144
  ds_read_b64_tr_b16 a[234:235], v12 offset:7168
  v_cvt_pk_bf16_f32 v55, v46, v47
  ds_write_b128 v23, v[52:55] offset:44032
  s_waitcnt lgkmcnt(0)
  s_barrier
  v_mfma_f32_32x32x16_bf16 v[80:95], a[224:227], a[220:223], v[80:95]
  ds_read_b64_tr_b16 a[236:237], v13 offset:6144
  ds_read_b64_tr_b16 a[238:239], v13 offset:7168
  ds_read_b128 v[128:131], v14 offset:6144
  ds_read_b128 v[132:135], v14 offset:43008
  ds_read_b128 v[136:139], v14 offset:7168
  ds_read_b128 v[140:143], v14 offset:44032
  v_mfma_f32_32x32x16_bf16 v[96:111], a[228:231], a[216:219], v[96:111]
  s_add_u32 m0, s41, 4096
  s_add_u32 s42, s31, 128
  buffer_load_dwordx4 v8, s[12:15], s42 offen lds
  buffer_load_dwordx4 v9, s[12:15], s42 offen offset:1024 lds
  ds_read_b128 v[144:147], v15 offset:6144
  ds_read_b128 v[148:151], v15 offset:43008
  ds_read_b128 v[152:155], v15 offset:7168
  v_mfma_f32_32x32x16_bf16 v[112:127], a[228:231], a[220:223], v[112:127]
  ds_read_b128 v[156:159], v15 offset:44032
  ds_read_b128 v[160:163], v16 offset:6144
  ds_read_b128 v[164:167], v16 offset:43008
  ds_read_b128 v[168:171], v16 offset:7168
  ds_read_b128 v[172:175], v16 offset:44032
  ds_read_b128 v[176:179], v17 offset:6144
  s_waitcnt lgkmcnt(12)
  v_mfma_f32_32x32x16_bf16 v[64:79], a[232:235], v[128:131], v[64:79]
  s_waitcnt vmcnt(16)
  ds_read_b64_tr_b16 a[224:225], v12 offset:8192
  ds_read_b64_tr_b16 a[226:227], v12 offset:9216
  ds_read_b128 v[180:183], v17 offset:43008
  ds_read_b128 v[184:187], v17 offset:7168
  ds_read_b128 v[188:191], v17 offset:44032
  s_waitcnt lgkmcnt(15)
  v_mfma_f32_32x32x16_bf16 v[80:95], a[232:235], v[132:135], v[80:95]
  ds_read_b64_tr_b16 a[228:229], v13 offset:8192
  ds_read_b64_tr_b16 a[230:231], v13 offset:9216
  s_waitcnt lgkmcnt(0)
  s_barrier
  v_mfma_f32_32x32x16_bf16 v[96:111], a[236:239], v[128:131], v[96:111]
  s_add_u32 m0, s41, 6144
  s_add_u32 s42, s31, 18560
  buffer_load_dwordx4 v8, s[12:15], s42 offen lds
  buffer_load_dwordx4 v9, s[12:15], s42 offen offset:1024 lds
  v_mfma_f32_32x32x16_bf16 v[112:127], a[236:239], v[132:135], v[112:127]
  v_mfma_f32_32x32x16_bf16 v[64:79], a[224:227], v[136:139], v[64:79]
  s_waitcnt vmcnt(16)
  ds_read_b64_tr_b16 a[232:233], v12 offset:10240
  ds_read_b64_tr_b16 a[234:235], v12 offset:11264
  v_mfma_f32_32x32x16_bf16 v[80:95], a[224:227], v[140:143], v[80:95]
  ds_read_b64_tr_b16 a[236:237], v13 offset:10240
  ds_read_b64_tr_b16 a[238:239], v13 offset:11264
  v_mfma_f32_32x32x16_bf16 v[96:111], a[228:231], v[136:139], v[96:111]
  s_add_u32 m0, s41, 8192
  s_add_u32 s42, s31, 36992
  buffer_load_dwordx4 v8, s[12:15], s42 offen lds
  buffer_load_dwordx4 v9, s[12:15], s42 offen offset:1024 lds
  v_mfma_f32_32x32x16_bf16 v[112:127], a[228:231], v[140:143], v[112:127]
  s_waitcnt lgkmcnt(2)
  v_mfma_f32_32x32x16_bf16 v[64:79], a[232:235], v[144:147], v[64:79]
  s_waitcnt vmcnt(16)
  ds_read_b64_tr_b16 a[224:225], v12 offset:12288
  ds_read_b64_tr_b16 a[226:227], v12 offset:13312
  v_mfma_f32_32x32x16_bf16 v[80:95], a[232:235], v[148:151], v[80:95]
  ds_read_b64_tr_b16 a[228:229], v13 offset:12288
  ds_read_b64_tr_b16 a[230:231], v13 offset:13312
  s_waitcnt lgkmcnt(4)
  v_mfma_f32_32x32x16_bf16 v[96:111], a[236:239], v[144:147], v[96:111]
  s_add_u32 m0, s41, 10240
  s_add_u32 s42, s31, 55424
  buffer_load_dwordx4 v8, s[12:15], s42 offen lds
  buffer_load_dwordx4 v9, s[12:15], s42 offen offset:1024 lds
  v_mfma_f32_32x32x16_bf16 v[112:127], a[236:239], v[148:151], v[112:127]
  s_waitcnt lgkmcnt(2)
  v_mfma_f32_32x32x16_bf16 v[64:79], a[224:227], v[152:155], v[64:79]
  s_waitcnt vmcnt(16)
  ds_read_b64_tr_b16 a[232:233], v12 offset:14336
  ds_read_b64_tr_b16 a[234:235], v12 offset:15360
  v_mfma_f32_32x32x16_bf16 v[80:95], a[224:227], v[156:159], v[80:95]
  ds_read_b64_tr_b16 a[236:237], v13 offset:14336
  ds_read_b64_tr_b16 a[238:239], v13 offset:15360
  s_waitcnt lgkmcnt(4)
  v_mfma_f32_32x32x16_bf16 v[96:111], a[228:231], v[152:155], v[96:111]
  s_add_u32 m0, s41, 12288
  s_add_u32 s42, s35, 128
  buffer_load_dwordx4 v8, s[12:15], s42 offen lds
  buffer_load_dwordx4 v9, s[12:15], s42 offen offset:1024 lds
  v_mfma_f32_32x32x16_bf16 v[112:127], a[228:231], v[156:159], v[112:127]
  s_waitcnt lgkmcnt(2)
  v_mfma_f32_32x32x16_bf16 v[64:79], a[232:235], v[160:163], v[64:79]
  s_waitcnt vmcnt(16)
  ds_read_b64_tr_b16 a[224:225], v12 offset:16384
  ds_read_b64_tr_b16 a[226:227], v12 offset:17408
  v_mfma_f32_32x32x16_bf16 v[80:95], a[232:235], v[164:167], v[80:95]
  ds_read_b64_tr_b16 a[228:229], v13 offset:16384
  ds_read_b64_tr_b16 a[230:231], v13 offset:17408
  s_waitcnt lgkmcnt(4)
  v_mfma_f32_32x32x16_bf16 v[96:111], a[236:239], v[160:163], v[96:111]
  s_add_u32 m0, s41, 14336
  s_add_u32 s42, s56, 128
  buffer_load_dwordx4 v8, s[12:15], s42 offen lds
  buffer_load_dwordx4 v9, s[12:15], s42 offen offset:1024 lds
  v_mfma_f32_32x32x16_bf16 v[112:127], a[236:239], v[164:167], v[112:127]
  s_waitcnt lgkmcnt(2)
  v_mfma_f32_32x32x16_bf16 v[64:79], a[224:227], v[168:171], v[64:79]
  s_waitcnt vmcnt(16)
  ds_read_b64_tr_b16 a[232:233], v12 offset:18432
  ds_read_b64_tr_b16 a[234:235], v12 offset:19456
  v_mfma_f32_32x32x16_bf16 v[80:95], a[224:227], v[172:175], v[80:95]
  ds_read_b64_tr_b16 a[236:237], v13 offset:18432
  ds_read_b64_tr_b16 a[238:239], v13 offset:19456
  s_waitcnt lgkmcnt(4)
  v_mfma_f32_32x32x16_bf16 v[96:111], a[228:231], v[168:171], v[96:111]
  s_add_u32 m0, s41, 16384
  s_add_u32 s42, s56, 18560
  buffer_load_dwordx4 v8, s[12:15], s42 offen lds
  buffer_load_dwordx4 v9, s[12:15], s42 offen offset:1024 lds
  v_mfma_f32_32x32x16_bf16 v[112:127], a[228:231], v[172:175], v[112:127]
  s_waitcnt lgkmcnt(2)
  v_mfma_f32_32x32x16_bf16 v[64:79], a[232:235], v[176:179], v[64:79]
  s_waitcnt vmcnt(16)
  ds_read_b64_tr_b16 a[224:225], v12 offset:0
  ds_read_b64_tr_b16 a[226:227], v12 offset:1024
  v_mfma_f32_32x32x16_bf16 v[80:95], a[232:235], v[180:183], v[80:95]
  ds_read_b64_tr_b16 a[228:229], v13 offset:0
  ds_read_b64_tr_b16 a[230:231], v13 offset:1024
  s_waitcnt lgkmcnt(4)
  v_mfma_f32_32x32x16_bf16 v[96:111], a[236:239], v[176:179], v[96:111]
  s_add_u32 m0, s41, 18432
  s_add_u32 s42, s57, 128
  buffer_load_dwordx4 v8, s[12:15], s42 offen lds
  buffer_load_dwordx4 v9, s[12:15], s42 offen offset:1024 lds
  v_mfma_f32_32x32x16_bf16 v[112:127], a[236:239], v[180:183], v[112:127]
  s_waitcnt lgkmcnt(2)
  v_mfma_f32_32x32x16_bf16 v[64:79], a[224:227], v[184:187], v[64:79]
  s_waitcnt vmcnt(16)
  ds_read_b64_tr_b16 a[232:233], v12 offset:2048
  ds_read_b64_tr_b16 a[234:235], v12 offset:3072
  v_mfma_f32_32x32x16_bf16 v[80:95], a[224:227], v[188:191], v[80:95]
  ds_read_b64_tr_b16 a[236:237], v13 offset:2048
  ds_read_b64_tr_b16 a[238:239], v13 offset:3072
  s_waitcnt lgkmcnt(4)
  v_mfma_f32_32x32x16_bf16 v[96:111], a[228:231], v[184:187], v[96:111]
  s_add_u32 m0, s41, 0
  s_add_u32 s42, s57, 18560
  buffer_load_dwordx4 v8, s[12:15], s42 offen lds
  buffer_load_dwordx4 v9, s[12:15], s42 offen offset:1024 lds
  v_mfma_f32_32x32x16_bf16 v[112:127], a[228:231], v[188:191], v[112:127]
  s_waitcnt lgkmcnt(2)
  v_mfma_f32_32x32x16_bf16 v[192:207], a[232:235], a[112:115], v[192:207]
  s_waitcnt vmcnt(16)
  ds_read_b64_tr_b16 a[224:225], v12 offset:4096
  ds_read_b64_tr_b16 a[226:227], v12 offset:5120
  v_cvt_pk_f16_f32 v56, v64, v65
  v_cvt_pk_f16_f32 v57, v66, v67
  v_cvt_pk_f16_f32 v58, v80, v81
  v_cvt_pk_f16_f32 v59, v82, v83
  v_mfma_f32_32x32x16_bf16 v[208:223], a[232:235], a[116:119], v[208:223]
  ds_read_b64_tr_b16 a[228:229], v13 offset:4096
  ds_read_b64_tr_b16 a[230:231], v13 offset:5120
  s_add_u32 s44, s39, 0
  buffer_store_dwordx4 v[56:59], v25, s[16:19], s44 offen nt
  s_waitcnt lgkmcnt(4)
  v_mfma_f32_32x32x16_bf16 v[224:239], a[236:239], a[112:115], v[224:239]
  s_add_u32 m0, s41, 2048
  s_add_u32 s42, s58, 128
  buffer_load_dwordx4 v8, s[12:15], s42 offen lds
  buffer_load_dwordx4 v9, s[12:15], s42 offen offset:1024 lds
  v_mfma_f32_32x32x16_bf16 v[240:255], a[236:239], a[116:119], v[240:255]
  s_waitcnt lgkmcnt(2)
  v_mfma_f32_32x32x16_bf16 v[192:207], a[224:227], a[120:123], v[192:207]
  s_waitcnt vmcnt(17)
  ds_read_b64_tr_b16 a[232:233], v12 offset:6144
  ds_read_b64_tr_b16 a[234:235], v12 offset:7168
  v_mfma_f32_32x32x16_bf16 v[208:223], a[224:227], a[124:127], v[208:223]
  ds_read_b64_tr_b16 a[236:237], v13 offset:6144
  ds_read_b64_tr_b16 a[238:239], v13 offset:7168
  s_waitcnt lgkmcnt(4)
  v_mfma_f32_32x32x16_bf16 v[224:239], a[228:231], a[120:123], v[224:239]
  s_add_u32 m0, s41, 4096
  s_add_u32 s42, s58, 18560
  buffer_load_dwordx4 v8, s[12:15], s42 offen lds
  buffer_load_dwordx4 v9, s[12:15], s42 offen offset:1024 lds
  v_mfma_f32_32x32x16_bf16 v[240:255], a[228:231], a[124:127], v[240:255]
  s_waitcnt lgkmcnt(2)
  v_mfma_f32_32x32x16_bf16 v[192:207], a[232:235], a[128:131], v[192:207]
  s_waitcnt vmcnt(17)
  ds_read_b64_tr_b16 a[224:225], v12 offset:8192
  ds_read_b64_tr_b16 a[226:227], v12 offset:9216
  v_cvt_pk_f16_f32 v60, v68, v69
  v_cvt_pk_f16_f32 v61, v70, v71
  v_cvt_pk_f16_f32 v62, v84, v85
  v_cvt_pk_f16_f32 v63, v86, v87
  v_mfma_f32_32x32x16_bf16 v[208:223], a[232:235], a[132:135], v[208:223]
  ds_read_b64_tr_b16 a[228:229], v13 offset:8192
  ds_read_b64_tr_b16 a[230:231], v13 offset:9216
  s_add_u32 s44, s39, 262144
  buffer_store_dwordx4 v[60:63], v25, s[16:19], s44 offen nt
  s_waitcnt lgkmcnt(4)
  v_mfma_f32_32x32x16_bf16 v[224:239], a[236:239], a[128:131], v[224:239]
  s_add_u32 m0, s41, 6144
  s_add_u32 s42, s59, 128
  buffer_load_dwordx4 v8, s[12:15], s42 offen lds
  buffer_load_dwordx4 v9, s[12:15], s42 offen offset:1024 lds
  v_mfma_f32_32x32x16_bf16 v[240:255], a[236:239], a[132:135], v[240:255]
  s_waitcnt lgkmcnt(2)
  v_mfma_f32_32x32x16_bf16 v[192:207], a[224:227], a[136:139], v[192:207]
  s_waitcnt vmcnt(18)
  ds_read_b64_tr_b16 a[232:233], v12 offset:10240
  ds_read_b64_tr_b16 a[234:235], v12 offset:11264
  v_mfma_f32_32x32x16_bf16 v[208:223], a[224:227], a[140:143], v[208:223]
  ds_read_b64_tr_b16 a[236:237], v13 offset:10240
  ds_read_b64_tr_b16 a[238:239], v13 offset:11264
  s_waitcnt lgkmcnt(4)
  v_mfma_f32_32x32x16_bf16 v[224:239], a[228:231], a[136:139], v[224:239]
  s_add_u32 m0, s41, 8192
  s_add_u32 s42, s59, 18560
  buffer_load_dwordx4 v8, s[12:15], s42 offen lds
  buffer_load_dwordx4 v9, s[12:15], s42 offen offset:1024 lds
  v_mfma_f32_32x32x16_bf16 v[240:255], a[228:231], a[140:143], v[240:255]
  s_waitcnt lgkmcnt(2)
  v_mfma_f32_32x32x16_bf16 v[192:207], a[232:235], a[144:147], v[192:207]
  s_waitcnt vmcnt(18)
  ds_read_b64_tr_b16 a[224:225], v12 offset:12288
  ds_read_b64_tr_b16 a[226:227], v12 offset:13312
  v_mfma_f32_32x32x16_bf16 v[208:223], a[232:235], a[148:151], v[208:223]
  ds_read_b64_tr_b16 a[228:229], v13 offset:12288
  ds_read_b64_tr_b16 a[230:231], v13 offset:13312
  s_waitcnt lgkmcnt(4)
  v_mfma_f32_32x32x16_bf16 v[224:239], a[236:239], a[144:147], v[224:239]
  s_add_u32 m0, s41, 10240
  s_add_u32 s42, s56, 36992
  buffer_load_dwordx4 v8, s[12:15], s42 offen lds
  buffer_load_dwordx4 v9, s[12:15], s42 offen offset:1024 lds
  v_mfma_f32_32x32x16_bf16 v[240:255], a[236:239], a[148:151], v[240:255]
  s_waitcnt lgkmcnt(2)
  v_mfma_f32_32x32x16_bf16 v[192:207], a[224:227], a[152:155], v[192:207]
  s_waitcnt vmcnt(18)
  ds_read_b64_tr_b16 a[232:233], v12 offset:14336
  ds_read_b64_tr_b16 a[234:235], v12 offset:15360
  v_cvt_pk_f16_f32 v48, v72, v73
  v_cvt_pk_f16_f32 v49, v74, v75
  v_cvt_pk_f16_f32 v50, v88, v89
  v_cvt_pk_f16_f32 v51, v90, v91
  v_mfma_f32_32x32x16_bf16 v[208:223], a[224:227], a[156:159], v[208:223]
  ds_read_b64_tr_b16 a[236:237], v13 offset:14336
  ds_read_b64_tr_b16 a[238:239], v13 offset:15360
  s_add_u32 s44, s39, 524288
  buffer_store_dwordx4 v[48:51], v25, s[16:19], s44 offen nt
  s_waitcnt lgkmcnt(4)
  v_mfma_f32_32x32x16_bf16 v[224:239], a[228:231], a[152:155], v[224:239]
  s_add_u32 m0, s41, 12288
  s_add_u32 s42, s56, 55424
  buffer_load_dwordx4 v8, s[12:15], s42 offen lds
  buffer_load_dwordx4 v9, s[12:15], s42 offen offset:1024 lds
  v_mfma_f32_32x32x16_bf16 v[240:255], a[228:231], a[156:159], v[240:255]
  s_waitcnt lgkmcnt(2)
  v_mfma_f32_32x32x16_bf16 v[192:207], a[232:235], a[160:163], v[192:207]
  s_waitcnt vmcnt(19)
  ds_read_b64_tr_b16 a[224:225], v12 offset:16384
  ds_read_b64_tr_b16 a[226:227], v12 offset:17408
  v_mfma_f32_32x32x16_bf16 v[208:223], a[232:235], a[164:167], v[208:223]
  ds_read_b64_tr_b16 a[228:229], v13 offset:16384
  ds_read_b64_tr_b16 a[230:231], v13 offset:17408
  s_waitcnt lgkmcnt(4)
  v_mfma_f32_32x32x16_bf16 v[224:239], a[236:239], a[160:163], v[224:239]
  s_add_u32 m0, s41, 14336
  s_add_u32 s42, s57, 36992
  buffer_load_dwordx4 v8, s[12:15], s42 offen lds
  buffer_load_dwordx4 v9, s[12:15], s42 offen offset:1024 lds
  v_mfma_f32_32x32x16_bf16 v[240:255], a[236:239], a[164:167], v[240:255]
  s_waitcnt lgkmcnt(2)
  v_mfma_f32_32x32x16_bf16 v[192:207], a[224:227], a[168:171], v[192:207]
  s_waitcnt vmcnt(19)
  ds_read_b64_tr_b16 a[232:233], v12 offset:18432
  ds_read_b64_tr_b16 a[234:235], v12 offset:19456
  v_cvt_pk_f16_f32 v52, v76, v77
  v_cvt_pk_f16_f32 v53, v78, v79
  v_cvt_pk_f16_f32 v54, v92, v93
  v_cvt_pk_f16_f32 v55, v94, v95
  v_mfma_f32_32x32x16_bf16 v[208:223], a[224:227], a[172:175], v[208:223]
  ds_read_b64_tr_b16 a[236:237], v13 offset:18432
  ds_read_b64_tr_b16 a[238:239], v13 offset:19456
  s_add_u32 s44, s39, 786432
  buffer_store_dwordx4 v[52:55], v25, s[16:19], s44 offen nt
  s_waitcnt lgkmcnt(4)
  v_mfma_f32_32x32x16_bf16 v[224:239], a[228:231], a[168:171], v[224:239]
  s_add_u32 m0, s41, 16384
  s_add_u32 s42, s57, 55424
  buffer_load_dwordx4 v8, s[12:15], s42 offen lds
  buffer_load_dwordx4 v9, s[12:15], s42 offen offset:1024 lds
  v_mfma_f32_32x32x16_bf16 v[240:255], a[228:231], a[172:175], v[240:255]
  s_waitcnt lgkmcnt(2)
  v_mfma_f32_32x32x16_bf16 v[192:207], a[232:235], a[176:179], v[192:207]
  s_waitcnt vmcnt(20)
  ds_read_b64_tr_b16 a[224:225], v12 offset:0
  ds_read_b64_tr_b16 a[226:227], v12 offset:1024
  v_mfma_f32_32x32x16_bf16 v[208:223], a[232:235], a[180:183], v[208:223]
  ds_read_b64_tr_b16 a[228:229], v13 offset:0
  ds_read_b64_tr_b16 a[230:231], v13 offset:1024
  s_waitcnt lgkmcnt(4)
  v_mfma_f32_32x32x16_bf16 v[224:239], a[236:239], a[176:179], v[224:239]
  s_add_u32 m0, s41, 18432
  s_add_u32 s42, s58, 36992
  buffer_load_dwordx4 v8, s[12:15], s42 offen lds
  buffer_load_dwordx4 v9, s[12:15], s42 offen offset:1024 lds
  v_mfma_f32_32x32x16_bf16 v[240:255], a[236:239], a[180:183], v[240:255]
  s_waitcnt lgkmcnt(2)
  v_mfma_f32_32x32x16_bf16 v[192:207], a[224:227], a[184:187], v[192:207]
  s_waitcnt vmcnt(19)
  ds_read_b64_tr_b16 a[232:233], v12 offset:2048
  ds_read_b64_tr_b16 a[234:235], v12 offset:3072
  v_mfma_f32_32x32x16_bf16 v[208:223], a[224:227], a[188:191], v[208:223]
  ds_read_b64_tr_b16 a[236:237], v13 offset:2048
  ds_read_b64_tr_b16 a[238:239], v13 offset:3072
  s_waitcnt lgkmcnt(4)
  v_mfma_f32_32x32x16_bf16 v[224:239], a[228:231], a[184:187], v[224:239]
  s_add_u32 m0, s41, 0
  s_add_u32 s42, s58, 55424
  buffer_load_dwordx4 v8, s[12:15], s42 offen lds
  buffer_load_dwordx4 v9, s[12:15], s42 offen offset:1024 lds
  v_mfma_f32_32x32x16_bf16 v[240:255], a[228:231], a[188:191], v[240:255]
  s_waitcnt lgkmcnt(2)
  v_mfma_f32_32x32x16_bf16 v[192:207], a[232:235], a[192:195], v[192:207]
  s_waitcnt vmcnt(19)
  ds_read_b64_tr_b16 a[224:225], v12 offset:4096
  ds_read_b64_tr_b16 a[226:227], v12 offset:5120
  v_cvt_pk_f16_f32 v56, v96, v97
  v_cvt_pk_f16_f32 v57, v98, v99
  v_cvt_pk_f16_f32 v58, v112, v113
  v_cvt_pk_f16_f32 v59, v114, v115
  v_mfma_f32_32x32x16_bf16 v[208:223], a[232:235], a[196:199], v[208:223]
  ds_read_b64_tr_b16 a[228:229], v13 offset:4096
  ds_read_b64_tr_b16 a[230:231], v13 offset:5120
  s_add_u32 s44, s39, 1048576
  buffer_store_dwordx4 v[56:59], v25, s[16:19], s44 offen nt
  s_waitcnt lgkmcnt(4)
  v_mfma_f32_32x32x16_bf16 v[224:239], a[236:239], a[192:195], v[224:239]
  s_add_u32 m0, s41, 2048
  s_add_u32 s42, s59, 36992
  buffer_load_dwordx4 v8, s[12:15], s42 offen lds
  buffer_load_dwordx4 v9, s[12:15], s42 offen offset:1024 lds
  v_mfma_f32_32x32x16_bf16 v[240:255], a[236:239], a[196:199], v[240:255]
  s_waitcnt lgkmcnt(2)
  v_mfma_f32_32x32x16_bf16 v[192:207], a[224:227], a[200:203], v[192:207]
  s_waitcnt vmcnt(19)
  ds_read_b64_tr_b16 a[232:233], v12 offset:6144
  ds_read_b64_tr_b16 a[234:235], v12 offset:7168
  v_mfma_f32_32x32x16_bf16 v[208:223], a[224:227], a[204:207], v[208:223]
  ds_read_b64_tr_b16 a[236:237], v13 offset:6144
  ds_read_b64_tr_b16 a[238:239], v13 offset:7168
  s_waitcnt lgkmcnt(4)
  v_mfma_f32_32x32x16_bf16 v[224:239], a[228:231], a[200:203], v[224:239]
  s_add_u32 m0, s41, 4096
  s_add_u32 s42, s59, 55424
  buffer_load_dwordx4 v8, s[12:15], s42 offen lds
  buffer_load_dwordx4 v9, s[12:15], s42 offen offset:1024 lds
  v_mfma_f32_32x32x16_bf16 v[240:255], a[228:231], a[204:207], v[240:255]
  s_waitcnt lgkmcnt(2)
  v_mfma_f32_32x32x16_bf16 v[192:207], a[232:235], a[208:211], v[192:207]
  s_waitcnt vmcnt(19)
  ds_read_b64_tr_b16 a[224:225], v12 offset:8192
  ds_read_b64_tr_b16 a[226:227], v12 offset:9216
  v_cvt_pk_f16_f32 v60, v100, v101
  v_cvt_pk_f16_f32 v61, v102, v103
  v_cvt_pk_f16_f32 v62, v116, v117
  v_cvt_pk_f16_f32 v63, v118, v119
  v_mfma_f32_32x32x16_bf16 v[208:223], a[232:235], a[212:215], v[208:223]
  ds_read_b64_tr_b16 a[228:229], v13 offset:8192
  ds_read_b64_tr_b16 a[230:231], v13 offset:9216
  s_add_u32 s44, s39, 1310720
  buffer_store_dwordx4 v[60:63], v25, s[16:19], s44 offen nt
  s_waitcnt lgkmcnt(4)
  v_mfma_f32_32x32x16_bf16 v[224:239], a[236:239], a[208:211], v[224:239]
  s_add_u32 m0, s41, 6144
  s_add_u32 s42, s37, 0
  buffer_load_dwordx4 v8, s[12:15], s42 offen lds
  buffer_load_dwordx4 v9, s[12:15], s42 offen offset:1024 lds
  v_mfma_f32_32x32x16_bf16 v[240:255], a[236:239], a[212:215], v[240:255]
  s_waitcnt lgkmcnt(2)
  v_mfma_f32_32x32x16_bf16 v[192:207], a[224:227], a[216:219], v[192:207]
  s_waitcnt vmcnt(20)
  ds_read_b64_tr_b16 a[232:233], v12 offset:10240
  ds_read_b64_tr_b16 a[234:235], v12 offset:11264
  v_mfma_f32_32x32x16_bf16 v[208:223], a[224:227], a[220:223], v[208:223]
  ds_read_b64_tr_b16 a[236:237], v13 offset:10240
  ds_read_b64_tr_b16 a[238:239], v13 offset:11264
  s_waitcnt lgkmcnt(4)
  v_mfma_f32_32x32x16_bf16 v[224:239], a[228:231], a[216:219], v[224:239]
  s_add_u32 m0, s41, 8192
  s_add_u32 s42, s37, 18432
  buffer_load_dwordx4 v8, s[12:15], s42 offen lds
  buffer_load_dwordx4 v9, s[12:15], s42 offen offset:1024 lds
  v_mfma_f32_32x32x16_bf16 v[240:255], a[228:231], a[220:223], v[240:255]
  s_waitcnt lgkmcnt(2)
  v_mfma_f32_32x32x16_bf16 v[192:207], a[232:235], v[128:131], v[192:207]
  s_waitcnt vmcnt(19)
  ds_read_b64_tr_b16 a[224:225], v12 offset:12288
  ds_read_b64_tr_b16 a[226:227], v12 offset:13312
  v_mfma_f32_32x32x16_bf16 v[208:223], a[232:235], v[132:135], v[208:223]
  ds_read_b64_tr_b16 a[228:229], v13 offset:12288
  ds_read_b64_tr_b16 a[230:231], v13 offset:13312
  s_waitcnt lgkmcnt(4)
  v_mfma_f32_32x32x16_bf16 v[224:239], a[236:239], v[128:131], v[224:239]
  s_add_u32 m0, s41, 10240
  s_add_u32 s42, s37, 36864
  buffer_load_dwordx4 v8, s[12:15], s42 offen lds
  buffer_load_dwordx4 v9, s[12:15], s42 offen offset:1024 lds
  v_mfma_f32_32x32x16_bf16 v[240:255], a[236:239], v[132:135], v[240:255]
  s_waitcnt lgkmcnt(2)
  v_mfma_f32_32x32x16_bf16 v[192:207], a[224:227], v[136:139], v[192:207]
  s_waitcnt vmcnt(19)
  ds_read_b64_tr_b16 a[232:233], v12 offset:14336
  ds_read_b64_tr_b16 a[234:235], v12 offset:15360
  v_cvt_pk_f16_f32 v48, v104, v105
  v_cvt_pk_f16_f32 v49, v106, v107
  v_cvt_pk_f16_f32 v50, v120, v121
  v_cvt_pk_f16_f32 v51, v122, v123
  v_mfma_f32_32x32x16_bf16 v[208:223], a[224:227], v[140:143], v[208:223]
  ds_read_b64_tr_b16 a[236:237], v13 offset:14336
  ds_read_b64_tr_b16 a[238:239], v13 offset:15360
  s_add_u32 s44, s39, 1572864
  buffer_store_dwordx4 v[48:51], v25, s[16:19], s44 offen nt
  s_waitcnt lgkmcnt(4)
  v_mfma_f32_32x32x16_bf16 v[224:239], a[228:231], v[136:139], v[224:239]
  s_add_u32 m0, s41, 12288
  s_add_u32 s42, s37, 55296
  buffer_load_dwordx4 v8, s[12:15], s42 offen lds
  buffer_load_dwordx4 v9, s[12:15], s42 offen offset:1024 lds
  v_mfma_f32_32x32x16_bf16 v[240:255], a[228:231], v[140:143], v[240:255]
  s_waitcnt lgkmcnt(2)
  v_mfma_f32_32x32x16_bf16 v[192:207], a[232:235], v[144:147], v[192:207]
  s_waitcnt vmcnt(19)
  ds_read_b64_tr_b16 a[224:225], v12 offset:16384
  ds_read_b64_tr_b16 a[226:227], v12 offset:17408
  v_mfma_f32_32x32x16_bf16 v[208:223], a[232:235], v[148:151], v[208:223]
  ds_read_b64_tr_b16 a[228:229], v13 offset:16384
  ds_read_b64_tr_b16 a[230:231], v13 offset:17408
  s_waitcnt lgkmcnt(4)
  v_mfma_f32_32x32x16_bf16 v[224:239], a[236:239], v[144:147], v[224:239]
  s_add_u32 m0, s41, 14336
  s_add_u32 s42, s38, 0
  buffer_load_dwordx4 v8, s[12:15], s42 offen lds
  buffer_load_dwordx4 v9, s[12:15], s42 offen offset:1024 lds
  v_mfma_f32_32x32x16_bf16 v[240:255], a[236:239], v[148:151], v[240:255]
  s_waitcnt lgkmcnt(2)
  v_mfma_f32_32x32x16_bf16 v[192:207], a[224:227], v[152:155], v[192:207]
  s_waitcnt vmcnt(19)
  ds_read_b64_tr_b16 a[232:233], v12 offset:18432
  ds_read_b64_tr_b16 a[234:235], v12 offset:19456
  v_cvt_pk_f16_f32 v52, v108, v109
  v_cvt_pk_f16_f32 v53, v110, v111
  v_cvt_pk_f16_f32 v54, v124, v125
  v_cvt_pk_f16_f32 v55, v126, v127
  v_mfma_f32_32x32x16_bf16 v[208:223], a[224:227], v[156:159], v[208:223]
  ds_read_b64_tr_b16 a[236:237], v13 offset:18432
  ds_read_b64_tr_b16 a[238:239], v13 offset:19456
  s_add_u32 s44, s39, 1835008
  buffer_store_dwordx4 v[52:55], v25, s[16:19], s44 offen nt
  s_waitcnt lgkmcnt(4)
  v_mfma_f32_32x32x16_bf16 v[224:239], a[228:231], v[152:155], v[224:239]
  s_add_u32 m0, s41, 16384
  s_add_u32 s42, s60, 0
  buffer_load_dwordx4 v8, s[12:15], s42 offen lds
  buffer_load_dwordx4 v9, s[12:15], s42 offen offset:1024 lds
  v_mfma_f32_32x32x16_bf16 v[240:255], a[228:231], v[156:159], v[240:255]
  s_waitcnt lgkmcnt(2)
  v_mfma_f32_32x32x16_bf16 v[192:207], a[232:235], v[160:163], v[192:207]
  s_waitcnt vmcnt(20)
  ds_read_b64_tr_b16 a[224:225], v12 offset:0
  ds_read_b64_tr_b16 a[226:227], v12 offset:1024
  v_mfma_f32_32x32x16_bf16 v[208:223], a[232:235], v[164:167], v[208:223]
  ds_read_b64_tr_b16 a[228:229], v13 offset:0
  ds_read_b64_tr_b16 a[230:231], v13 offset:1024
  s_waitcnt lgkmcnt(4)
  v_mfma_f32_32x32x16_bf16 v[224:239], a[236:239], v[160:163], v[224:239]
  s_add_u32 m0, s41, 18432
  s_add_u32 s42, s60, 18432
  buffer_load_dwordx4 v8, s[12:15], s42 offen lds
  buffer_load_dwordx4 v9, s[12:15], s42 offen offset:1024 lds
  v_mfma_f32_32x32x16_bf16 v[240:255], a[236:239], v[164:167], v[240:255]
  s_waitcnt lgkmcnt(2)
  v_mfma_f32_32x32x16_bf16 v[192:207], a[224:227], v[168:171], v[192:207]
  s_waitcnt vmcnt(19)
  ds_read_b64_tr_b16 a[232:233], v12 offset:2048
  ds_read_b64_tr_b16 a[234:235], v12 offset:3072
  v_mfma_f32_32x32x16_bf16 v[208:223], a[224:227], v[172:175], v[208:223]
  ds_read_b64_tr_b16 a[236:237], v13 offset:2048
  ds_read_b64_tr_b16 a[238:239], v13 offset:3072
  s_waitcnt lgkmcnt(4)
  v_mfma_f32_32x32x16_bf16 v[224:239], a[228:231], v[168:171], v[224:239]
  s_add_u32 m0, s41, 0
  s_add_u32 s42, s60, 36864
  buffer_load_dwordx4 v8, s[12:15], s42 offen lds
  buffer_load_dwordx4 v9, s[12:15], s42 offen offset:1024 lds
  v_mfma_f32_32x32x16_bf16 v[240:255], a[228:231], v[172:175], v[240:255]
  s_waitcnt lgkmcnt(2)
  v_mfma_f32_32x32x16_bf16 v[192:207], a[232:235], v[176:179], v[192:207]
  s_waitcnt vmcnt(19)
  ds_read_b64_tr_b16 a[224:225], v12 offset:4096
  ds_read_b64_tr_b16 a[226:227], v12 offset:5120
  v_mfma_f32_32x32x16_bf16 v[208:223], a[232:235], v[180:183], v[208:223]
  ds_read_b64_tr_b16 a[228:229], v13 offset:4096
  ds_read_b64_tr_b16 a[230:231], v13 offset:5120
  s_waitcnt lgkmcnt(4)
  v_mfma_f32_32x32x16_bf16 v[224:239], a[236:239], v[176:179], v[224:239]
  s_add_u32 m0, s41, 2048
  s_add_u32 s42, s60, 55296
  buffer_load_dwordx4 v8, s[12:15], s42 offen lds
  buffer_load_dwordx4 v9, s[12:15], s42 offen offset:1024 lds
  v_mfma_f32_32x32x16_bf16 v[240:255], a[236:239], v[180:183], v[240:255]
  s_waitcnt lgkmcnt(2)
  v_mfma_f32_32x32x16_bf16 v[192:207], a[224:227], v[184:187], v[192:207]
  s_waitcnt vmcnt(18)
  ds_read_b64_tr_b16 a[232:233], v12 offset:6144
  ds_read_b64_tr_b16 a[234:235], v12 offset:7168
  v_mfma_f32_32x32x16_bf16 v[208:223], a[224:227], v[188:191], v[208:223]
  ds_read_b64_tr_b16 a[236:237], v13 offset:6144
  ds_read_b64_tr_b16 a[238:239], v13 offset:7168
  s_waitcnt lgkmcnt(4)
  v_mfma_f32_32x32x16_bf16 v[224:239], a[228:231], v[184:187], v[224:239]
  v_mfma_f32_32x32x16_bf16 v[240:255], a[228:231], v[188:191], v[240:255]
  s_waitcnt lgkmcnt(2)
  v_mfma_f32_32x32x16_bf16 v[64:79], a[232:235], a[0:3], 0
  s_waitcnt vmcnt(16)
  ds_read_b64_tr_b16 a[224:225], v12 offset:8192
  ds_read_b64_tr_b16 a[226:227], v12 offset:9216
  v_cvt_pk_f16_f32 v56, v192, v193
  v_cvt_pk_f16_f32 v57, v194, v195
  s_nop 1
  v_cvt_pk_f16_f32 v58, v208, v209
  v_mfma_f32_32x32x16_bf16 v[80:95], a[232:235], a[4:7], 0
  ds_read_b64_tr_b16 a[228:229], v13 offset:8192
  ds_read_b64_tr_b16 a[230:231], v13 offset:9216
  v_cvt_pk_f16_f32 v59, v210, v211
  s_add_u32 s44, s39, 2097152
  buffer_store_dwordx4 v[56:59], v25, s[16:19], s44 offen nt
  s_waitcnt lgkmcnt(4)
  v_mfma_f32_32x32x16_bf16 v[96:111], a[236:239], a[0:3], 0
  v_mfma_f32_32x32x16_bf16 v[112:127], a[236:239], a[4:7], 0
  s_waitcnt lgkmcnt(2)
  v_mfma_f32_32x32x16_bf16 v[64:79], a[224:227], a[8:11], v[64:79]
  s_waitcnt vmcnt(15)
  ds_read_b64_tr_b16 a[232:233], v12 offset:10240
  ds_read_b64_tr_b16 a[234:235], v12 offset:11264
  v_cvt_pk_f16_f32 v60, v196, v197
  v_cvt_pk_f16_f32 v61, v198, v199
  v_cvt_pk_f16_f32 v62, v212, v213
  v_cvt_pk_f16_f32 v63, v214, v215
  v_mfma_f32_32x32x16_bf16 v[80:95], a[224:227], a[12:15], v[80:95]
  ds_read_b64_tr_b16 a[236:237], v13 offset:10240
  ds_read_b64_tr_b16 a[238:239], v13 offset:11264
  s_add_u32 s44, s39, 2359296
  buffer_store_dwordx4 v[60:63], v25, s[16:19], s44 offen nt
  s_waitcnt lgkmcnt(4)
  v_mfma_f32_32x32x16_bf16 v[96:111], a[228:231], a[8:11], v[96:111]
  v_mfma_f32_32x32x16_bf16 v[112:127], a[228:231], a[12:15], v[112:127]
  s_waitcnt lgkmcnt(2)
  v_mfma_f32_32x32x16_bf16 v[64:79], a[232:235], a[16:19], v[64:79]
  s_waitcnt vmcnt(13)
  ds_read_b64_tr_b16 a[224:225], v12 offset:12288
  ds_read_b64_tr_b16 a[226:227], v12 offset:13312
  v_cvt_pk_f16_f32 v48, v200, v201
  v_cvt_pk_f16_f32 v49, v202, v203
  v_cvt_pk_f16_f32 v50, v216, v217
  v_cvt_pk_f16_f32 v51, v218, v219
  v_mfma_f32_32x32x16_bf16 v[80:95], a[232:235], a[20:23], v[80:95]
  ds_read_b64_tr_b16 a[228:229], v13 offset:12288
  ds_read_b64_tr_b16 a[230:231], v13 offset:13312
  s_add_u32 s44, s39, 2621440
  buffer_store_dwordx4 v[48:51], v25, s[16:19], s44 offen nt
  s_waitcnt lgkmcnt(4)
  v_mfma_f32_32x32x16_bf16 v[96:111], a[236:239], a[16:19], v[96:111]
  v_mfma_f32_32x32x16_bf16 v[112:127], a[236:239], a[20:23], v[112:127]
  s_waitcnt lgkmcnt(2)
  v_mfma_f32_32x32x16_bf16 v[64:79], a[224:227], a[24:27], v[64:79]
  s_waitcnt vmcnt(12)
  ds_read_b64_tr_b16 a[232:233], v12 offset:14336
  ds_read_b64_tr_b16 a[234:235], v12 offset:15360
  v_cvt_pk_f16_f32 v52, v204, v205
  v_cvt_pk_f16_f32 v53, v206, v207
  v_cvt_pk_f16_f32 v54, v220, v221
  v_cvt_pk_f16_f32 v55, v222, v223
  v_mfma_f32_32x32x16_bf16 v[80:95], a[224:227], a[28:31], v[80:95]
  ds_read_b64_tr_b16 a[236:237], v13 offset:14336
  ds_read_b64_tr_b16 a[238:239], v13 offset:15360
  s_add_u32 s44, s39, 2883584
  buffer_store_dwordx4 v[52:55], v25, s[16:19], s44 offen nt
  s_waitcnt lgkmcnt(4)
  v_mfma_f32_32x32x16_bf16 v[96:111], a[228:231], a[24:27], v[96:111]
  v_mfma_f32_32x32x16_bf16 v[112:127], a[228:231], a[28:31], v[112:127]
  s_waitcnt lgkmcnt(2)
  v_mfma_f32_32x32x16_bf16 v[64:79], a[232:235], a[32:35], v[64:79]
  s_waitcnt vmcnt(10)
  ds_read_b64_tr_b16 a[224:225], v12 offset:16384
  ds_read_b64_tr_b16 a[226:227], v12 offset:17408
  v_cvt_pk_f16_f32 v56, v224, v225
  v_cvt_pk_f16_f32 v57, v226, v227
  v_cvt_pk_f16_f32 v58, v240, v241
  v_cvt_pk_f16_f32 v59, v242, v243
  v_mfma_f32_32x32x16_bf16 v[80:95], a[232:235], a[36:39], v[80:95]
  ds_read_b64_tr_b16 a[228:229], v13 offset:16384
  ds_read_b64_tr_b16 a[230:231], v13 offset:17408
  s_add_u32 s44, s39, 3145728
  buffer_store_dwordx4 v[56:59], v25, s[16:19], s44 offen nt
  s_waitcnt lgkmcnt(4)
  v_mfma_f32_32x32x16_bf16 v[96:111], a[236:239], a[32:35], v[96:111]
  v_mfma_f32_32x32x16_bf16 v[112:127], a[236:239], a[36:39], v[112:127]
  s_waitcnt lgkmcnt(2)
  v_mfma_f32_32x32x16_bf16 v[64:79], a[224:227], a[160:163], v[64:79]
  s_waitcnt vmcnt(9)
  ds_read_b64_tr_b16 a[232:233], v12 offset:18432
  ds_read_b64_tr_b16 a[234:235], v12 offset:19456
  v_cvt_pk_f16_f32 v60, v228, v229
  v_cvt_pk_f16_f32 v61, v230, v231
  v_cvt_pk_f16_f32 v62, v244, v245
  v_cvt_pk_f16_f32 v63, v246, v247
  v_mfma_f32_32x32x16_bf16 v[80:95], a[224:227], a[164:167], v[80:95]
  ds_read_b64_tr_b16 a[236:237], v13 offset:18432
  ds_read_b64_tr_b16 a[238:239], v13 offset:19456
  s_add_u32 s44, s39, 3407872
  buffer_store_dwordx4 v[60:63], v25, s[16:19], s44 offen nt
  s_waitcnt lgkmcnt(4)
  v_mfma_f32_32x32x16_bf16 v[96:111], a[228:231], a[160:163], v[96:111]
  v_mfma_f32_32x32x16_bf16 v[112:127], a[228:231], a[164:167], v[112:127]
  s_waitcnt lgkmcnt(2)
  v_mfma_f32_32x32x16_bf16 v[64:79], a[232:235], a[168:171], v[64:79]
  s_waitcnt vmcnt(8)
  ds_read_b64_tr_b16 a[224:225], v12 offset:0
  ds_read_b64_tr_b16 a[226:227], v12 offset:1024
  v_cvt_pk_f16_f32 v48, v232, v233
  v_cvt_pk_f16_f32 v49, v234, v235
  v_cvt_pk_f16_f32 v50, v248, v249
  v_cvt_pk_f16_f32 v51, v250, v251
  v_mfma_f32_32x32x16_bf16 v[80:95], a[232:235], a[172:175], v[80:95]
  ds_read_b64_tr_b16 a[228:229], v13 offset:0
  ds_read_b64_tr_b16 a[230:231], v13 offset:1024
  s_add_u32 s44, s39, 3670016
  buffer_store_dwordx4 v[48:51], v25, s[16:19], s44 offen nt
  s_waitcnt lgkmcnt(4)
  v_mfma_f32_32x32x16_bf16 v[96:111], a[236:239], a[168:171], v[96:111]
  v_mfma_f32_32x32x16_bf16 v[112:127], a[236:239], a[172:175], v[112:127]
  s_waitcnt lgkmcnt(2)
  v_mfma_f32_32x32x16_bf16 v[64:79], a[224:227], v[128:131], v[64:79]
  s_waitcnt vmcnt(7)
  ds_read_b64_tr_b16 a[232:233], v12 offset:2048
  ds_read_b64_tr_b16 a[234:235], v12 offset:3072
  v_cvt_pk_f16_f32 v52, v236, v237
  v_cvt_pk_f16_f32 v53, v238, v239
  v_cvt_pk_f16_f32 v54, v252, v253
  v_cvt_pk_f16_f32 v55, v254, v255
  v_mfma_f32_32x32x16_bf16 v[80:95], a[224:227], v[132:135], v[80:95]
  ds_read_b64_tr_b16 a[236:237], v13 offset:2048
  ds_read_b64_tr_b16 a[238:239], v13 offset:3072
  s_add_u32 s44, s39, 3932160
  buffer_store_dwordx4 v[52:55], v25, s[16:19], s44 offen nt
  s_waitcnt lgkmcnt(4)
  v_mfma_f32_32x32x16_bf16 v[96:111], a[228:231], v[128:131], v[96:111]
  v_mfma_f32_32x32x16_bf16 v[112:127], a[228:231], v[132:135], v[112:127]
  s_waitcnt lgkmcnt(2)
  v_mfma_f32_32x32x16_bf16 v[64:79], a[232:235], v[136:139], v[64:79]
  v_mfma_f32_32x32x16_bf16 v[80:95], a[232:235], v[140:143], v[80:95]
  s_waitcnt lgkmcnt(0)
  v_mfma_f32_32x32x16_bf16 v[96:111], a[236:239], v[136:139], v[96:111]
  v_mfma_f32_32x32x16_bf16 v[112:127], a[236:239], v[140:143], v[112:127]
  v_add_u32 v22, s62, v3
  s_nop 8
  ds_write_b128 v22, v[64:67] offset:0
  ds_write_b128 v22, v[68:71] offset:1024
  ds_write_b128 v22, v[72:75] offset:2048
  ds_write_b128 v22, v[76:79] offset:3072
  ds_write_b128 v22, v[80:83] offset:4096
  ds_write_b128 v22, v[84:87] offset:5120
  ds_write_b128 v22, v[88:91] offset:6144
  ds_write_b128 v22, v[92:95] offset:7168
  ds_write_b128 v22, v[96:99] offset:8192
  ds_write_b128 v22, v[100:103] offset:9216
  ds_write_b128 v22, v[104:107] offset:10240
  ds_write_b128 v22, v[108:111] offset:11264
  ds_write_b128 v22, v[112:115] offset:12288
  ds_write_b128 v22, v[116:119] offset:13312
  ds_write_b128 v22, v[120:123] offset:14336
  ds_write_b128 v22, v[124:127] offset:15360
  s_waitcnt lgkmcnt(0)
  s_barrier
  v_add_u32 v22, s63, v3
  ds_read_b128 v[64:67], v22 offset:0
  ds_read_b128 v[68:71], v22 offset:1024
  ds_read_b128 v[72:75], v22 offset:4096
  ds_read_b128 v[76:79], v22 offset:5120
  ds_read_b128 v[80:83], v22 offset:16384
  ds_read_b128 v[84:87], v22 offset:17408
  ds_read_b128 v[88:91], v22 offset:20480
  ds_read_b128 v[92:95], v22 offset:21504
  ds_read_b128 v[96:99], v22 offset:36864
  ds_read_b128 v[100:103], v22 offset:37888
  ds_read_b128 v[104:107], v22 offset:40960
  ds_read_b128 v[108:111], v22 offset:41984
  ds_read_b128 v[112:115], v22 offset:53248
  ds_read_b128 v[116:119], v22 offset:54272
  ds_read_b128 v[120:123], v22 offset:57344
  ds_read_b128 v[124:127], v22 offset:58368
  s_waitcnt lgkmcnt(11)
  v_add_f32 v64, v64, v80
  v_add_f32 v65, v65, v81
  v_add_f32 v66, v66, v82
  v_add_f32 v67, v67, v83
  s_waitcnt lgkmcnt(10)
  v_add_f32 v68, v68, v84
  v_add_f32 v69, v69, v85
  v_add_f32 v70, v70, v86
  v_add_f32 v71, v71, v87
  s_waitcnt lgkmcnt(9)
  v_add_f32 v72, v72, v88
  v_add_f32 v73, v73, v89
  v_add_f32 v74, v74, v90
  v_add_f32 v75, v75, v91
  s_waitcnt lgkmcnt(8)
  v_add_f32 v76, v76, v92
  v_add_f32 v77, v77, v93
  v_add_f32 v78, v78, v94
  v_add_f32 v79, v79, v95
  s_waitcnt lgkmcnt(7)
  v_add_f32 v64, v64, v96
  v_add_f32 v65, v65, v97
  v_add_f32 v66, v66, v98
  v_add_f32 v67, v67, v99
  s_waitcnt lgkmcnt(6)
  v_add_f32 v68, v68, v100
  v_add_f32 v69, v69, v101
  v_add_f32 v70, v70, v102
  v_add_f32 v71, v71, v103
  s_waitcnt lgkmcnt(5)
  v_add_f32 v72, v72, v104
  v_add_f32 v73, v73, v105
  v_add_f32 v74, v74, v106
  v_add_f32 v75, v75, v107
  s_waitcnt lgkmcnt(4)
  v_add_f32 v76, v76, v108
  v_add_f32 v77, v77, v109
  v_add_f32 v78, v78, v110
  v_add_f32 v79, v79, v111
  s_waitcnt lgkmcnt(3)
  v_add_f32 v64, v64, v112
  v_add_f32 v65, v65, v113
  v_add_f32 v66, v66, v114
  v_add_f32 v67, v67, v115
  s_waitcnt lgkmcnt(2)
  v_add_f32 v68, v68, v116
  v_add_f32 v69, v69, v117
  v_add_f32 v70, v70, v118
  v_add_f32 v71, v71, v119
  s_waitcnt lgkmcnt(1)
  v_add_f32 v72, v72, v120
  v_add_f32 v73, v73, v121
  v_add_f32 v74, v74, v122
  v_add_f32 v75, v75, v123
  s_waitcnt lgkmcnt(0)
  v_add_f32 v76, v76, v124
  v_add_f32 v77, v77, v125
  v_add_f32 v78, v78, v126
  v_add_f32 v79, v79, v127
  v_cvt_pk_f16_f32 v56, v64, v65
  v_cvt_pk_f16_f32 v57, v66, v67
  v_cvt_pk_f16_f32 v58, v72, v73
  v_cvt_pk_f16_f32 v59, v74, v75
  s_add_u32 s44, s40, 0
  buffer_store_dwordx4 v[56:59], v25, s[16:19], s44 offen sc1
  v_cvt_pk_f16_f32 v60, v68, v69
  v_cvt_pk_f16_f32 v61, v70, v71
  v_cvt_pk_f16_f32 v62, v76, v77
  v_cvt_pk_f16_f32 v63, v78, v79
  s_add_u32 s44, s40, 262144
  buffer_store_dwordx4 v[60:63], v25, s[16:19], s44 offen sc1
ka_end:
  s_endpgm

.globl kb_kernel
.p2align 8
.type kb_kernel,@function
kb_kernel:
  s_cmp_ge_u32 s2, 144
  s_cbranch_scc1 kb_end
  s_load_dwordx16 s[32:47], s[0:1], 0
  s_load_dwordx2 s[48:49], s[0:1], 128
  s_load_dwordx4 s[52:55], s[0:1], 104
  s_load_dwordx2 s[50:51], s[0:1], 64
  v_lshrrev_b32 v1, 6, v0
  v_and_b32 v2, 63, v0
  v_readfirstlane_b32 s20, v1
  s_and_b32 s3, s2, 7
  s_lshr_b32 s4, s2, 3
  s_lshl_b32 s5, s3, 4
  s_add_u32 s5, s5, s4
  s_lshl_b32 s6, s3, 1
  s_add_u32 s6, s6, s4
  s_add_u32 s6, s6, 112
  s_cmp_lt_u32 s4, 16
  s_cselect_b32 s21, s5, s6
  s_and_b32 s22, s20, 3
  s_lshr_b32 s23, s20, 2
  s_lshl_b32 s24, s21, 2
  s_add_u32 s24, s24, s22
  s_lshl_b32 s5, s24, 8
  v_lshl_add_u32 v3, v2, 2, s5
  s_lshl_b32 s5, s24, 1
  v_mov_b32 v4, s5
  v_lshrrev_b32 v156, 4, v0
  v_and_b32 v157, 15, v0
  v_lshlrev_b32 v158, 6, v156
  v_lshl_add_u32 v158, v157, 1, v158
  s_lshl_b32 s6, s21, 14
  v_lshl_add_u32 v190, v158, 3, s6
  v_lshlrev_b32 v189, 3, v158
  v_add_u32 v189, 2359296, v189
  v_lshlrev_b32 v188, 9, v156
  v_lshl_add_u32 v188, v157, 4, v188
  s_mul_i32 s25, s22, 27984
  s_mul_i32 s26, s22, 1808
  s_add_u32 s26, s26, 142912
  s_waitcnt lgkmcnt(0)
  global_load_dword v10, v3, s[34:35]
  global_load_dword v11, v3, s[36:37]
  global_load_dword v12, v3, s[38:39]
  global_load_dword v13, v3, s[40:41]
  global_load_dword v14, v3, s[42:43]
  global_load_dword v15, v3, s[44:45]
  global_load_ushort v16, v4, s[46:47]
  global_load_dwordx4 v[172:175], v190, s[48:49]
  global_load_dwordx4 v[176:179], v190, s[48:49] offset:256
  global_load_dwordx4 v[180:183], v189, s[48:49]
  global_load_dwordx4 v[184:187], v189, s[48:49] offset:256
  s_mov_b32 s8, s48
  s_mov_b32 s9, s49
  s_mov_b32 s10, 268435456
  s_mov_b32 s11, 0x00020000
  s_mov_b32 s12, s54
  s_mov_b32 s13, s55
  s_mov_b32 s14, 2359296
  s_mov_b32 s15, 0x00020000
  s_lshl_b32 s5, s21, 3
  s_add_u32 s56, s50, s5
  s_addc_u32 s57, s51, 0
  s_load_dwordx2 s[16:17], s[56:57], 0
  s_add_u32 s56, s52, s5
  s_addc_u32 s57, s53, 0
  s_load_dwordx2 s[18:19], s[56:57], 0
  s_lshl_b32 s27, s21, 17
  s_add_u32 s27, s27, 10485760
  s_add_u32 s5, s26, 1276
  v_lshlrev_b32 v5, 2, v2
  v_sub_u32 v64, s5, v5
  v_add_u32 v5, 1, v2
  v_lshrrev_b32 v5, 6, v5
  v_lshlrev_b32 v5, 1, v5
  v_sub_u32 v65, v64, v5
  v_mov_b32 v8, 0
  v_mov_b32 v9, s26
  s_mov_b64 exec, 1
  ds_write_b32 v9, v8 offset:1792
  s_mov_b64 exec, -1
  v_and_b32 v6, 15, v2
  s_lshl_b32 s5, s23, 4
  v_add_u32 v6, s5, v6
  v_lshrrev_b32 v7, 4, v2
  v_max_u32 v8, 1, v7
  v_sub_u32 v8, 4, v8
  v_lshlrev_b32 v8, v8, v6
  v_lshlrev_b32 v9, 2, v7
  v_lshlrev_b32 v17, 7, v7
  v_cmp_gt_u32 vcc, 2, v7
  s_nop 1
  v_cndmask_b32 v9, v17, v9, vcc
  v_add_u32 v8, v8, v9
  v_lshl_add_u32 v150, v8, 1, s26
  v_cmp_eq_u32 vcc, 3, v7
  v_mov_b32 v9, 4
  v_mov_b32 v17, 128
  v_cndmask_b32 v9, v9, v17, vcc
  v_add_u32 v151, v150, v9
  v_min_u32 v9, 2, v7
  v_lshlrev_b32 v9, 7, v9
  v_add3_u32 v9, v9, v6, 0
  v_add_u32 v9, 512, v9
  v_lshl_add_u32 v152, v9, 1, s26
  v_and_b32 v8, 15, v2
  v_mul_u32_u24 v8, 528, v8
  v_lshl_add_u32 v8, v7, 4, v8
  v_add_u32 v153, s25, v8
  s_mul_i32 s5, s23, 8448
  s_add_u32 s5, s5, 11088
  v_add_u32 v154, s5, v153
  v_lshl_add_u32 v155, v2, 3, s25
  v_lshlrev_b32 v170, 4, v2
  v_lshrrev_b32 v169, 5, v2
  s_mul_i32 s6, s22, 17664
  s_lshl_b32 s7, s23, 11
  s_add_u32 s6, s6, s7
  v_lshl_add_u32 v160, v2, 5, s6
  v_mov_b32 v144, 0
  v_mov_b32 v145, 0
  v_mov_b32 v146, 0
  v_mov_b32 v147, 0
  s_mul_i32 s6, s22, 13968
  s_mul_i32 s7, s23, 7040
  s_add_u32 s6, s6, s7
  s_add_u32 s6, s6, 70656
  v_add_u32 v161, s6, v170
  v_min_u32 v162, 15, v2
  v_lshl_add_u32 v162, v162, 4, s6
  s_mul_i32 s7, s23, 2304
  s_add_u32 s6, s6, s7
  v_mov_b32 v163, s6
  s_mul_i32 s6, s22, 17664
  s_mul_i32 s7, s23, 8832
  s_add_u32 s6, s6, s7
  v_min_u32 v164, 6, v2
  v_lshl_add_u32 v164, v164, 4, s6
  v_mul_u32_u24 v165, 144, v156
  v_lshl_add_u32 v165, v157, 2, v165
  v_add_u32 v165, 72960, v165
  v_cmp_lt_u32 vcc, 13, v157
  v_mov_b32 v166, 0
  v_mov_b32 v6, 16
  v_cndmask_b32 v166, v166, v6, vcc
  v_add_u32 v166, v165, v166
  v_and_b32 v167, 3, v2
  v_mul_u32_u24 v167, 4416, v167
  v_bfe_u32 v6, v2, 2, 3
  v_add_u32 v6, v6, v169
  v_lshlrev_b32 v6, 4, v6
  v_sub_u32 v167, v167, v6
  s_mul_i32 s6, s22, 17664
  s_lshl_b32 s7, s23, 10
  s_sub_u32 s6, s6, s7
  s_add_u32 s6, s6, 1152
  v_add_u32 v167, s6, v167
  v_bfe_u32 v168, v2, 1, 4
  v_mul_u32_u24 v168, 144, v168
  v_and_b32 v6, 1, v2
  v_xor_b32 v6, 1, v6
  v_mul_u32_u24 v6, 7040, v6
  v_add_u32 v168, v168, v6
  v_lshlrev_b32 v6, 4, v169
  v_sub_u32 v168, v168, v6
  s_mul_i32 s6, s22, 13968
  s_mul_i32 s7, s23, 1152
  s_sub_u32 s6, s6, s7
  s_add_u32 s6, s6, 70656
  v_add_u32 v168, s6, v168
  v_mov_b32 v171, v158
  s_cmp_eq_u32 s23, 0
  s_cbranch_scc1 kb_ga0
  v_sub_u32 v5, 1023, v170
  v_sub_u32 v8, 1022, v170
  v_cvt_f32_u32 v6, v5
  v_cvt_f32_u32 v7, v8
  v_lshl_or_b32 v5, v8, 16, v5
  s_mov_b32 s28, 0xbd80bd80
  s_mov_b32 s29, 0x01000100
  s_mov_b32 s30, 0xfffefffe
  s_mov_b32 s31, 0x03800380
  v_cvt_pk_bf16_f32 v8, v6, v7
  v_pk_min_u16 v9, v5, s29
  v_pk_add_u16 v8, v8, s28
  v_pk_add_f32 v[6:7], v[6:7], -2.0 op_sel_hi:[1,0]
  v_pk_max_i16 v8, v8, v9
  v_pk_add_u16 v5, v5, s30
  v_mad_u32_u16 v64, v8, 2, s26
  v_mad_u32_u16 v65, v8, 2, s26 op_sel:[1,0,0,0]
  v_cvt_pk_bf16_f32 v8, v6, v7
  v_pk_min_u16 v9, v5, s29
  v_pk_add_u16 v8, v8, s28
  v_pk_add_f32 v[6:7], v[6:7], -2.0 op_sel_hi:[1,0]
  v_pk_max_i16 v8, v8, v9
  v_pk_add_u16 v5, v5, s30
  v_mad_u32_u16 v66, v8, 2, s26
  v_mad_u32_u16 v67, v8, 2, s26 op_sel:[1,0,0,0]
kb_ga0:
  s_cmp_eq_u32 s23, 0
  s_cbranch_scc1 kb_ga1
  v_cvt_pk_bf16_f32 v8, v6, v7
  v_pk_min_u16 v9, v5, s29
  v_pk_add_u16 v8, v8, s28
  v_pk_add_f32 v[6:7], v[6:7], -2.0 op_sel_hi:[1,0]
  v_pk_max_i16 v8, v8, v9
  v_pk_add_u16 v5, v5, s30
  v_mad_u32_u16 v68, v8, 2, s26
  v_mad_u32_u16 v69, v8, 2, s26 op_sel:[1,0,0,0]
  v_cvt_pk_bf16_f32 v8, v6, v7
  v_pk_min_u16 v9, v5, s29
  v_pk_add_u16 v8, v8, s28
  v_pk_add_f32 v[6:7], v[6:7], -2.0 op_sel_hi:[1,0]
  v_pk_max_i16 v8, v8, v9
  v_pk_add_u16 v5, v5, s30
  v_mad_u32_u16 v70, v8, 2, s26
  v_mad_u32_u16 v71, v8, 2, s26 op_sel:[1,0,0,0]
kb_ga1:
  s_cmp_eq_u32 s23, 0
  s_cbranch_scc1 kb_ga2
  v_cvt_pk_bf16_f32 v8, v6, v7
  v_pk_min_u16 v9, v5, s29
  v_pk_add_u16 v8, v8, s28
  v_pk_add_f32 v[6:7], v[6:7], -2.0 op_sel_hi:[1,0]
  v_pk_max_i16 v8, v8, v9
  v_pk_add_u16 v5, v5, s30
  v_mad_u32_u16 v72, v8, 2, s26
  v_mad_u32_u16 v73, v8, 2, s26 op_sel:[1,0,0,0]
  v_cvt_pk_bf16_f32 v8, v6, v7
  v_pk_min_u16 v9, v5, s29
  v_pk_add_u16 v8, v8, s28
  v_pk_add_f32 v[6:7], v[6:7], -2.0 op_sel_hi:[1,0]
  v_pk_max_i16 v8, v8, v9
  v_pk_add_u16 v5, v5, s30
  v_mad_u32_u16 v74, v8, 2, s26
  v_mad_u32_u16 v75, v8, 2, s26 op_sel:[1,0,0,0]
kb_ga2:
  s_cmp_eq_u32 s23, 0
  s_cbranch_scc1 kb_ga3
  v_cvt_pk_bf16_f32 v8, v6, v7
  v_pk_min_u16 v9, v5, s29
  v_pk_add_u16 v8, v8, s28
  v_pk_add_f32 v[6:7], v[6:7], -2.0 op_sel_hi:[1,0]
  v_pk_max_i16 v8, v8, v9
  v_pk_add_u16 v5, v5, s30
  v_mad_u32_u16 v76, v8, 2, s26
  v_mad_u32_u16 v77, v8, 2, s26 op_sel:[1,0,0,0]
  v_cvt_pk_bf16_f32 v8, v6, v7
  v_pk_min_u16 v9, v5, s29
  v_pk_add_u16 v8, v8, s28
  v_pk_add_f32 v[6:7], v[6:7], -2.0 op_sel_hi:[1,0]
  v_pk_max_i16 v8, v8, v9
  v_pk_add_u16 v5, v5, s30
  v_mad_u32_u16 v78, v8, 2, s26
  v_mad_u32_u16 v79, v8, 2, s26 op_sel:[1,0,0,0]
kb_ga3:
  s_cmp_eq_u32 s23, 0
  s_cbranch_scc1 kb_ga4
  v_cvt_pk_bf16_f32 v8, v6, v7
  v_pk_min_u16 v9, v5, s29
  v_pk_add_u16 v8, v8, s28
  v_pk_add_f32 v[6:7], v[6:7], -2.0 op_sel_hi:[1,0]
  v_pk_max_i16 v8, v8, v9
  v_pk_add_u16 v5, v5, s30
  v_pk_min_u16 v8, v8, s31
  v_mad_u32_u16 v80, v8, 2, s26
  v_mad_u32_u16 v81, v8, 2, s26 op_sel:[1,0,0,0]
  v_cvt_pk_bf16_f32 v8, v6, v7
  v_pk_min_u16 v9, v5, s29
  v_pk_add_u16 v8, v8, s28
  v_pk_add_f32 v[6:7], v[6:7], -2.0 op_sel_hi:[1,0]
  v_pk_max_i16 v8, v8, v9
  v_pk_add_u16 v5, v5, s30
  v_pk_min_u16 v8, v8, s31
  v_mad_u32_u16 v82, v8, 2, s26
  v_mad_u32_u16 v83, v8, 2, s26 op_sel:[1,0,0,0]
kb_ga4:
  s_waitcnt vmcnt(4)
  buffer_load_dwordx4 v[192:195], v188, s[8:11], s27 offen offset:0
  buffer_load_dwordx4 v[196:199], v188, s[8:11], s27 offen offset:256
  v_lshlrev_b32 v16, 16, v16
  v_mul_f32 v17, 0x3fb8aa3b, v16
  v_mov_b32 v18, 0x3fb8aa3b
  v_fma_f32 v18, v16, v18, -v17
  v_fmac_f32 v18, 0x32a57060, v16
  v_exp_f32 v17, v17
  v_mul_f32 v18, 0x3f317218, v18
  v_fmac_f32 v17, v17, v18
  v_cvt_pk_bf16_f32 v17, v17, v17
  v_lshlrev_b32 v16, 16, v17
  v_lshlrev_b32 v20, 16, v10
  v_and_b32 v21, 0xffff0000, v10
  v_lshlrev_b32 v22, 16, v11
  v_and_b32 v23, 0xffff0000, v11
  v_mul_f32 v20, v16, v20
  v_mul_f32 v21, v16, v21
  v_mul_f32 v22, v16, v22
  v_mul_f32 v23, v16, v23
  v_mul_f32 v20, 0x3fb8aa3b, v20
  v_mul_f32 v21, 0x3fb8aa3b, v21
  v_mul_f32 v22, 0.15915494, v22
  v_mul_f32 v23, 0.15915494, v23
  s_cmp_eq_u32 s23, 0
  s_cbranch_scc1 kb_hi
  v_mul_f32 v24, 0x41000000, v20
  v_mul_f32 v26, 0x41000000, v22
  v_mul_f32 v25, 0x41000000, v21
  v_mul_f32 v27, 0x41000000, v23
  v_exp_f32 v24, v24
  v_fract_f32 v26, v26
  v_exp_f32 v25, v25
  v_fract_f32 v27, v27
  v_cos_f32 v28, v26
  v_sin_f32 v30, v26
  v_cos_f32 v29, v27
  v_sin_f32 v31, v27
  s_nop 0
  v_mul_f32 v32, v24, v28
  v_mul_f32 v33, v24, v30
  v_mul_f32 v34, v25, v29
  v_mul_f32 v35, v25, v31
  v_mul_f32 v24, 0x43000000, v20
  v_mul_f32 v26, 0x43000000, v22
  v_mul_f32 v25, 0x43000000, v21
  v_mul_f32 v27, 0x43000000, v23
  v_exp_f32 v24, v24
  v_fract_f32 v26, v26
  v_exp_f32 v25, v25
  v_fract_f32 v27, v27
  v_cos_f32 v28, v26
  v_sin_f32 v30, v26
  v_cos_f32 v29, v27
  v_sin_f32 v31, v27
  s_nop 0
  v_mul_f32 v40, v24, v28
  v_mul_f32 v41, v24, v30
  v_mul_f32 v42, v25, v29
  v_mul_f32 v43, v25, v31
  v_mov_b32 v36, 1.0
  v_mov_b32 v37, 0
  v_mov_b32 v38, 1.0
  v_mov_b32 v39, 0
  v_cvt_pk_f16_f32 v52, v36, v37
  v_cvt_pk_f16_f32 v53, v38, v39
  ds_write_b64 v155, v[52:53] offset:11088
  v_cvt_pk_f16_f32 v54, v40, v41
  v_cvt_pk_f16_f32 v55, v42, v43
  ds_write_b64 v155, v[54:55] offset:19536
  v_pk_mul_f32 v[44:45], v[36:37], v[32:33] op_sel:[0,0] op_sel_hi:[0,1]
  v_pk_mul_f32 v[46:47], v[38:39], v[34:35] op_sel:[0,0] op_sel_hi:[0,1]
  v_pk_fma_f32 v[36:37], v[36:37], v[32:33], v[44:45] op_sel:[1,1,0] op_sel_hi:[1,0,1] neg_lo:[1,0,0]
  v_pk_fma_f32 v[38:39], v[38:39], v[34:35], v[46:47] op_sel:[1,1,0] op_sel_hi:[1,0,1] neg_lo:[1,0,0]
  v_pk_mul_f32 v[48:49], v[40:41], v[32:33] op_sel:[0,0] op_sel_hi:[0,1]
  v_pk_mul_f32 v[50:51], v[42:43], v[34:35] op_sel:[0,0] op_sel_hi:[0,1]
  v_pk_fma_f32 v[40:41], v[40:41], v[32:33], v[48:49] op_sel:[1,1,0] op_sel_hi:[1,0,1] neg_lo:[1,0,0]
  v_pk_fma_f32 v[42:43], v[42:43], v[34:35], v[50:51] op_sel:[1,1,0] op_sel_hi:[1,0,1] neg_lo:[1,0,0]
  v_cvt_pk_f16_f32 v56, v36, v37
  v_cvt_pk_f16_f32 v57, v38, v39
  ds_write_b64 v155, v[56:57] offset:11616
  v_cvt_pk_f16_f32 v58, v40, v41
  v_cvt_pk_f16_f32 v59, v42, v43
  ds_write_b64 v155, v[58:59] offset:20064
  v_pk_mul_f32 v[44:45], v[36:37], v[32:33] op_sel:[0,0] op_sel_hi:[0,1]
  v_pk_mul_f32 v[46:47], v[38:39], v[34:35] op_sel:[0,0] op_sel_hi:[0,1]
  v_pk_fma_f32 v[36:37], v[36:37], v[32:33], v[44:45] op_sel:[1,1,0] op_sel_hi:[1,0,1] neg_lo:[1,0,0]
  v_pk_fma_f32 v[38:39], v[38:39], v[34:35], v[46:47] op_sel:[1,1,0] op_sel_hi:[1,0,1] neg_lo:[1,0,0]
  v_pk_mul_f32 v[48:49], v[40:41], v[32:33] op_sel:[0,0] op_sel_hi:[0,1]
  v_pk_mul_f32 v[50:51], v[42:43], v[34:35] op_sel:[0,0] op_sel_hi:[0,1]
  v_pk_fma_f32 v[40:41], v[40:41], v[32:33], v[48:49] op_sel:[1,1,0] op_sel_hi:[1,0,1] neg_lo:[1,0,0]
  v_pk_fma_f32 v[42:43], v[42:43], v[34:35], v[50:51] op_sel:[1,1,0] op_sel_hi:[1,0,1] neg_lo:[1,0,0]
  v_cvt_pk_f16_f32 v52, v36, v37
  v_cvt_pk_f16_f32 v53, v38, v39
  ds_write_b64 v155, v[52:53] offset:12144
  v_cvt_pk_f16_f32 v54, v40, v41
  v_cvt_pk_f16_f32 v55, v42, v43
  ds_write_b64 v155, v[54:55] offset:20592
  v_pk_mul_f32 v[44:45], v[36:37], v[32:33] op_sel:[0,0] op_sel_hi:[0,1]
  v_pk_mul_f32 v[46:47], v[38:39], v[34:35] op_sel:[0,0] op_sel_hi:[0,1]
  v_pk_fma_f32 v[36:37], v[36:37], v[32:33], v[44:45] op_sel:[1,1,0] op_sel_hi:[1,0,1] neg_lo:[1,0,0]
  v_pk_fma_f32 v[38:39], v[38:39], v[34:35], v[46:47] op_sel:[1,1,0] op_sel_hi:[1,0,1] neg_lo:[1,0,0]
  v_pk_mul_f32 v[48:49], v[40:41], v[32:33] op_sel:[0,0] op_sel_hi:[0,1]
  v_pk_mul_f32 v[50:51], v[42:43], v[34:35] op_sel:[0,0] op_sel_hi:[0,1]
  v_pk_fma_f32 v[40:41], v[40:41], v[32:33], v[48:49] op_sel:[1,1,0] op_sel_hi:[1,0,1] neg_lo:[1,0,0]
  v_pk_fma_f32 v[42:43], v[42:43], v[34:35], v[50:51] op_sel:[1,1,0] op_sel_hi:[1,0,1] neg_lo:[1,0,0]
  v_cvt_pk_f16_f32 v56, v36, v37
  v_cvt_pk_f16_f32 v57, v38, v39
  ds_write_b64 v155, v[56:57] offset:12672
  v_cvt_pk_f16_f32 v58, v40, v41
  v_cvt_pk_f16_f32 v59, v42, v43
  ds_write_b64 v155, v[58:59] offset:21120
  v_pk_mul_f32 v[44:45], v[36:37], v[32:33] op_sel:[0,0] op_sel_hi:[0,1]
  v_pk_mul_f32 v[46:47], v[38:39], v[34:35] op_sel:[0,0] op_sel_hi:[0,1]
  v_pk_fma_f32 v[36:37], v[36:37], v[32:33], v[44:45] op_sel:[1,1,0] op_sel_hi:[1,0,1] neg_lo:[1,0,0]
  v_pk_fma_f32 v[38:39], v[38:39], v[34:35], v[46:47] op_sel:[1,1,0] op_sel_hi:[1,0,1] neg_lo:[1,0,0]
  v_pk_mul_f32 v[48:49], v[40:41], v[32:33] op_sel:[0,0] op_sel_hi:[0,1]
  v_pk_mul_f32 v[50:51], v[42:43], v[34:35] op_sel:[0,0] op_sel_hi:[0,1]
  v_pk_fma_f32 v[40:41], v[40:41], v[32:33], v[48:49] op_sel:[1,1,0] op_sel_hi:[1,0,1] neg_lo:[1,0,0]
  v_pk_fma_f32 v[42:43], v[42:43], v[34:35], v[50:51] op_sel:[1,1,0] op_sel_hi:[1,0,1] neg_lo:[1,0,0]
  v_cvt_pk_f16_f32 v52, v36, v37
  v_cvt_pk_f16_f32 v53, v38, v39
  ds_write_b64 v155, v[52:53] offset:13200
  v_cvt_pk_f16_f32 v54, v40, v41
  v_cvt_pk_f16_f32 v55, v42, v43
  ds_write_b64 v155, v[54:55] offset:21648
  v_pk_mul_f32 v[44:45], v[36:37], v[32:33] op_sel:[0,0] op_sel_hi:[0,1]
  v_pk_mul_f32 v[46:47], v[38:39], v[34:35] op_sel:[0,0] op_sel_hi:[0,1]
  v_pk_fma_f32 v[36:37], v[36:37], v[32:33], v[44:45] op_sel:[1,1,0] op_sel_hi:[1,0,1] neg_lo:[1,0,0]
  v_pk_fma_f32 v[38:39], v[38:39], v[34:35], v[46:47] op_sel:[1,1,0] op_sel_hi:[1,0,1] neg_lo:[1,0,0]
  v_pk_mul_f32 v[48:49], v[40:41], v[32:33] op_sel:[0,0] op_sel_hi:[0,1]
  v_pk_mul_f32 v[50:51], v[42:43], v[34:35] op_sel:[0,0] op_sel_hi:[0,1]
  v_pk_fma_f32 v[40:41], v[40:41], v[32:33], v[48:49] op_sel:[1,1,0] op_sel_hi:[1,0,1] neg_lo:[1,0,0]
  v_pk_fma_f32 v[42:43], v[42:43], v[34:35], v[50:51] op_sel:[1,1,0] op_sel_hi:[1,0,1] neg_lo:[1,0,0]
  v_cvt_pk_f16_f32 v56, v36, v37
  v_cvt_pk_f16_f32 v57, v38, v39
  ds_write_b64 v155, v[56:57] offset:13728
  v_cvt_pk_f16_f32 v58, v40, v41
  v_cvt_pk_f16_f32 v59, v42, v43
  ds_write_b64 v155, v[58:59] offset:22176
  v_pk_mul_f32 v[44:45], v[36:37], v[32:33] op_sel:[0,0] op_sel_hi:[0,1]
  v_pk_mul_f32 v[46:47], v[38:39], v[34:35] op_sel:[0,0] op_sel_hi:[0,1]
  v_pk_fma_f32 v[36:37], v[36:37], v[32:33], v[44:45] op_sel:[1,1,0] op_sel_hi:[1,0,1] neg_lo:[1,0,0]
  v_pk_fma_f32 v[38:39], v[38:39], v[34:35], v[46:47] op_sel:[1,1,0] op_sel_hi:[1,0,1] neg_lo:[1,0,0]
  v_pk_mul_f32 v[48:49], v[40:41], v[32:33] op_sel:[0,0] op_sel_hi:[0,1]
  v_pk_mul_f32 v[50:51], v[42:43], v[34:35] op_sel:[0,0] op_sel_hi:[0,1]
  v_pk_fma_f32 v[40:41], v[40:41], v[32:33], v[48:49] op_sel:[1,1,0] op_sel_hi:[1,0,1] neg_lo:[1,0,0]
  v_pk_fma_f32 v[42:43], v[42:43], v[34:35], v[50:51] op_sel:[1,1,0] op_sel_hi:[1,0,1] neg_lo:[1,0,0]
  v_cvt_pk_f16_f32 v52, v36, v37
  v_cvt_pk_f16_f32 v53, v38, v39
  ds_write_b64 v155, v[52:53] offset:14256
  v_cvt_pk_f16_f32 v54, v40, v41
  v_cvt_pk_f16_f32 v55, v42, v43
  ds_write_b64 v155, v[54:55] offset:22704
  v_pk_mul_f32 v[44:45], v[36:37], v[32:33] op_sel:[0,0] op_sel_hi:[0,1]
  v_pk_mul_f32 v[46:47], v[38:39], v[34:35] op_sel:[0,0] op_sel_hi:[0,1]
  v_pk_fma_f32 v[36:37], v[36:37], v[32:33], v[44:45] op_sel:[1,1,0] op_sel_hi:[1,0,1] neg_lo:[1,0,0]
  v_pk_fma_f32 v[38:39], v[38:39], v[34:35], v[46:47] op_sel:[1,1,0] op_sel_hi:[1,0,1] neg_lo:[1,0,0]
  v_pk_mul_f32 v[48:49], v[40:41], v[32:33] op_sel:[0,0] op_sel_hi:[0,1]
  v_pk_mul_f32 v[50:51], v[42:43], v[34:35] op_sel:[0,0] op_sel_hi:[0,1]
  v_pk_fma_f32 v[40:41], v[40:41], v[32:33], v[48:49] op_sel:[1,1,0] op_sel_hi:[1,0,1] neg_lo:[1,0,0]
  v_pk_fma_f32 v[42:43], v[42:43], v[34:35], v[50:51] op_sel:[1,1,0] op_sel_hi:[1,0,1] neg_lo:[1,0,0]
  v_cvt_pk_f16_f32 v56, v36, v37
  v_cvt_pk_f16_f32 v57, v38, v39
  ds_write_b64 v155, v[56:57] offset:14784
  v_cvt_pk_f16_f32 v58, v40, v41
  v_cvt_pk_f16_f32 v59, v42, v43
  ds_write_b64 v155, v[58:59] offset:23232
  v_pk_mul_f32 v[44:45], v[36:37], v[32:33] op_sel:[0,0] op_sel_hi:[0,1]
  v_pk_mul_f32 v[46:47], v[38:39], v[34:35] op_sel:[0,0] op_sel_hi:[0,1]
  v_pk_fma_f32 v[36:37], v[36:37], v[32:33], v[44:45] op_sel:[1,1,0] op_sel_hi:[1,0,1] neg_lo:[1,0,0]
  v_pk_fma_f32 v[38:39], v[38:39], v[34:35], v[46:47] op_sel:[1,1,0] op_sel_hi:[1,0,1] neg_lo:[1,0,0]
  v_pk_mul_f32 v[48:49], v[40:41], v[32:33] op_sel:[0,0] op_sel_hi:[0,1]
  v_pk_mul_f32 v[50:51], v[42:43], v[34:35] op_sel:[0,0] op_sel_hi:[0,1]
  v_pk_fma_f32 v[40:41], v[40:41], v[32:33], v[48:49] op_sel:[1,1,0] op_sel_hi:[1,0,1] neg_lo:[1,0,0]
  v_pk_fma_f32 v[42:43], v[42:43], v[34:35], v[50:51] op_sel:[1,1,0] op_sel_hi:[1,0,1] neg_lo:[1,0,0]
  v_cvt_pk_f16_f32 v52, v36, v37
  v_cvt_pk_f16_f32 v53, v38, v39
  ds_write_b64 v155, v[52:53] offset:15312
  v_cvt_pk_f16_f32 v54, v40, v41
  v_cvt_pk_f16_f32 v55, v42, v43
  ds_write_b64 v155, v[54:55] offset:23760
  v_pk_mul_f32 v[44:45], v[36:37], v[32:33] op_sel:[0,0] op_sel_hi:[0,1]
  v_pk_mul_f32 v[46:47], v[38:39], v[34:35] op_sel:[0,0] op_sel_hi:[0,1]
  v_pk_fma_f32 v[36:37], v[36:37], v[32:33], v[44:45] op_sel:[1,1,0] op_sel_hi:[1,0,1] neg_lo:[1,0,0]
  v_pk_fma_f32 v[38:39], v[38:39], v[34:35], v[46:47] op_sel:[1,1,0] op_sel_hi:[1,0,1] neg_lo:[1,0,0]
  v_pk_mul_f32 v[48:49], v[40:41], v[32:33] op_sel:[0,0] op_sel_hi:[0,1]
  v_pk_mul_f32 v[50:51], v[42:43], v[34:35] op_sel:[0,0] op_sel_hi:[0,1]
  v_pk_fma_f32 v[40:41], v[40:41], v[32:33], v[48:49] op_sel:[1,1,0] op_sel_hi:[1,0,1] neg_lo:[1,0,0]
  v_pk_fma_f32 v[42:43], v[42:43], v[34:35], v[50:51] op_sel:[1,1,0] op_sel_hi:[1,0,1] neg_lo:[1,0,0]
  v_cvt_pk_f16_f32 v56, v36, v37
  v_cvt_pk_f16_f32 v57, v38, v39
  ds_write_b64 v155, v[56:57] offset:15840
  v_cvt_pk_f16_f32 v58, v40, v41
  v_cvt_pk_f16_f32 v59, v42, v43
  ds_write_b64 v155, v[58:59] offset:24288
  v_pk_mul_f32 v[44:45], v[36:37], v[32:33] op_sel:[0,0] op_sel_hi:[0,1]
  v_pk_mul_f32 v[46:47], v[38:39], v[34:35] op_sel:[0,0] op_sel_hi:[0,1]
  v_pk_fma_f32 v[36:37], v[36:37], v[32:33], v[44:45] op_sel:[1,1,0] op_sel_hi:[1,0,1] neg_lo:[1,0,0]
  v_pk_fma_f32 v[38:39], v[38:39], v[34:35], v[46:47] op_sel:[1,1,0] op_sel_hi:[1,0,1] neg_lo:[1,0,0]
  v_pk_mul_f32 v[48:49], v[40:41], v[32:33] op_sel:[0,0] op_sel_hi:[0,1]
  v_pk_mul_f32 v[50:51], v[42:43], v[34:35] op_sel:[0,0] op_sel_hi:[0,1]
  v_pk_fma_f32 v[40:41], v[40:41], v[32:33], v[48:49] op_sel:[1,1,0] op_sel_hi:[1,0,1] neg_lo:[1,0,0]
  v_pk_fma_f32 v[42:43], v[42:43], v[34:35], v[50:51] op_sel:[1,1,0] op_sel_hi:[1,0,1] neg_lo:[1,0,0]
  v_cvt_pk_f16_f32 v52, v36, v37
  v_cvt_pk_f16_f32 v53, v38, v39
  ds_write_b64 v155, v[52:53] offset:16368
  v_cvt_pk_f16_f32 v54, v40, v41
  v_cvt_pk_f16_f32 v55, v42, v43
  ds_write_b64 v155, v[54:55] offset:24816
  v_pk_mul_f32 v[44:45], v[36:37], v[32:33] op_sel:[0,0] op_sel_hi:[0,1]
  v_pk_mul_f32 v[46:47], v[38:39], v[34:35] op_sel:[0,0] op_sel_hi:[0,1]
  v_pk_fma_f32 v[36:37], v[36:37], v[32:33], v[44:45] op_sel:[1,1,0] op_sel_hi:[1,0,1] neg_lo:[1,0,0]
  v_pk_fma_f32 v[38:39], v[38:39], v[34:35], v[46:47] op_sel:[1,1,0] op_sel_hi:[1,0,1] neg_lo:[1,0,0]
  v_pk_mul_f32 v[48:49], v[40:41], v[32:33] op_sel:[0,0] op_sel_hi:[0,1]
  v_pk_mul_f32 v[50:51], v[42:43], v[34:35] op_sel:[0,0] op_sel_hi:[0,1]
  v_pk_fma_f32 v[40:41], v[40:41], v[32:33], v[48:49] op_sel:[1,1,0] op_sel_hi:[1,0,1] neg_lo:[1,0,0]
  v_pk_fma_f32 v[42:43], v[42:43], v[34:35], v[50:51] op_sel:[1,1,0] op_sel_hi:[1,0,1] neg_lo:[1,0,0]
  v_cvt_pk_f16_f32 v56, v36, v37
  v_cvt_pk_f16_f32 v57, v38, v39
  ds_write_b64 v155, v[56:57] offset:16896
  v_cvt_pk_f16_f32 v58, v40, v41
  v_cvt_pk_f16_f32 v59, v42, v43
  ds_write_b64 v155, v[58:59] offset:25344
  v_pk_mul_f32 v[44:45], v[36:37], v[32:33] op_sel:[0,0] op_sel_hi:[0,1]
  v_pk_mul_f32 v[46:47], v[38:39], v[34:35] op_sel:[0,0] op_sel_hi:[0,1]
  v_pk_fma_f32 v[36:37], v[36:37], v[32:33], v[44:45] op_sel:[1,1,0] op_sel_hi:[1,0,1] neg_lo:[1,0,0]
  v_pk_fma_f32 v[38:39], v[38:39], v[34:35], v[46:47] op_sel:[1,1,0] op_sel_hi:[1,0,1] neg_lo:[1,0,0]
  v_pk_mul_f32 v[48:49], v[40:41], v[32:33] op_sel:[0,0] op_sel_hi:[0,1]
  v_pk_mul_f32 v[50:51], v[42:43], v[34:35] op_sel:[0,0] op_sel_hi:[0,1]
  v_pk_fma_f32 v[40:41], v[40:41], v[32:33], v[48:49] op_sel:[1,1,0] op_sel_hi:[1,0,1] neg_lo:[1,0,0]
  v_pk_fma_f32 v[42:43], v[42:43], v[34:35], v[50:51] op_sel:[1,1,0] op_sel_hi:[1,0,1] neg_lo:[1,0,0]
  v_cvt_pk_f16_f32 v52, v36, v37
  v_cvt_pk_f16_f32 v53, v38, v39
  ds_write_b64 v155, v[52:53] offset:17424
  v_cvt_pk_f16_f32 v54, v40, v41
  v_cvt_pk_f16_f32 v55, v42, v43
  ds_write_b64 v155, v[54:55] offset:25872
  v_pk_mul_f32 v[44:45], v[36:37], v[32:33] op_sel:[0,0] op_sel_hi:[0,1]
  v_pk_mul_f32 v[46:47], v[38:39], v[34:35] op_sel:[0,0] op_sel_hi:[0,1]
  v_pk_fma_f32 v[36:37], v[36:37], v[32:33], v[44:45] op_sel:[1,1,0] op_sel_hi:[1,0,1] neg_lo:[1,0,0]
  v_pk_fma_f32 v[38:39], v[38:39], v[34:35], v[46:47] op_sel:[1,1,0] op_sel_hi:[1,0,1] neg_lo:[1,0,0]
  v_pk_mul_f32 v[48:49], v[40:41], v[32:33] op_sel:[0,0] op_sel_hi:[0,1]
  v_pk_mul_f32 v[50:51], v[42:43], v[34:35] op_sel:[0,0] op_sel_hi:[0,1]
  v_pk_fma_f32 v[40:41], v[40:41], v[32:33], v[48:49] op_sel:[1,1,0] op_sel_hi:[1,0,1] neg_lo:[1,0,0]
  v_pk_fma_f32 v[42:43], v[42:43], v[34:35], v[50:51] op_sel:[1,1,0] op_sel_hi:[1,0,1] neg_lo:[1,0,0]
  v_cvt_pk_f16_f32 v56, v36, v37
  v_cvt_pk_f16_f32 v57, v38, v39
  ds_write_b64 v155, v[56:57] offset:17952
  v_cvt_pk_f16_f32 v58, v40, v41
  v_cvt_pk_f16_f32 v59, v42, v43
  ds_write_b64 v155, v[58:59] offset:26400
  v_pk_mul_f32 v[44:45], v[36:37], v[32:33] op_sel:[0,0] op_sel_hi:[0,1]
  v_pk_mul_f32 v[46:47], v[38:39], v[34:35] op_sel:[0,0] op_sel_hi:[0,1]
  v_pk_fma_f32 v[36:37], v[36:37], v[32:33], v[44:45] op_sel:[1,1,0] op_sel_hi:[1,0,1] neg_lo:[1,0,0]
  v_pk_fma_f32 v[38:39], v[38:39], v[34:35], v[46:47] op_sel:[1,1,0] op_sel_hi:[1,0,1] neg_lo:[1,0,0]
  v_pk_mul_f32 v[48:49], v[40:41], v[32:33] op_sel:[0,0] op_sel_hi:[0,1]
  v_pk_mul_f32 v[50:51], v[42:43], v[34:35] op_sel:[0,0] op_sel_hi:[0,1]
  v_pk_fma_f32 v[40:41], v[40:41], v[32:33], v[48:49] op_sel:[1,1,0] op_sel_hi:[1,0,1] neg_lo:[1,0,0]
  v_pk_fma_f32 v[42:43], v[42:43], v[34:35], v[50:51] op_sel:[1,1,0] op_sel_hi:[1,0,1] neg_lo:[1,0,0]
  v_cvt_pk_f16_f32 v52, v36, v37
  v_cvt_pk_f16_f32 v53, v38, v39
  ds_write_b64 v155, v[52:53] offset:18480
  v_cvt_pk_f16_f32 v54, v40, v41
  v_cvt_pk_f16_f32 v55, v42, v43
  ds_write_b64 v155, v[54:55] offset:26928
  v_pk_mul_f32 v[44:45], v[36:37], v[32:33] op_sel:[0,0] op_sel_hi:[0,1]
  v_pk_mul_f32 v[46:47], v[38:39], v[34:35] op_sel:[0,0] op_sel_hi:[0,1]
  v_pk_fma_f32 v[36:37], v[36:37], v[32:33], v[44:45] op_sel:[1,1,0] op_sel_hi:[1,0,1] neg_lo:[1,0,0]
  v_pk_fma_f32 v[38:39], v[38:39], v[34:35], v[46:47] op_sel:[1,1,0] op_sel_hi:[1,0,1] neg_lo:[1,0,0]
  v_pk_mul_f32 v[48:49], v[40:41], v[32:33] op_sel:[0,0] op_sel_hi:[0,1]
  v_pk_mul_f32 v[50:51], v[42:43], v[34:35] op_sel:[0,0] op_sel_hi:[0,1]
  v_pk_fma_f32 v[40:41], v[40:41], v[32:33], v[48:49] op_sel:[1,1,0] op_sel_hi:[1,0,1] neg_lo:[1,0,0]
  v_pk_fma_f32 v[42:43], v[42:43], v[34:35], v[50:51] op_sel:[1,1,0] op_sel_hi:[1,0,1] neg_lo:[1,0,0]
  v_cvt_pk_f16_f32 v56, v36, v37
  v_cvt_pk_f16_f32 v57, v38, v39
  ds_write_b64 v155, v[56:57] offset:19008
  v_cvt_pk_f16_f32 v58, v40, v41
  v_cvt_pk_f16_f32 v59, v42, v43
  ds_write_b64 v155, v[58:59] offset:27456
  s_branch kb_join
kb_hi:
  v_xor_b32 v22, 0x80000000, v22
  v_xor_b32 v23, 0x80000000, v23
  v_lshlrev_b32 v40, 16, v12
  v_and_b32 v41, 0xffff0000, v12
  v_lshlrev_b32 v42, 16, v13
  v_and_b32 v43, 0xffff0000, v13
  v_lshlrev_b32 v44, 16, v14
  v_and_b32 v45, 0xffff0000, v14
  v_lshlrev_b32 v46, 16, v15
  v_and_b32 v47, 0xffff0000, v15
  v_mul_f32 v40, v16, v40
  v_mul_f32 v41, v16, v41
  v_mul_f32 v42, v16, v42
  v_mul_f32 v43, v16, v43
  v_mul_f32 v36, v44, v40
  v_fma_f32 v36, -v46, v42, v36
  v_mul_f32 v37, v44, v42
  v_fma_f32 v37, -v46, v40, -v37
  v_mul_f32 v38, v45, v41
  v_fma_f32 v38, -v47, v43, v38
  v_mul_f32 v39, v45, v43
  v_fma_f32 v39, -v47, v41, -v39
  v_max3_f32 v48, abs(v36), abs(v37), abs(v38)
  v_max_f32 v49, abs(v39), abs(v39)
  v_max_f32 v48, v48, v49
  s_nop 1
  v_max_f32_dpp v48, v48, v48 row_ror:8 row_mask:0xf bank_mask:0xf
  s_nop 1
  v_max_f32_dpp v48, v48, v48 row_ror:4 row_mask:0xf bank_mask:0xf
  s_nop 1
  v_max_f32_dpp v48, v48, v48 row_ror:2 row_mask:0xf bank_mask:0xf
  s_nop 1
  v_max_f32_dpp v48, v48, v48 row_ror:1 row_mask:0xf bank_mask:0xf
  s_nop 1
  v_readlane_b32 s56, v48, 0
  v_readlane_b32 s57, v48, 16
  v_readlane_b32 s58, v48, 32
  v_readlane_b32 s59, v48, 48
  s_nop 3
  s_max_u32 s56, s56, s57
  s_max_u32 s58, s58, s59
  s_max_u32 s56, s56, s58
  s_lshr_b32 s56, s56, 23
  s_max_u32 s56, s56, 1
  s_min_u32 s56, s56, 253
  s_sub_u32 s57, 254, s56
  s_lshl_b32 s57, s57, 23
  s_lshl_b32 s56, s56, 23
  v_mul_f32 v36, s57, v36
  v_mul_f32 v37, s57, v37
  v_mul_f32 v38, s57, v38
  v_mul_f32 v39, s57, v39
  v_mul_f32 v24, 0x3f800000, v20
  v_mul_f32 v26, 0x3f800000, v22
  v_mul_f32 v25, 0x3f800000, v21
  v_mul_f32 v27, 0x3f800000, v23
  v_exp_f32 v24, v24
  v_fract_f32 v26, v26
  v_exp_f32 v25, v25
  v_fract_f32 v27, v27
  v_cos_f32 v28, v26
  v_sin_f32 v30, v26
  v_cos_f32 v29, v27
  v_sin_f32 v31, v27
  s_nop 0
  v_mul_f32 v32, v24, v28
  v_mul_f32 v33, v24, v30
  v_mul_f32 v34, v25, v29
  v_mul_f32 v35, v25, v31
  v_mul_f32 v24, 0x43800000, v20
  v_mul_f32 v26, 0x43800000, v22
  v_mul_f32 v25, 0x43800000, v21
  v_mul_f32 v27, 0x43800000, v23
  v_exp_f32 v24, v24
  v_fract_f32 v26, v26
  v_exp_f32 v25, v25
  v_fract_f32 v27, v27
  v_cos_f32 v28, v26
  v_sin_f32 v30, v26
  v_cos_f32 v29, v27
  v_sin_f32 v31, v27
  s_nop 0
  v_mul_f32 v40, v24, v28
  v_mul_f32 v41, v24, v30
  v_mul_f32 v42, v25, v29
  v_mul_f32 v43, v25, v31
  v_pk_mul_f32 v[44:45], v[36:37], v[40:41] op_sel:[0,0] op_sel_hi:[0,1]
  v_pk_mul_f32 v[46:47], v[38:39], v[42:43] op_sel:[0,0] op_sel_hi:[0,1]
  v_pk_fma_f32 v[56:57], v[36:37], v[40:41], v[44:45] op_sel:[1,1,0] op_sel_hi:[1,0,1] neg_lo:[1,0,0]
  v_pk_fma_f32 v[58:59], v[38:39], v[42:43], v[46:47] op_sel:[1,1,0] op_sel_hi:[1,0,1] neg_lo:[1,0,0]
  v_pk_mul_f32 v[48:49], v[32:33], v[32:33] op_sel:[0,0] op_sel_hi:[0,1]
  v_pk_mul_f32 v[50:51], v[34:35], v[34:35] op_sel:[0,0] op_sel_hi:[0,1]
  v_pk_fma_f32 v[60:61], v[32:33], v[32:33], v[48:49] op_sel:[1,1,0] op_sel_hi:[1,0,1] neg_lo:[1,0,0]
  v_pk_fma_f32 v[62:63], v[34:35], v[34:35], v[50:51] op_sel:[1,1,0] op_sel_hi:[1,0,1] neg_lo:[1,0,0]
  v_cvt_pk_f16_f32 v52, v36, v37
  v_cvt_pk_f16_f32 v53, v38, v39
  ds_write_b64 v155, v[52:53] offset:0
  v_pk_mul_f32 v[48:49], v[60:61], v[60:61] op_sel:[0,0] op_sel_hi:[0,1]
  v_pk_mul_f32 v[50:51], v[62:63], v[62:63] op_sel:[0,0] op_sel_hi:[0,1]
  v_pk_fma_f32 v[86:87], v[60:61], v[60:61], v[48:49] op_sel:[1,1,0] op_sel_hi:[1,0,1] neg_lo:[1,0,0]
  v_pk_fma_f32 v[88:89], v[62:63], v[62:63], v[50:51] op_sel:[1,1,0] op_sel_hi:[1,0,1] neg_lo:[1,0,0]
  v_cvt_pk_f16_f32 v54, v56, v57
  v_cvt_pk_f16_f32 v55, v58, v59
  ds_write_b64 v155, v[54:55] offset:4224
  v_pk_mul_f32 v[44:45], v[56:57], v[60:61] op_sel:[0,0] op_sel_hi:[0,1]
  v_pk_mul_f32 v[46:47], v[58:59], v[62:63] op_sel:[0,0] op_sel_hi:[0,1]
  v_pk_fma_f32 v[94:95], v[56:57], v[60:61], v[44:45] op_sel:[1,1,0] op_sel_hi:[1,0,1] neg_lo:[1,0,0]
  v_pk_fma_f32 v[96:97], v[58:59], v[62:63], v[46:47] op_sel:[1,1,0] op_sel_hi:[1,0,1] neg_lo:[1,0,0]
  v_pk_mul_f32 v[48:49], v[36:37], v[32:33] op_sel:[0,0] op_sel_hi:[0,1]
  v_pk_mul_f32 v[50:51], v[38:39], v[34:35] op_sel:[0,0] op_sel_hi:[0,1]
  v_pk_fma_f32 v[36:37], v[36:37], v[32:33], v[48:49] op_sel:[1,1,0] op_sel_hi:[1,0,1] neg_lo:[1,0,0]
  v_pk_fma_f32 v[38:39], v[38:39], v[34:35], v[50:51] op_sel:[1,1,0] op_sel_hi:[1,0,1] neg_lo:[1,0,0]
  v_cvt_pk_f16_f32 v90, v94, v95
  v_cvt_pk_f16_f32 v91, v96, v97
  ds_write_b64 v155, v[90:91] offset:4752
  v_cvt_pk_f16_f32 v52, v36, v37
  v_cvt_pk_f16_f32 v53, v38, v39
  ds_write_b64 v155, v[52:53] offset:528
  v_pk_mul_f32 v[44:45], v[94:95], v[60:61] op_sel:[0,0] op_sel_hi:[0,1]
  v_pk_mul_f32 v[46:47], v[96:97], v[62:63] op_sel:[0,0] op_sel_hi:[0,1]
  v_pk_fma_f32 v[94:95], v[94:95], v[60:61], v[44:45] op_sel:[1,1,0] op_sel_hi:[1,0,1] neg_lo:[1,0,0]
  v_pk_fma_f32 v[96:97], v[96:97], v[62:63], v[46:47] op_sel:[1,1,0] op_sel_hi:[1,0,1] neg_lo:[1,0,0]
  v_pk_mul_f32 v[48:49], v[36:37], v[32:33] op_sel:[0,0] op_sel_hi:[0,1]
  v_pk_mul_f32 v[50:51], v[38:39], v[34:35] op_sel:[0,0] op_sel_hi:[0,1]
  v_pk_fma_f32 v[36:37], v[36:37], v[32:33], v[48:49] op_sel:[1,1,0] op_sel_hi:[1,0,1] neg_lo:[1,0,0]
  v_pk_fma_f32 v[38:39], v[38:39], v[34:35], v[50:51] op_sel:[1,1,0] op_sel_hi:[1,0,1] neg_lo:[1,0,0]
  v_cvt_pk_f16_f32 v90, v94, v95
  v_cvt_pk_f16_f32 v91, v96, v97
  ds_write_b64 v155, v[90:91] offset:5280
  v_cvt_pk_f16_f32 v52, v36, v37
  v_cvt_pk_f16_f32 v53, v38, v39
  ds_write_b64 v155, v[52:53] offset:1056
  v_pk_mul_f32 v[44:45], v[94:95], v[60:61] op_sel:[0,0] op_sel_hi:[0,1]
  v_pk_mul_f32 v[46:47], v[96:97], v[62:63] op_sel:[0,0] op_sel_hi:[0,1]
  v_pk_fma_f32 v[94:95], v[94:95], v[60:61], v[44:45] op_sel:[1,1,0] op_sel_hi:[1,0,1] neg_lo:[1,0,0]
  v_pk_fma_f32 v[96:97], v[96:97], v[62:63], v[46:47] op_sel:[1,1,0] op_sel_hi:[1,0,1] neg_lo:[1,0,0]
  v_pk_mul_f32 v[48:49], v[36:37], v[32:33] op_sel:[0,0] op_sel_hi:[0,1]
  v_pk_mul_f32 v[50:51], v[38:39], v[34:35] op_sel:[0,0] op_sel_hi:[0,1]
  v_pk_fma_f32 v[36:37], v[36:37], v[32:33], v[48:49] op_sel:[1,1,0] op_sel_hi:[1,0,1] neg_lo:[1,0,0]
  v_pk_fma_f32 v[38:39], v[38:39], v[34:35], v[50:51] op_sel:[1,1,0] op_sel_hi:[1,0,1] neg_lo:[1,0,0]
  v_cvt_pk_f16_f32 v90, v94, v95
  v_cvt_pk_f16_f32 v91, v96, v97
  ds_write_b64 v155, v[90:91] offset:5808
  v_cvt_pk_f16_f32 v52, v36, v37
  v_cvt_pk_f16_f32 v53, v38, v39
  ds_write_b64 v155, v[52:53] offset:1584
  v_pk_mul_f32 v[44:45], v[56:57], v[40:41] op_sel:[0,0] op_sel_hi:[0,1]
  v_pk_mul_f32 v[46:47], v[58:59], v[42:43] op_sel:[0,0] op_sel_hi:[0,1]
  v_pk_fma_f32 v[56:57], v[56:57], v[40:41], v[44:45] op_sel:[1,1,0] op_sel_hi:[1,0,1] neg_lo:[1,0,0]
  v_pk_fma_f32 v[58:59], v[58:59], v[42:43], v[46:47] op_sel:[1,1,0] op_sel_hi:[1,0,1] neg_lo:[1,0,0]
  v_pk_mul_f32 v[48:49], v[36:37], v[32:33] op_sel:[0,0] op_sel_hi:[0,1]
  v_pk_mul_f32 v[50:51], v[38:39], v[34:35] op_sel:[0,0] op_sel_hi:[0,1]
  v_pk_fma_f32 v[36:37], v[36:37], v[32:33], v[48:49] op_sel:[1,1,0] op_sel_hi:[1,0,1] neg_lo:[1,0,0]
  v_pk_fma_f32 v[38:39], v[38:39], v[34:35], v[50:51] op_sel:[1,1,0] op_sel_hi:[1,0,1] neg_lo:[1,0,0]
  v_cvt_pk_f16_f32 v90, v56, v57
  v_cvt_pk_f16_f32 v91, v58, v59
  ds_write_b64 v155, v[90:91] offset:6336
  v_cvt_pk_f16_f32 v52, v36, v37
  v_cvt_pk_f16_f32 v53, v38, v39
  ds_write_b64 v155, v[52:53] offset:2112
  v_pk_mul_f32 v[44:45], v[56:57], v[86:87] op_sel:[0,0] op_sel_hi:[0,1]
  v_pk_mul_f32 v[46:47], v[58:59], v[88:89] op_sel:[0,0] op_sel_hi:[0,1]
  v_pk_fma_f32 v[94:95], v[56:57], v[86:87], v[44:45] op_sel:[1,1,0] op_sel_hi:[1,0,1] neg_lo:[1,0,0]
  v_pk_fma_f32 v[96:97], v[58:59], v[88:89], v[46:47] op_sel:[1,1,0] op_sel_hi:[1,0,1] neg_lo:[1,0,0]
  v_pk_mul_f32 v[48:49], v[36:37], v[32:33] op_sel:[0,0] op_sel_hi:[0,1]
  v_pk_mul_f32 v[50:51], v[38:39], v[34:35] op_sel:[0,0] op_sel_hi:[0,1]
  v_pk_fma_f32 v[36:37], v[36:37], v[32:33], v[48:49] op_sel:[1,1,0] op_sel_hi:[1,0,1] neg_lo:[1,0,0]
  v_pk_fma_f32 v[38:39], v[38:39], v[34:35], v[50:51] op_sel:[1,1,0] op_sel_hi:[1,0,1] neg_lo:[1,0,0]
  v_cvt_pk_f16_f32 v90, v94, v95
  v_cvt_pk_f16_f32 v91, v96, v97
  ds_write_b64 v155, v[90:91] offset:6864
  v_cvt_pk_f16_f32 v52, v36, v37
  v_cvt_pk_f16_f32 v53, v38, v39
  ds_write_b64 v155, v[52:53] offset:2640
  v_pk_mul_f32 v[44:45], v[56:57], v[40:41] op_sel:[0,0] op_sel_hi:[0,1]
  v_pk_mul_f32 v[46:47], v[58:59], v[42:43] op_sel:[0,0] op_sel_hi:[0,1]
  v_pk_fma_f32 v[56:57], v[56:57], v[40:41], v[44:45] op_sel:[1,1,0] op_sel_hi:[1,0,1] neg_lo:[1,0,0]
  v_pk_fma_f32 v[58:59], v[58:59], v[42:43], v[46:47] op_sel:[1,1,0] op_sel_hi:[1,0,1] neg_lo:[1,0,0]
  v_pk_mul_f32 v[48:49], v[36:37], v[32:33] op_sel:[0,0] op_sel_hi:[0,1]
  v_pk_mul_f32 v[50:51], v[38:39], v[34:35] op_sel:[0,0] op_sel_hi:[0,1]
  v_pk_fma_f32 v[36:37], v[36:37], v[32:33], v[48:49] op_sel:[1,1,0] op_sel_hi:[1,0,1] neg_lo:[1,0,0]
  v_pk_fma_f32 v[38:39], v[38:39], v[34:35], v[50:51] op_sel:[1,1,0] op_sel_hi:[1,0,1] neg_lo:[1,0,0]
  v_cvt_pk_f16_f32 v90, v56, v57
  v_cvt_pk_f16_f32 v91, v58, v59
  ds_write_b64 v155, v[90:91] offset:7392
  v_cvt_pk_f16_f32 v52, v36, v37
  v_cvt_pk_f16_f32 v53, v38, v39
  ds_write_b64 v155, v[52:53] offset:3168
  v_pk_mul_f32 v[44:45], v[56:57], v[86:87] op_sel:[0,0] op_sel_hi:[0,1]
  v_pk_mul_f32 v[46:47], v[58:59], v[88:89] op_sel:[0,0] op_sel_hi:[0,1]
  v_pk_fma_f32 v[94:95], v[56:57], v[86:87], v[44:45] op_sel:[1,1,0] op_sel_hi:[1,0,1] neg_lo:[1,0,0]
  v_pk_fma_f32 v[96:97], v[58:59], v[88:89], v[46:47] op_sel:[1,1,0] op_sel_hi:[1,0,1] neg_lo:[1,0,0]
  v_pk_mul_f32 v[48:49], v[36:37], v[32:33] op_sel:[0,0] op_sel_hi:[0,1]
  v_pk_mul_f32 v[50:51], v[38:39], v[34:35] op_sel:[0,0] op_sel_hi:[0,1]
  v_pk_fma_f32 v[36:37], v[36:37], v[32:33], v[48:49] op_sel:[1,1,0] op_sel_hi:[1,0,1] neg_lo:[1,0,0]
  v_pk_fma_f32 v[38:39], v[38:39], v[34:35], v[50:51] op_sel:[1,1,0] op_sel_hi:[1,0,1] neg_lo:[1,0,0]
  v_cvt_pk_f16_f32 v90, v94, v95
  v_cvt_pk_f16_f32 v91, v96, v97
  ds_write_b64 v155, v[90:91] offset:7920
  v_cvt_pk_f16_f32 v52, v36, v37
  v_cvt_pk_f16_f32 v53, v38, v39
  ds_write_b64 v155, v[52:53] offset:3696
  v_pk_mul_f32 v[44:45], v[56:57], v[40:41] op_sel:[0,0] op_sel_hi:[0,1]
  v_pk_mul_f32 v[46:47], v[58:59], v[42:43] op_sel:[0,0] op_sel_hi:[0,1]
  v_pk_fma_f32 v[56:57], v[56:57], v[40:41], v[44:45] op_sel:[1,1,0] op_sel_hi:[1,0,1] neg_lo:[1,0,0]
  v_pk_fma_f32 v[58:59], v[58:59], v[42:43], v[46:47] op_sel:[1,1,0] op_sel_hi:[1,0,1] neg_lo:[1,0,0]
  v_cvt_pk_f16_f32 v52, v56, v57
  v_cvt_pk_f16_f32 v53, v58, v59
  ds_write_b64 v155, v[52:53] offset:8448
  v_pk_mul_f32 v[44:45], v[56:57], v[40:41] op_sel:[0,0] op_sel_hi:[0,1]
  v_pk_mul_f32 v[46:47], v[58:59], v[42:43] op_sel:[0,0] op_sel_hi:[0,1]
  v_pk_fma_f32 v[56:57], v[56:57], v[40:41], v[44:45] op_sel:[1,1,0] op_sel_hi:[1,0,1] neg_lo:[1,0,0]
  v_pk_fma_f32 v[58:59], v[58:59], v[42:43], v[46:47] op_sel:[1,1,0] op_sel_hi:[1,0,1] neg_lo:[1,0,0]
  v_cvt_pk_f16_f32 v54, v56, v57
  v_cvt_pk_f16_f32 v55, v58, v59
  ds_write_b64 v155, v[54:55] offset:8976
  v_pk_mul_f32 v[44:45], v[56:57], v[40:41] op_sel:[0,0] op_sel_hi:[0,1]
  v_pk_mul_f32 v[46:47], v[58:59], v[42:43] op_sel:[0,0] op_sel_hi:[0,1]
  v_pk_fma_f32 v[56:57], v[56:57], v[40:41], v[44:45] op_sel:[1,1,0] op_sel_hi:[1,0,1] neg_lo:[1,0,0]
  v_pk_fma_f32 v[58:59], v[58:59], v[42:43], v[46:47] op_sel:[1,1,0] op_sel_hi:[1,0,1] neg_lo:[1,0,0]
  v_cvt_pk_f16_f32 v52, v56, v57
  v_cvt_pk_f16_f32 v53, v58, v59
  ds_write_b64 v155, v[52:53] offset:9504
  v_pk_mul_f32 v[44:45], v[56:57], v[40:41] op_sel:[0,0] op_sel_hi:[0,1]
  v_pk_mul_f32 v[46:47], v[58:59], v[42:43] op_sel:[0,0] op_sel_hi:[0,1]
  v_pk_fma_f32 v[56:57], v[56:57], v[40:41], v[44:45] op_sel:[1,1,0] op_sel_hi:[1,0,1] neg_lo:[1,0,0]
  v_pk_fma_f32 v[58:59], v[58:59], v[42:43], v[46:47] op_sel:[1,1,0] op_sel_hi:[1,0,1] neg_lo:[1,0,0]
  v_cvt_pk_f16_f32 v54, v56, v57
  v_cvt_pk_f16_f32 v55, v58, v59
  ds_write_b64 v155, v[54:55] offset:10032
  v_pk_mul_f32 v[44:45], v[56:57], v[40:41] op_sel:[0,0] op_sel_hi:[0,1]
  v_pk_mul_f32 v[46:47], v[58:59], v[42:43] op_sel:[0,0] op_sel_hi:[0,1]
  v_pk_fma_f32 v[56:57], v[56:57], v[40:41], v[44:45] op_sel:[1,1,0] op_sel_hi:[1,0,1] neg_lo:[1,0,0]
  v_pk_fma_f32 v[58:59], v[58:59], v[42:43], v[46:47] op_sel:[1,1,0] op_sel_hi:[1,0,1] neg_lo:[1,0,0]
  v_cvt_pk_f16_f32 v52, v56, v57
  v_cvt_pk_f16_f32 v53, v58, v59
  ds_write_b64 v155, v[52:53] offset:10560
  v_mov_b32 v48, s56
  s_lshl_b32 s5, s22, 2
  v_mov_b32 v49, s5
  v_add_u32 v49, 150144, v49
  s_mov_b64 exec, 1
  ds_write_b32 v49, v48
  s_mov_b64 exec, -1
kb_join:
  s_waitcnt lgkmcnt(0)
  s_barrier
  s_add_u32 s27, s27, 16384
  buffer_load_dwordx4 v[200:203], v188, s[8:11], s27 offen offset:0
  buffer_load_dwordx4 v[204:207], v188, s[8:11], s27 offen offset:256
  s_add_u32 s27, s27, 16384
  buffer_load_dwordx4 v[208:211], v188, s[8:11], s27 offen offset:0
  buffer_load_dwordx4 v[212:215], v188, s[8:11], s27 offen offset:256
  ds_read_b128 v[96:99], v153 offset:0
  ds_read_b128 v[100:103], v153 offset:8448
  ds_read_b128 v[104:107], v154 offset:0
  ds_read_b128 v[108:111], v153 offset:64
  ds_read_b128 v[112:115], v153 offset:8512
  ds_read_b128 v[116:119], v154 offset:64
  ds_read_b128 v[120:123], v153 offset:128
  ds_read_b128 v[124:127], v153 offset:8576
  ds_read_b128 v[128:131], v154 offset:128
  ds_read_b128 v[132:135], v153 offset:192
  ds_read_b128 v[136:139], v153 offset:8640
  ds_read_b128 v[140:143], v154 offset:192
  s_lshl_b32 s5, s22, 2
  s_add_u32 s5, s5, 150144
  v_mov_b32 v15, s5
  ds_read_b32 v15, v15
  s_waitcnt vmcnt(6)
  v_rcp_f32 v52, v181
  v_rcp_f32 v54, v183
  v_rcp_f32 v56, v185
  v_rcp_f32 v58, v187
  v_lshlrev_b32 v84, 16, v172
  v_and_b32 v85, 0xffff0000, v172
  v_lshlrev_b32 v86, 16, v173
  v_and_b32 v87, 0xffff0000, v173
  v_lshlrev_b32 v92, 16, v174
  v_and_b32 v93, 0xffff0000, v174
  v_lshlrev_b32 v94, 16, v175
  v_and_b32 v95, 0xffff0000, v175
  v_pk_add_f32 v[84:85], v[84:85], v[180:181] op_sel:[0,0] op_sel_hi:[1,0] neg_lo:[0,1] neg_hi:[0,1]
  v_pk_add_f32 v[86:87], v[86:87], v[180:181] op_sel:[0,0] op_sel_hi:[1,0] neg_lo:[0,1] neg_hi:[0,1]
  v_pk_add_f32 v[92:93], v[92:93], v[182:183] op_sel:[0,0] op_sel_hi:[1,0] neg_lo:[0,1] neg_hi:[0,1]
  v_pk_add_f32 v[94:95], v[94:95], v[182:183] op_sel:[0,0] op_sel_hi:[1,0] neg_lo:[0,1] neg_hi:[0,1]
  v_cvt_pk_bf16_f32 v18, v84, v85
  v_cvt_pk_bf16_f32 v19, v86, v87
  v_cvt_pk_bf16_f32 v22, v92, v93
  v_cvt_pk_bf16_f32 v23, v94, v95
  v_lshlrev_b32 v84, 16, v18
  v_and_b32 v85, 0xffff0000, v18
  v_lshlrev_b32 v86, 16, v19
  v_and_b32 v87, 0xffff0000, v19
  s_waitcnt lgkmcnt(10)
  v_mfma_f32_16x16x32_f16 v[40:43], v[96:99], v[104:107], 0
  v_mfma_f32_16x16x32_f16 v[44:47], v[100:103], v[104:107], 0
  v_lshlrev_b32 v92, 16, v22
  v_and_b32 v93, 0xffff0000, v22
  v_lshlrev_b32 v94, 16, v23
  v_and_b32 v95, 0xffff0000, v23
  ds_read_b128 v[96:99], v153 offset:256
  ds_read_b128 v[100:103], v153 offset:8704
  ds_read_b128 v[104:107], v154 offset:256
  s_waitcnt lgkmcnt(10)
  v_mfma_f32_16x16x32_f16 v[40:43], v[108:111], v[116:119], v[40:43]
  v_mfma_f32_16x16x32_f16 v[44:47], v[112:115], v[116:119], v[44:47]
  v_pk_mul_f32 v[88:89], v[84:85], v[52:53] op_sel:[0,0] op_sel_hi:[1,0]
  v_pk_mul_f32 v[90:91], v[86:87], v[52:53] op_sel:[0,0] op_sel_hi:[1,0]
  v_pk_mul_f32 v[60:61], v[92:93], v[54:55] op_sel:[0,0] op_sel_hi:[1,0]
  v_pk_mul_f32 v[62:63], v[94:95], v[54:55] op_sel:[0,0] op_sel_hi:[1,0]
  ds_read_b128 v[108:111], v153 offset:320
  ds_read_b128 v[112:115], v153 offset:8768
  ds_read_b128 v[116:119], v154 offset:320
  s_waitcnt lgkmcnt(10)
  v_mfma_f32_16x16x32_f16 v[40:43], v[120:123], v[128:131], v[40:43]
  v_mfma_f32_16x16x32_f16 v[44:47], v[124:127], v[128:131], v[44:47]
  v_pk_fma_f32 v[84:85], v[88:89], v[180:181], v[84:85] op_sel:[0,1,0] op_sel_hi:[1,1,1] neg_lo:[1,0,0] neg_hi:[1,0,0]
  v_pk_fma_f32 v[86:87], v[90:91], v[180:181], v[86:87] op_sel:[0,1,0] op_sel_hi:[1,1,1] neg_lo:[1,0,0] neg_hi:[1,0,0]
  v_pk_fma_f32 v[92:93], v[60:61], v[182:183], v[92:93] op_sel:[0,1,0] op_sel_hi:[1,1,1] neg_lo:[1,0,0] neg_hi:[1,0,0]
  v_pk_fma_f32 v[94:95], v[62:63], v[182:183], v[94:95] op_sel:[0,1,0] op_sel_hi:[1,1,1] neg_lo:[1,0,0] neg_hi:[1,0,0]
  ds_read_b128 v[120:123], v153 offset:384
  ds_read_b128 v[124:127], v153 offset:8832
  ds_read_b128 v[128:131], v154 offset:384
  s_waitcnt lgkmcnt(10)
  v_mfma_f32_16x16x32_f16 v[40:43], v[132:135], v[140:143], v[40:43]
  v_mfma_f32_16x16x32_f16 v[44:47], v[136:139], v[140:143], v[44:47]
  v_pk_fma_f32 v[88:89], v[84:85], v[52:53], v[88:89] op_sel:[0,0,0] op_sel_hi:[1,0,1]
  v_pk_fma_f32 v[90:91], v[86:87], v[52:53], v[90:91] op_sel:[0,0,0] op_sel_hi:[1,0,1]
  v_pk_fma_f32 v[60:61], v[92:93], v[54:55], v[60:61] op_sel:[0,0,0] op_sel_hi:[1,0,1]
  v_pk_fma_f32 v[62:63], v[94:95], v[54:55], v[62:63] op_sel:[0,0,0] op_sel_hi:[1,0,1]
  ds_read_b128 v[132:135], v153 offset:448
  ds_read_b128 v[136:139], v153 offset:8896
  ds_read_b128 v[140:143], v154 offset:448
  v_cvt_pk_bf16_f32 v18, v88, v89
  v_cvt_pk_bf16_f32 v19, v90, v91
  v_cvt_pk_bf16_f32 v22, v60, v61
  v_cvt_pk_bf16_f32 v23, v62, v63
  v_lshlrev_b32 v84, 16, v18
  v_and_b32 v85, 0xffff0000, v18
  v_lshlrev_b32 v86, 16, v19
  v_and_b32 v87, 0xffff0000, v19
  v_lshlrev_b32 v92, 16, v22
  v_and_b32 v93, 0xffff0000, v22
  v_lshlrev_b32 v94, 16, v23
  v_and_b32 v95, 0xffff0000, v23
  v_cvt_pk_f16_f32 v32, v84, v92
  v_cvt_pk_f16_f32 v33, v85, v93
  v_cvt_pk_f16_f32 v34, v86, v94
  v_cvt_pk_f16_f32 v35, v87, v95
  v_lshlrev_b32 v84, 16, v176
  v_and_b32 v85, 0xffff0000, v176
  v_lshlrev_b32 v86, 16, v177
  v_and_b32 v87, 0xffff0000, v177
  v_lshlrev_b32 v92, 16, v178
  v_and_b32 v93, 0xffff0000, v178
  v_lshlrev_b32 v94, 16, v179
  v_and_b32 v95, 0xffff0000, v179
  s_waitcnt lgkmcnt(9)
  v_mfma_f32_16x16x32_f16 v[40:43], v[96:99], v[104:107], v[40:43]
  v_mfma_f32_16x16x32_f16 v[44:47], v[100:103], v[104:107], v[44:47]
  v_pk_add_f32 v[84:85], v[84:85], v[184:185] op_sel:[0,0] op_sel_hi:[1,0] neg_lo:[0,1] neg_hi:[0,1]
  v_pk_add_f32 v[86:87], v[86:87], v[184:185] op_sel:[0,0] op_sel_hi:[1,0] neg_lo:[0,1] neg_hi:[0,1]
  v_pk_add_f32 v[92:93], v[92:93], v[186:187] op_sel:[0,0] op_sel_hi:[1,0] neg_lo:[0,1] neg_hi:[0,1]
  v_pk_add_f32 v[94:95], v[94:95], v[186:187] op_sel:[0,0] op_sel_hi:[1,0] neg_lo:[0,1] neg_hi:[0,1]
  s_waitcnt lgkmcnt(6)
  v_mfma_f32_16x16x32_f16 v[40:43], v[108:111], v[116:119], v[40:43]
  v_mfma_f32_16x16x32_f16 v[44:47], v[112:115], v[116:119], v[44:47]
  v_cvt_pk_bf16_f32 v26, v84, v85
  v_cvt_pk_bf16_f32 v27, v86, v87
  v_cvt_pk_bf16_f32 v30, v92, v93
  v_cvt_pk_bf16_f32 v31, v94, v95
  s_waitcnt lgkmcnt(3)
  v_mfma_f32_16x16x32_f16 v[40:43], v[120:123], v[128:131], v[40:43]
  v_mfma_f32_16x16x32_f16 v[44:47], v[124:127], v[128:131], v[44:47]
  v_lshlrev_b32 v84, 16, v26
  v_and_b32 v85, 0xffff0000, v26
  v_lshlrev_b32 v86, 16, v27
  v_and_b32 v87, 0xffff0000, v27
  s_waitcnt lgkmcnt(0)
  v_mfma_f32_16x16x32_f16 v[40:43], v[132:135], v[140:143], v[40:43]
  v_mfma_f32_16x16x32_f16 v[44:47], v[136:139], v[140:143], v[44:47]
  v_lshlrev_b32 v92, 16, v30
  v_and_b32 v93, 0xffff0000, v30
  v_lshlrev_b32 v94, 16, v31
  v_and_b32 v95, 0xffff0000, v31
  v_pk_mul_f32 v[88:89], v[84:85], v[56:57] op_sel:[0,0] op_sel_hi:[1,0]
  v_pk_mul_f32 v[90:91], v[86:87], v[56:57] op_sel:[0,0] op_sel_hi:[1,0]
  v_pk_mul_f32 v[60:61], v[92:93], v[58:59] op_sel:[0,0] op_sel_hi:[1,0]
  v_pk_mul_f32 v[62:63], v[94:95], v[58:59] op_sel:[0,0] op_sel_hi:[1,0]
  v_pk_fma_f32 v[84:85], v[88:89], v[184:185], v[84:85] op_sel:[0,1,0] op_sel_hi:[1,1,1] neg_lo:[1,0,0] neg_hi:[1,0,0]
  v_pk_fma_f32 v[86:87], v[90:91], v[184:185], v[86:87] op_sel:[0,1,0] op_sel_hi:[1,1,1] neg_lo:[1,0,0] neg_hi:[1,0,0]
  v_pk_fma_f32 v[92:93], v[60:61], v[186:187], v[92:93] op_sel:[0,1,0] op_sel_hi:[1,1,1] neg_lo:[1,0,0] neg_hi:[1,0,0]
  v_pk_fma_f32 v[94:95], v[62:63], v[186:187], v[94:95] op_sel:[0,1,0] op_sel_hi:[1,1,1] neg_lo:[1,0,0] neg_hi:[1,0,0]
  v_pk_fma_f32 v[88:89], v[84:85], v[56:57], v[88:89] op_sel:[0,0,0] op_sel_hi:[1,0,1]
  v_pk_fma_f32 v[90:91], v[86:87], v[56:57], v[90:91] op_sel:[0,0,0] op_sel_hi:[1,0,1]
  v_cvt_pk_f16_f32 v48, v40, v41
  v_cvt_pk_f16_f32 v49, v42, v43
  v_cvt_pk_f16_f32 v50, v44, v45
  v_cvt_pk_f16_f32 v51, v46, v47
  ds_write_b32 v150, v48
  ds_write_b32 v151, v49
  ds_write_b16 v152, v50
  ds_write_b16_d16_hi v152, v50 offset:64
  ds_write_b16 v152, v51 offset:128
  ds_write_b16_d16_hi v152, v51 offset:192
  v_pk_fma_f32 v[60:61], v[92:93], v[58:59], v[60:61] op_sel:[0,0,0] op_sel_hi:[1,0,1]
  v_pk_fma_f32 v[62:63], v[94:95], v[58:59], v[62:63] op_sel:[0,0,0] op_sel_hi:[1,0,1]
  v_cvt_pk_bf16_f32 v26, v88, v89
  v_cvt_pk_bf16_f32 v27, v90, v91
  v_cvt_pk_bf16_f32 v30, v60, v61
  v_cvt_pk_bf16_f32 v31, v62, v63
  v_lshlrev_b32 v84, 16, v26
  v_and_b32 v85, 0xffff0000, v26
  s_waitcnt lgkmcnt(0)
  s_barrier
  s_cmp_eq_u32 s23, 0
  s_cbranch_scc1 kb_g0
  ds_read_u16 v96, v64
  ds_read_u16 v97, v65
  ds_read_u16 v98, v66
  ds_read_u16 v99, v67
  ds_read_u16 v100, v68
  ds_read_u16 v101, v69
  ds_read_u16 v102, v70
  ds_read_u16 v103, v71
  ds_read_u16 v104, v72
  ds_read_u16 v105, v73
  ds_read_u16 v106, v74
  ds_read_u16 v107, v75
  ds_read_u16 v108, v76
  ds_read_u16 v109, v77
  ds_read_u16 v110, v78
  ds_read_u16 v111, v79
  ds_read_u16 v112, v80
  ds_read_u16 v113, v81
  ds_read_u16 v114, v82
  s_branch kb_g1
kb_g0:
  ds_read_u16 v96, v64 offset:0
  ds_read_u16 v97, v64 offset:2
  ds_read_u16 v98, v64 offset:4
  ds_read_u16 v99, v65
kb_g1:
  ds_write_b128 v161, v[144:147]
  ds_write_b128 v161, v[144:147] offset:1024
  s_mov_b64 exec, 0xffff
  ds_write_b128 v162, v[144:147] offset:2048
  s_mov_b64 exec, 1
  ds_write_b64 v163, v[144:145]
  s_mov_b64 exec, 0x7f
  ds_write_b128 v164, v[144:147] offset:4096
  ds_write_b128 v164, v[144:147] offset:8512
  s_mov_b64 exec, -1
  s_add_u32 s27, s27, 16384
  buffer_load_dwordx4 v[216:219], v188, s[8:11], s27 offen offset:0
  buffer_load_dwordx4 v[220:223], v188, s[8:11], s27 offen offset:256
  s_add_u32 s27, s27, 16384
  buffer_load_dwordx4 v[224:227], v188, s[8:11], s27 offen offset:0
  buffer_load_dwordx4 v[228:231], v188, s[8:11], s27 offen offset:256
  v_lshlrev_b32 v86, 16, v27
  v_and_b32 v87, 0xffff0000, v27
  v_lshlrev_b32 v92, 16, v30
  v_and_b32 v93, 0xffff0000, v30
  v_lshlrev_b32 v94, 16, v31
  v_and_b32 v95, 0xffff0000, v31
  v_cvt_pk_f16_f32 v36, v84, v92
  v_cvt_pk_f16_f32 v37, v85, v93
  v_cvt_pk_f16_f32 v38, v86, v94
  v_cvt_pk_f16_f32 v39, v87, v95
  ds_write_b32 v165, v32 offset:0
  ds_write_b32 v165, v32 offset:7048
  ds_write_b32 v165, v33 offset:13968
  ds_write_b32 v165, v33 offset:21016
  ds_write_b32 v165, v34 offset:27936
  ds_write_b32 v165, v34 offset:34984
  ds_write_b32 v165, v35 offset:41904
  ds_write_b32 v165, v35 offset:48952
  s_waitcnt lgkmcnt(14)
  s_cmp_eq_u32 s23, 0
  s_cbranch_scc1 kb_p0
  v_lshl_or_b32 v64, v100, 16, v99
  v_lshl_or_b32 v65, v102, 16, v101
  v_lshl_or_b32 v66, v104, 16, v103
  v_lshl_or_b32 v67, v106, 16, v105
  v_lshl_or_b32 v68, v108, 16, v107
  v_lshl_or_b32 v69, v110, 16, v109
  v_lshl_or_b32 v70, v112, 16, v111
  v_lshl_or_b32 v71, v114, 16, v113
  ds_write_b128 v160, v[64:67] offset:0
  ds_write_b128 v160, v[68:71] offset:16
  ds_write_b32 v165, v36 offset:64
  ds_write_b32 v166, v36 offset:7112
  v_lshl_or_b32 v72, v99, 16, v98
  v_lshl_or_b32 v73, v101, 16, v100
  v_lshl_or_b32 v74, v103, 16, v102
  v_lshl_or_b32 v75, v105, 16, v104
  v_lshl_or_b32 v76, v107, 16, v106
  v_lshl_or_b32 v77, v109, 16, v108
  v_lshl_or_b32 v78, v111, 16, v110
  v_lshl_or_b32 v79, v113, 16, v112
  ds_write_b128 v160, v[72:75] offset:4416
  ds_write_b128 v160, v[76:79] offset:4432
  ds_write_b32 v165, v37 offset:14032
  ds_write_b32 v166, v37 offset:21080
  v_lshl_or_b32 v80, v98, 16, v97
  v_lshl_or_b32 v81, v100, 16, v99
  v_lshl_or_b32 v82, v102, 16, v101
  v_lshl_or_b32 v83, v104, 16, v103
  v_lshl_or_b32 v84, v106, 16, v105
  v_lshl_or_b32 v85, v108, 16, v107
  v_lshl_or_b32 v86, v110, 16, v109
  v_lshl_or_b32 v87, v112, 16, v111
  ds_write_b128 v160, v[80:83] offset:8832
  ds_write_b128 v160, v[84:87] offset:8848
  ds_write_b32 v165, v38 offset:28000
  ds_write_b32 v166, v38 offset:35048
  v_lshl_or_b32 v88, v97, 16, v96
  v_lshl_or_b32 v89, v99, 16, v98
  v_lshl_or_b32 v90, v101, 16, v100
  v_lshl_or_b32 v91, v103, 16, v102
  v_lshl_or_b32 v92, v105, 16, v104
  v_lshl_or_b32 v93, v107, 16, v106
  v_lshl_or_b32 v94, v109, 16, v108
  v_lshl_or_b32 v95, v111, 16, v110
  ds_write_b128 v160, v[88:91] offset:13248
  ds_write_b128 v160, v[92:95] offset:13264
  ds_write_b32 v165, v39 offset:41968
  ds_write_b32 v166, v39 offset:49016
  s_branch kb_p1
kb_p0:
  v_lshl_or_b32 v64, v97, 16, v98
  v_lshl_or_b32 v65, v97, 16, v97
  v_lshl_or_b32 v66, v97, 16, v97
  v_lshl_or_b32 v67, v97, 16, v97
  v_lshl_or_b32 v68, v96, 16, v96
  v_lshl_or_b32 v69, v96, 16, v96
  v_lshl_or_b32 v70, v96, 16, v96
  v_lshl_or_b32 v71, v99, 16, v96
  ds_write_b128 v160, v[64:67] offset:0
  ds_write_b128 v160, v[68:71] offset:16
  ds_write_b32 v165, v36 offset:64
  ds_write_b32 v166, v36 offset:7112
  v_lshl_or_b32 v72, v98, 16, v98
  v_lshl_or_b32 v73, v97, 16, v97
  v_lshl_or_b32 v74, v97, 16, v97
  v_lshl_or_b32 v75, v97, 16, v97
  v_lshl_or_b32 v76, v96, 16, v97
  v_lshl_or_b32 v77, v96, 16, v96
  v_lshl_or_b32 v78, v96, 16, v96
  v_lshl_or_b32 v79, v96, 16, v96
  ds_write_b128 v160, v[72:75] offset:4416
  ds_write_b128 v160, v[76:79] offset:4432
  ds_write_b32 v165, v37 offset:14032
  ds_write_b32 v166, v37 offset:21080
  v_lshl_or_b32 v80, v98, 16, v98
  v_lshl_or_b32 v81, v97, 16, v98
  v_lshl_or_b32 v82, v97, 16, v97
  v_lshl_or_b32 v83, v97, 16, v97
  v_lshl_or_b32 v84, v97, 16, v97
  v_lshl_or_b32 v85, v96, 16, v96
  v_lshl_or_b32 v86, v96, 16, v96
  v_lshl_or_b32 v87, v96, 16, v96
  ds_write_b128 v160, v[80:83] offset:8832
  ds_write_b128 v160, v[84:87] offset:8848
  ds_write_b32 v165, v38 offset:28000
  ds_write_b32 v166, v38 offset:35048
  v_lshl_or_b32 v88, v98, 16, v98
  v_lshl_or_b32 v89, v98, 16, v98
  v_lshl_or_b32 v90, v97, 16, v97
  v_lshl_or_b32 v91, v97, 16, v97
  v_lshl_or_b32 v92, v97, 16, v97
  v_lshl_or_b32 v93, v96, 16, v97
  v_lshl_or_b32 v94, v96, 16, v96
  v_lshl_or_b32 v95, v96, 16, v96
  ds_write_b128 v160, v[88:91] offset:13248
  ds_write_b128 v160, v[92:95] offset:13264
  ds_write_b32 v165, v39 offset:41968
  ds_write_b32 v166, v39 offset:49016
kb_p1:
  v_mov_b32 v12, v167
  v_mov_b32 v14, v168
  v_mov_b32 v13, v169
  v_mov_b32 v8, v170
  v_mov_b32 v5, v171
  s_waitcnt lgkmcnt(0)
  s_barrier
  ds_read_b128 v[64:67], v12 offset:3040
  ds_read_b128 v[68:71], v14 offset:2416
  ds_read_b128 v[72:75], v14 offset:4720
  ds_read_b128 v[76:79], v12 offset:992
  ds_read_b128 v[80:83], v12 offset:3008
  ds_read_b128 v[84:87], v14 offset:2384
  ds_read_b128 v[88:91], v14 offset:4688
  ds_read_b128 v[92:95], v12 offset:960
  ds_read_b128 v[96:99], v12 offset:2976
  ds_read_b128 v[100:103], v14 offset:2352
  ds_read_b128 v[104:107], v14 offset:4656
  ds_read_b128 v[108:111], v12 offset:928
  s_waitcnt lgkmcnt(9)
  v_mfma_f32_32x32x16_f16 v[128:143], v[64:67], v[68:71], 0
  s_lshl_b32 s56, s16, 16
  s_and_b32 s57, s16, 0xffff0000
  s_lshl_b32 s60, s18, 16
  v_mfma_f32_32x32x16_f16 v[144:159], v[64:67], v[72:75], 0
  s_add_u32 s27, s27, 16384
  buffer_load_dwordx4 v[232:235], v188, s[8:11], s27 offen offset:0
  s_and_b32 s61, s18, 0xffff0000
  s_lshl_b32 s58, s17, 16
  s_and_b32 s59, s17, 0xffff0000
  s_waitcnt lgkmcnt(8)
  v_mfma_f32_32x32x16_f16 v[144:159], v[76:79], v[68:71], v[144:159]
  s_lshl_b32 s62, s19, 16
  s_and_b32 s63, s19, 0xffff0000
  v_lshlrev_b32 v32, 16, v18
  ds_read_b128 v[64:67], v12 offset:2944
  ds_read_b128 v[68:71], v14 offset:2320
  ds_read_b128 v[72:75], v14 offset:4624
  ds_read_b128 v[76:79], v12 offset:896
  s_waitcnt lgkmcnt(9)
  v_mfma_f32_32x32x16_f16 v[128:143], v[80:83], v[84:87], v[128:143]
  v_lshlrev_b32 v48, 16, v172
  v_and_b32 v33, 0xffff0000, v18
  v_and_b32 v49, 0xffff0000, v172
  v_mfma_f32_32x32x16_f16 v[144:159], v[80:83], v[88:91], v[144:159]
  buffer_load_dwordx4 v[236:239], v188, s[8:11], s27 offen offset:256
  v_lshlrev_b32 v34, 16, v19
  v_lshlrev_b32 v50, 16, v173
  v_and_b32 v35, 0xffff0000, v19
  s_waitcnt lgkmcnt(8)
  v_mfma_f32_32x32x16_f16 v[144:159], v[92:95], v[84:87], v[144:159]
  v_and_b32 v51, 0xffff0000, v173
  v_lshlrev_b32 v36, 16, v22
  v_lshlrev_b32 v52, 16, v174
  ds_read_b128 v[80:83], v12 offset:2912
  ds_read_b128 v[84:87], v14 offset:2272
  ds_read_b128 v[88:91], v14 offset:4576
  ds_read_b128 v[92:95], v12 offset:864
  s_waitcnt lgkmcnt(9)
  v_mfma_f32_32x32x16_f16 v[128:143], v[96:99], v[100:103], v[128:143]
  v_and_b32 v37, 0xffff0000, v22
  v_and_b32 v53, 0xffff0000, v174
  v_lshlrev_b32 v38, 16, v23
  v_mfma_f32_32x32x16_f16 v[144:159], v[96:99], v[104:107], v[144:159]
  s_add_u32 s27, s27, 16384
  buffer_load_dwordx4 v[240:243], v188, s[8:11], s27 offen offset:0
  v_lshlrev_b32 v54, 16, v175
  v_and_b32 v39, 0xffff0000, v23
  v_and_b32 v55, 0xffff0000, v175
  s_waitcnt lgkmcnt(8)
  v_mfma_f32_32x32x16_f16 v[144:159], v[108:111], v[100:103], v[144:159]
  v_lshlrev_b32 v40, 16, v26
  v_lshlrev_b32 v56, 16, v176
  v_and_b32 v41, 0xffff0000, v26
  ds_read_b128 v[96:99], v12 offset:2880
  ds_read_b128 v[100:103], v14 offset:2240
  ds_read_b128 v[104:107], v14 offset:4544
  ds_read_b128 v[108:111], v12 offset:832
  s_waitcnt lgkmcnt(9)
  v_mfma_f32_32x32x16_f16 v[128:143], v[64:67], v[68:71], v[128:143]
  v_and_b32 v57, 0xffff0000, v176
  v_lshlrev_b32 v42, 16, v27
  v_lshlrev_b32 v58, 16, v177
  v_mfma_f32_32x32x16_f16 v[144:159], v[64:67], v[72:75], v[144:159]
  buffer_load_dwordx4 v[244:247], v188, s[8:11], s27 offen offset:256
  v_and_b32 v43, 0xffff0000, v27
  v_and_b32 v59, 0xffff0000, v177
  v_lshlrev_b32 v44, 16, v30
  s_waitcnt lgkmcnt(8)
  v_mfma_f32_32x32x16_f16 v[144:159], v[76:79], v[68:71], v[144:159]
  v_lshlrev_b32 v60, 16, v178
  v_and_b32 v45, 0xffff0000, v30
  v_and_b32 v61, 0xffff0000, v178
  ds_read_b128 v[64:67], v12 offset:2848
  ds_read_b128 v[68:71], v14 offset:2208
  ds_read_b128 v[72:75], v14 offset:4512
  ds_read_b128 v[76:79], v12 offset:800
  s_waitcnt lgkmcnt(9)
  v_mfma_f32_32x32x16_f16 v[128:143], v[80:83], v[84:87], v[128:143]
  v_lshlrev_b32 v46, 16, v31
  v_lshlrev_b32 v62, 16, v179
  v_and_b32 v47, 0xffff0000, v31
  v_mfma_f32_32x32x16_f16 v[144:159], v[80:83], v[88:91], v[144:159]
  s_add_u32 s27, s27, 16384
  buffer_load_dwordx4 v[248:251], v188, s[8:11], s27 offen offset:0
  v_and_b32 v63, 0xffff0000, v179
  v_mul_f32 v32, s56, v32
  v_mul_f32 v33, s57, v33
  s_waitcnt lgkmcnt(8)
  v_mfma_f32_32x32x16_f16 v[144:159], v[92:95], v[84:87], v[144:159]
  v_mul_f32 v34, s58, v34
  v_mul_f32 v35, s59, v35
  v_mul_f32 v36, s56, v36
  ds_read_b128 v[80:83], v12 offset:2816
  ds_read_b128 v[84:87], v14 offset:2176
  ds_read_b128 v[88:91], v14 offset:4480
  ds_read_b128 v[92:95], v12 offset:768
  s_waitcnt lgkmcnt(9)
  v_mfma_f32_32x32x16_f16 v[128:143], v[96:99], v[100:103], v[128:143]
  v_mul_f32 v37, s57, v37
  v_mul_f32 v38, s58, v38
  v_mul_f32 v39, s59, v39
  v_mfma_f32_32x32x16_f16 v[144:159], v[96:99], v[104:107], v[144:159]
  buffer_load_dwordx4 v[252:255], v188, s[8:11], s27 offen offset:256
  v_mul_f32 v40, s56, v40
  v_mul_f32 v41, s57, v41
  v_mul_f32 v42, s58, v42
  s_waitcnt lgkmcnt(8)
  v_mfma_f32_32x32x16_f16 v[144:159], v[108:111], v[100:103], v[144:159]
  v_mul_f32 v43, s59, v43
  v_mul_f32 v44, s56, v44
  v_mul_f32 v45, s57, v45
  ds_read_b128 v[96:99], v12 offset:2784
  ds_read_b128 v[100:103], v14 offset:2128
  ds_read_b128 v[104:107], v14 offset:4432
  ds_read_b128 v[108:111], v12 offset:736
  s_waitcnt lgkmcnt(9)
  v_mfma_f32_32x32x16_f16 v[128:143], v[64:67], v[68:71], v[128:143]
  v_mul_f32 v46, s58, v46
  v_mul_f32 v47, s59, v47
  v_cvt_pk_bf16_f32 v16, v32, v33
  v_mfma_f32_32x32x16_f16 v[144:159], v[64:67], v[72:75], v[144:159]
  v_cvt_pk_bf16_f32 v17, v34, v35
  v_cvt_pk_bf16_f32 v18, v36, v37
  v_cvt_pk_bf16_f32 v19, v38, v39
  s_waitcnt lgkmcnt(8)
  v_mfma_f32_32x32x16_f16 v[144:159], v[76:79], v[68:71], v[144:159]
  v_lshlrev_b32 v32, 16, v16
  v_lshlrev_b32 v34, 16, v17
  v_lshlrev_b32 v36, 16, v18
  ds_read_b128 v[64:67], v12 offset:2752
  ds_read_b128 v[68:71], v14 offset:2096
  ds_read_b128 v[72:75], v14 offset:4400
  ds_read_b128 v[76:79], v12 offset:704
  s_waitcnt lgkmcnt(9)
  v_mfma_f32_32x32x16_f16 v[128:143], v[80:83], v[84:87], v[128:143]
  v_lshlrev_b32 v38, 16, v19
  v_and_b32 v33, 0xffff0000, v16
  v_and_b32 v35, 0xffff0000, v17
  v_mfma_f32_32x32x16_f16 v[144:159], v[80:83], v[88:91], v[144:159]
  v_and_b32 v37, 0xffff0000, v18
  v_and_b32 v39, 0xffff0000, v19
  v_cvt_pk_bf16_f32 v16, v40, v41
  s_waitcnt lgkmcnt(8)
  v_mfma_f32_32x32x16_f16 v[144:159], v[92:95], v[84:87], v[144:159]
  v_cvt_pk_bf16_f32 v17, v42, v43
  v_cvt_pk_bf16_f32 v18, v44, v45
  v_cvt_pk_bf16_f32 v19, v46, v47
  ds_read_b128 v[80:83], v12 offset:2720
  ds_read_b128 v[84:87], v14 offset:2064
  ds_read_b128 v[88:91], v14 offset:4368
  ds_read_b128 v[92:95], v12 offset:672
  s_waitcnt lgkmcnt(9)
  v_mfma_f32_32x32x16_f16 v[128:143], v[96:99], v[100:103], v[128:143]
  v_mfma_f32_32x32x16_f16 v[144:159], v[96:99], v[104:107], v[144:159]
  s_waitcnt lgkmcnt(8)
  v_mfma_f32_32x32x16_f16 v[144:159], v[108:111], v[100:103], v[144:159]
  ds_read_b128 v[96:99], v12 offset:2688
  ds_read_b128 v[100:103], v14 offset:2032
  ds_read_b128 v[104:107], v14 offset:4336
  ds_read_b128 v[108:111], v12 offset:640
  s_waitcnt lgkmcnt(9)
  v_mfma_f32_32x32x16_f16 v[128:143], v[64:67], v[68:71], v[128:143]
  v_mfma_f32_32x32x16_f16 v[144:159], v[64:67], v[72:75], v[144:159]
  s_waitcnt lgkmcnt(8)
  v_mfma_f32_32x32x16_f16 v[144:159], v[76:79], v[68:71], v[144:159]
  ds_read_b128 v[64:67], v12 offset:2656
  ds_read_b128 v[68:71], v14 offset:1984
  ds_read_b128 v[72:75], v14 offset:4288
  ds_read_b128 v[76:79], v12 offset:608
  s_waitcnt lgkmcnt(9)
  v_mfma_f32_32x32x16_f16 v[128:143], v[80:83], v[84:87], v[128:143]
  v_mfma_f32_32x32x16_f16 v[144:159], v[80:83], v[88:91], v[144:159]
  s_waitcnt lgkmcnt(8)
  v_mfma_f32_32x32x16_f16 v[144:159], v[92:95], v[84:87], v[144:159]
  ds_read_b128 v[80:83], v12 offset:2624
  ds_read_b128 v[84:87], v14 offset:1952
  ds_read_b128 v[88:91], v14 offset:4256
  ds_read_b128 v[92:95], v12 offset:576
  s_waitcnt lgkmcnt(9)
  v_mfma_f32_32x32x16_f16 v[128:143], v[96:99], v[100:103], v[128:143]
  v_mfma_f32_32x32x16_f16 v[144:159], v[96:99], v[104:107], v[144:159]
  s_waitcnt lgkmcnt(8)
  v_mfma_f32_32x32x16_f16 v[144:159], v[108:111], v[100:103], v[144:159]
  ds_read_b128 v[96:99], v12 offset:2592
  ds_read_b128 v[100:103], v14 offset:1920
  ds_read_b128 v[104:107], v14 offset:4224
  ds_read_b128 v[108:111], v12 offset:544
  s_waitcnt lgkmcnt(9)
  v_mfma_f32_32x32x16_f16 v[128:143], v[64:67], v[68:71], v[128:143]
  v_lshlrev_b32 v40, 16, v16
  v_lshlrev_b32 v42, 16, v17
  v_lshlrev_b32 v44, 16, v18
  v_lshlrev_b32 v46, 16, v19
  v_mfma_f32_32x32x16_f16 v[144:159], v[64:67], v[72:75], v[144:159]
  v_and_b32 v41, 0xffff0000, v16
  v_and_b32 v43, 0xffff0000, v17
  v_and_b32 v45, 0xffff0000, v18
  v_and_b32 v47, 0xffff0000, v19
  s_waitcnt lgkmcnt(8)
  v_mfma_f32_32x32x16_f16 v[144:159], v[76:79], v[68:71], v[144:159]
  s_waitcnt vmcnt(12)
  v_fma_mix_f32 v112, v192, 1.0, v200 op_sel:[0,0,0] op_sel_hi:[1,0,1]
  v_fma_mix_f32 v113, v192, 1.0, v200 op_sel:[1,0,1] op_sel_hi:[1,0,1]
  v_fma_mix_f32 v114, v193, 1.0, v201 op_sel:[0,0,0] op_sel_hi:[1,0,1]
  v_fma_mix_f32 v115, v193, 1.0, v201 op_sel:[1,0,1] op_sel_hi:[1,0,1]
  ds_read_b128 v[64:67], v12 offset:2560
  ds_read_b128 v[68:71], v14 offset:1888
  ds_read_b128 v[72:75], v14 offset:4192
  ds_read_b128 v[76:79], v12 offset:512
  s_waitcnt lgkmcnt(9)
  v_mfma_f32_32x32x16_f16 v[128:143], v[80:83], v[84:87], v[128:143]
  v_fma_mix_f32 v116, v194, 1.0, v202 op_sel:[0,0,0] op_sel_hi:[1,0,1]
  v_fma_mix_f32 v117, v194, 1.0, v202 op_sel:[1,0,1] op_sel_hi:[1,0,1]
  v_fma_mix_f32 v118, v195, 1.0, v203 op_sel:[0,0,0] op_sel_hi:[1,0,1]
  v_fma_mix_f32 v119, v195, 1.0, v203 op_sel:[1,0,1] op_sel_hi:[1,0,1]
  v_mfma_f32_32x32x16_f16 v[144:159], v[80:83], v[88:91], v[144:159]
  v_fma_mix_f32 v120, v196, 1.0, v204 op_sel:[0,0,0] op_sel_hi:[1,0,1]
  v_fma_mix_f32 v121, v196, 1.0, v204 op_sel:[1,0,1] op_sel_hi:[1,0,1]
  v_fma_mix_f32 v122, v197, 1.0, v205 op_sel:[0,0,0] op_sel_hi:[1,0,1]
  v_fma_mix_f32 v123, v197, 1.0, v205 op_sel:[1,0,1] op_sel_hi:[1,0,1]
  s_waitcnt lgkmcnt(8)
  v_mfma_f32_32x32x16_f16 v[144:159], v[92:95], v[84:87], v[144:159]
  v_fma_mix_f32 v124, v198, 1.0, v206 op_sel:[0,0,0] op_sel_hi:[1,0,1]
  v_fma_mix_f32 v125, v198, 1.0, v206 op_sel:[1,0,1] op_sel_hi:[1,0,1]
  v_fma_mix_f32 v126, v199, 1.0, v207 op_sel:[0,0,0] op_sel_hi:[1,0,1]
  v_fma_mix_f32 v127, v199, 1.0, v207 op_sel:[1,0,1] op_sel_hi:[1,0,1]
  ds_read_b128 v[80:83], v12 offset:2528
  ds_read_b128 v[84:87], v14 offset:1840
  ds_read_b128 v[88:91], v14 offset:4144
  ds_read_b128 v[92:95], v12 offset:480
  s_waitcnt lgkmcnt(9)
  v_mfma_f32_32x32x16_f16 v[128:143], v[96:99], v[100:103], v[128:143]
  s_waitcnt vmcnt(10)
  v_fma_mix_f32 v112, v208, 1.0, v112 op_sel:[0,0,0] op_sel_hi:[1,0,0]
  v_fma_mix_f32 v113, v208, 1.0, v113 op_sel:[1,0,0] op_sel_hi:[1,0,0]
  v_fma_mix_f32 v114, v209, 1.0, v114 op_sel:[0,0,0] op_sel_hi:[1,0,0]
  v_fma_mix_f32 v115, v209, 1.0, v115 op_sel:[1,0,0] op_sel_hi:[1,0,0]
  v_mfma_f32_32x32x16_f16 v[144:159], v[96:99], v[104:107], v[144:159]
  v_fma_mix_f32 v116, v210, 1.0, v116 op_sel:[0,0,0] op_sel_hi:[1,0,0]
  v_fma_mix_f32 v117, v210, 1.0, v117 op_sel:[1,0,0] op_sel_hi:[1,0,0]
  v_fma_mix_f32 v118, v211, 1.0, v118 op_sel:[0,0,0] op_sel_hi:[1,0,0]
  v_fma_mix_f32 v119, v211, 1.0, v119 op_sel:[1,0,0] op_sel_hi:[1,0,0]
  s_waitcnt lgkmcnt(8)
  v_mfma_f32_32x32x16_f16 v[144:159], v[108:111], v[100:103], v[144:159]
  v_fma_mix_f32 v120, v212, 1.0, v120 op_sel:[0,0,0] op_sel_hi:[1,0,0]
  v_fma_mix_f32 v121, v212, 1.0, v121 op_sel:[1,0,0] op_sel_hi:[1,0,0]
  v_fma_mix_f32 v122, v213, 1.0, v122 op_sel:[0,0,0] op_sel_hi:[1,0,0]
  v_fma_mix_f32 v123, v213, 1.0, v123 op_sel:[1,0,0] op_sel_hi:[1,0,0]
  ds_read_b128 v[96:99], v12 offset:2496
  ds_read_b128 v[100:103], v14 offset:1808
  ds_read_b128 v[104:107], v14 offset:4112
  ds_read_b128 v[108:111], v12 offset:448
  s_waitcnt lgkmcnt(9)
  v_mfma_f32_32x32x16_f16 v[128:143], v[64:67], v[68:71], v[128:143]
  v_fma_mix_f32 v124, v214, 1.0, v124 op_sel:[0,0,0] op_sel_hi:[1,0,0]
  v_fma_mix_f32 v125, v214, 1.0, v125 op_sel:[1,0,0] op_sel_hi:[1,0,0]
  v_fma_mix_f32 v126, v215, 1.0, v126 op_sel:[0,0,0] op_sel_hi:[1,0,0]
  v_fma_mix_f32 v127, v215, 1.0, v127 op_sel:[1,0,0] op_sel_hi:[1,0,0]
  v_mfma_f32_32x32x16_f16 v[144:159], v[64:67], v[72:75], v[144:159]
  s_waitcnt vmcnt(8)
  v_fma_mix_f32 v112, v216, 1.0, v112 op_sel:[0,0,0] op_sel_hi:[1,0,0]
  v_fma_mix_f32 v113, v216, 1.0, v113 op_sel:[1,0,0] op_sel_hi:[1,0,0]
  v_fma_mix_f32 v114, v217, 1.0, v114 op_sel:[0,0,0] op_sel_hi:[1,0,0]
  v_fma_mix_f32 v115, v217, 1.0, v115 op_sel:[1,0,0] op_sel_hi:[1,0,0]
  s_waitcnt lgkmcnt(8)
  v_mfma_f32_32x32x16_f16 v[144:159], v[76:79], v[68:71], v[144:159]
  v_fma_mix_f32 v116, v218, 1.0, v116 op_sel:[0,0,0] op_sel_hi:[1,0,0]
  v_fma_mix_f32 v117, v218, 1.0, v117 op_sel:[1,0,0] op_sel_hi:[1,0,0]
  v_fma_mix_f32 v118, v219, 1.0, v118 op_sel:[0,0,0] op_sel_hi:[1,0,0]
  v_fma_mix_f32 v119, v219, 1.0, v119 op_sel:[1,0,0] op_sel_hi:[1,0,0]
  ds_read_b128 v[64:67], v12 offset:2464
  ds_read_b128 v[68:71], v14 offset:1776
  ds_read_b128 v[72:75], v14 offset:4080
  ds_read_b128 v[76:79], v12 offset:416
  s_waitcnt lgkmcnt(9)
  v_mfma_f32_32x32x16_f16 v[128:143], v[80:83], v[84:87], v[128:143]
  v_fma_mix_f32 v120, v220, 1.0, v120 op_sel:[0,0,0] op_sel_hi:[1,0,0]
  v_fma_mix_f32 v121, v220, 1.0, v121 op_sel:[1,0,0] op_sel_hi:[1,0,0]
  v_fma_mix_f32 v122, v221, 1.0, v122 op_sel:[0,0,0] op_sel_hi:[1,0,0]
  v_fma_mix_f32 v123, v221, 1.0, v123 op_sel:[1,0,0] op_sel_hi:[1,0,0]
  v_mfma_f32_32x32x16_f16 v[144:159], v[80:83], v[88:91], v[144:159]
  v_fma_mix_f32 v124, v222, 1.0, v124 op_sel:[0,0,0] op_sel_hi:[1,0,0]
  v_fma_mix_f32 v125, v222, 1.0, v125 op_sel:[1,0,0] op_sel_hi:[1,0,0]
  v_fma_mix_f32 v126, v223, 1.0, v126 op_sel:[0,0,0] op_sel_hi:[1,0,0]
  v_fma_mix_f32 v127, v223, 1.0, v127 op_sel:[1,0,0] op_sel_hi:[1,0,0]
  s_waitcnt lgkmcnt(8)
  v_mfma_f32_32x32x16_f16 v[144:159], v[92:95], v[84:87], v[144:159]
  s_waitcnt vmcnt(6)
  v_fma_mix_f32 v112, v224, 1.0, v112 op_sel:[0,0,0] op_sel_hi:[1,0,0]
  v_fma_mix_f32 v113, v224, 1.0, v113 op_sel:[1,0,0] op_sel_hi:[1,0,0]
  v_fma_mix_f32 v114, v225, 1.0, v114 op_sel:[0,0,0] op_sel_hi:[1,0,0]
  v_fma_mix_f32 v115, v225, 1.0, v115 op_sel:[1,0,0] op_sel_hi:[1,0,0]
  ds_read_b128 v[80:83], v12 offset:2432
  ds_read_b128 v[84:87], v14 offset:1744
  ds_read_b128 v[88:91], v14 offset:4048
  ds_read_b128 v[92:95], v12 offset:384
  s_waitcnt lgkmcnt(9)
  v_mfma_f32_32x32x16_f16 v[128:143], v[96:99], v[100:103], v[128:143]
  v_fma_mix_f32 v116, v226, 1.0, v116 op_sel:[0,0,0] op_sel_hi:[1,0,0]
  v_fma_mix_f32 v117, v226, 1.0, v117 op_sel:[1,0,0] op_sel_hi:[1,0,0]
  v_fma_mix_f32 v118, v227, 1.0, v118 op_sel:[0,0,0] op_sel_hi:[1,0,0]
  v_fma_mix_f32 v119, v227, 1.0, v119 op_sel:[1,0,0] op_sel_hi:[1,0,0]
  v_mfma_f32_32x32x16_f16 v[144:159], v[96:99], v[104:107], v[144:159]
  v_fma_mix_f32 v120, v228, 1.0, v120 op_sel:[0,0,0] op_sel_hi:[1,0,0]
  v_fma_mix_f32 v121, v228, 1.0, v121 op_sel:[1,0,0] op_sel_hi:[1,0,0]
  v_fma_mix_f32 v122, v229, 1.0, v122 op_sel:[0,0,0] op_sel_hi:[1,0,0]
  v_fma_mix_f32 v123, v229, 1.0, v123 op_sel:[1,0,0] op_sel_hi:[1,0,0]
  s_waitcnt lgkmcnt(8)
  v_mfma_f32_32x32x16_f16 v[144:159], v[108:111], v[100:103], v[144:159]
  v_fma_mix_f32 v124, v230, 1.0, v124 op_sel:[0,0,0] op_sel_hi:[1,0,0]
  v_fma_mix_f32 v125, v230, 1.0, v125 op_sel:[1,0,0] op_sel_hi:[1,0,0]
  v_fma_mix_f32 v126, v231, 1.0, v126 op_sel:[0,0,0] op_sel_hi:[1,0,0]
  v_fma_mix_f32 v127, v231, 1.0, v127 op_sel:[1,0,0] op_sel_hi:[1,0,0]
  ds_read_b128 v[96:99], v12 offset:2400
  ds_read_b128 v[100:103], v14 offset:1696
  ds_read_b128 v[104:107], v14 offset:4000
  ds_read_b128 v[108:111], v12 offset:352
  s_waitcnt lgkmcnt(9)
  v_mfma_f32_32x32x16_f16 v[128:143], v[64:67], v[68:71], v[128:143]
  s_waitcnt vmcnt(4)
  v_fma_mix_f32 v112, v232, 1.0, v112 op_sel:[0,0,0] op_sel_hi:[1,0,0]
  v_fma_mix_f32 v113, v232, 1.0, v113 op_sel:[1,0,0] op_sel_hi:[1,0,0]
  v_fma_mix_f32 v114, v233, 1.0, v114 op_sel:[0,0,0] op_sel_hi:[1,0,0]
  v_fma_mix_f32 v115, v233, 1.0, v115 op_sel:[1,0,0] op_sel_hi:[1,0,0]
  v_mfma_f32_32x32x16_f16 v[144:159], v[64:67], v[72:75], v[144:159]
  v_fma_mix_f32 v116, v234, 1.0, v116 op_sel:[0,0,0] op_sel_hi:[1,0,0]
  v_fma_mix_f32 v117, v234, 1.0, v117 op_sel:[1,0,0] op_sel_hi:[1,0,0]
  v_fma_mix_f32 v118, v235, 1.0, v118 op_sel:[0,0,0] op_sel_hi:[1,0,0]
  v_fma_mix_f32 v119, v235, 1.0, v119 op_sel:[1,0,0] op_sel_hi:[1,0,0]
  s_waitcnt lgkmcnt(8)
  v_mfma_f32_32x32x16_f16 v[144:159], v[76:79], v[68:71], v[144:159]
  v_fma_mix_f32 v120, v236, 1.0, v120 op_sel:[0,0,0] op_sel_hi:[1,0,0]
  v_fma_mix_f32 v121, v236, 1.0, v121 op_sel:[1,0,0] op_sel_hi:[1,0,0]
  v_fma_mix_f32 v122, v237, 1.0, v122 op_sel:[0,0,0] op_sel_hi:[1,0,0]
  v_fma_mix_f32 v123, v237, 1.0, v123 op_sel:[1,0,0] op_sel_hi:[1,0,0]
  ds_read_b128 v[64:67], v12 offset:2368
  ds_read_b128 v[68:71], v14 offset:1664
  ds_read_b128 v[72:75], v14 offset:3968
  ds_read_b128 v[76:79], v12 offset:320
  s_waitcnt lgkmcnt(9)
  v_mfma_f32_32x32x16_f16 v[128:143], v[80:83], v[84:87], v[128:143]
  v_fma_mix_f32 v124, v238, 1.0, v124 op_sel:[0,0,0] op_sel_hi:[1,0,0]
  v_fma_mix_f32 v125, v238, 1.0, v125 op_sel:[1,0,0] op_sel_hi:[1,0,0]
  v_fma_mix_f32 v126, v239, 1.0, v126 op_sel:[0,0,0] op_sel_hi:[1,0,0]
  v_fma_mix_f32 v127, v239, 1.0, v127 op_sel:[1,0,0] op_sel_hi:[1,0,0]
  v_mfma_f32_32x32x16_f16 v[144:159], v[80:83], v[88:91], v[144:159]
  s_waitcnt vmcnt(2)
  v_fma_mix_f32 v112, v240, 1.0, v112 op_sel:[0,0,0] op_sel_hi:[1,0,0]
  v_fma_mix_f32 v113, v240, 1.0, v113 op_sel:[1,0,0] op_sel_hi:[1,0,0]
  v_fma_mix_f32 v114, v241, 1.0, v114 op_sel:[0,0,0] op_sel_hi:[1,0,0]
  v_fma_mix_f32 v115, v241, 1.0, v115 op_sel:[1,0,0] op_sel_hi:[1,0,0]
  s_waitcnt lgkmcnt(8)
  v_mfma_f32_32x32x16_f16 v[144:159], v[92:95], v[84:87], v[144:159]
  v_fma_mix_f32 v116, v242, 1.0, v116 op_sel:[0,0,0] op_sel_hi:[1,0,0]
  v_fma_mix_f32 v117, v242, 1.0, v117 op_sel:[1,0,0] op_sel_hi:[1,0,0]
  v_fma_mix_f32 v118, v243, 1.0, v118 op_sel:[0,0,0] op_sel_hi:[1,0,0]
  v_fma_mix_f32 v119, v243, 1.0, v119 op_sel:[1,0,0] op_sel_hi:[1,0,0]
  ds_read_b128 v[80:83], v12 offset:2336
  ds_read_b128 v[84:87], v14 offset:1632
  ds_read_b128 v[88:91], v14 offset:3936
  ds_read_b128 v[92:95], v12 offset:288
  s_waitcnt lgkmcnt(9)
  v_mfma_f32_32x32x16_f16 v[128:143], v[96:99], v[100:103], v[128:143]
  v_fma_mix_f32 v120, v244, 1.0, v120 op_sel:[0,0,0] op_sel_hi:[1,0,0]
  v_fma_mix_f32 v121, v244, 1.0, v121 op_sel:[1,0,0] op_sel_hi:[1,0,0]
  v_fma_mix_f32 v122, v245, 1.0, v122 op_sel:[0,0,0] op_sel_hi:[1,0,0]
  v_fma_mix_f32 v123, v245, 1.0, v123 op_sel:[1,0,0] op_sel_hi:[1,0,0]
  v_mfma_f32_32x32x16_f16 v[144:159], v[96:99], v[104:107], v[144:159]
  v_fma_mix_f32 v124, v246, 1.0, v124 op_sel:[0,0,0] op_sel_hi:[1,0,0]
  v_fma_mix_f32 v125, v246, 1.0, v125 op_sel:[1,0,0] op_sel_hi:[1,0,0]
  v_fma_mix_f32 v126, v247, 1.0, v126 op_sel:[0,0,0] op_sel_hi:[1,0,0]
  v_fma_mix_f32 v127, v247, 1.0, v127 op_sel:[1,0,0] op_sel_hi:[1,0,0]
  s_waitcnt lgkmcnt(8)
  v_mfma_f32_32x32x16_f16 v[144:159], v[108:111], v[100:103], v[144:159]
  s_waitcnt vmcnt(0)
  v_fma_mix_f32 v112, v248, 1.0, v112 op_sel:[0,0,0] op_sel_hi:[1,0,0]
  v_fma_mix_f32 v113, v248, 1.0, v113 op_sel:[1,0,0] op_sel_hi:[1,0,0]
  v_fma_mix_f32 v114, v249, 1.0, v114 op_sel:[0,0,0] op_sel_hi:[1,0,0]
  v_fma_mix_f32 v115, v249, 1.0, v115 op_sel:[1,0,0] op_sel_hi:[1,0,0]
  ds_read_b128 v[96:99], v12 offset:2304
  ds_read_b128 v[100:103], v14 offset:1600
  ds_read_b128 v[104:107], v14 offset:3904
  ds_read_b128 v[108:111], v12 offset:256
  s_waitcnt lgkmcnt(9)
  v_mfma_f32_32x32x16_f16 v[128:143], v[64:67], v[68:71], v[128:143]
  v_fma_mix_f32 v116, v250, 1.0, v116 op_sel:[0,0,0] op_sel_hi:[1,0,0]
  v_fma_mix_f32 v117, v250, 1.0, v117 op_sel:[1,0,0] op_sel_hi:[1,0,0]
  v_fma_mix_f32 v118, v251, 1.0, v118 op_sel:[0,0,0] op_sel_hi:[1,0,0]
  v_fma_mix_f32 v119, v251, 1.0, v119 op_sel:[1,0,0] op_sel_hi:[1,0,0]
  v_mfma_f32_32x32x16_f16 v[144:159], v[64:67], v[72:75], v[144:159]
  v_fma_mix_f32 v120, v252, 1.0, v120 op_sel:[0,0,0] op_sel_hi:[1,0,0]
  v_fma_mix_f32 v121, v252, 1.0, v121 op_sel:[1,0,0] op_sel_hi:[1,0,0]
  v_fma_mix_f32 v122, v253, 1.0, v122 op_sel:[0,0,0] op_sel_hi:[1,0,0]
  v_fma_mix_f32 v123, v253, 1.0, v123 op_sel:[1,0,0] op_sel_hi:[1,0,0]
  s_waitcnt lgkmcnt(8)
  v_mfma_f32_32x32x16_f16 v[144:159], v[76:79], v[68:71], v[144:159]
  v_fma_mix_f32 v124, v254, 1.0, v124 op_sel:[0,0,0] op_sel_hi:[1,0,0]
  v_fma_mix_f32 v125, v254, 1.0, v125 op_sel:[1,0,0] op_sel_hi:[1,0,0]
  v_fma_mix_f32 v126, v255, 1.0, v126 op_sel:[0,0,0] op_sel_hi:[1,0,0]
  v_fma_mix_f32 v127, v255, 1.0, v127 op_sel:[1,0,0] op_sel_hi:[1,0,0]
  ds_read_b128 v[64:67], v12 offset:2272
  ds_read_b128 v[68:71], v14 offset:1552
  ds_read_b128 v[72:75], v14 offset:3856
  ds_read_b128 v[76:79], v12 offset:224
  s_waitcnt lgkmcnt(9)
  v_mfma_f32_32x32x16_f16 v[128:143], v[80:83], v[84:87], v[128:143]
  v_cvt_pk_bf16_f32 v16, v112, v113
  v_cvt_pk_bf16_f32 v17, v114, v115
  v_cvt_pk_bf16_f32 v18, v116, v117
  v_cvt_pk_bf16_f32 v19, v118, v119
  v_mfma_f32_32x32x16_f16 v[144:159], v[80:83], v[88:91], v[144:159]
  v_lshlrev_b32 v112, 16, v16
  v_lshlrev_b32 v114, 16, v17
  v_lshlrev_b32 v116, 16, v18
  v_lshlrev_b32 v118, 16, v19
  s_waitcnt lgkmcnt(8)
  v_mfma_f32_32x32x16_f16 v[144:159], v[92:95], v[84:87], v[144:159]
  v_and_b32 v113, 0xffff0000, v16
  v_and_b32 v115, 0xffff0000, v17
  v_and_b32 v117, 0xffff0000, v18
  v_and_b32 v119, 0xffff0000, v19
  ds_read_b128 v[80:83], v12 offset:2240
  ds_read_b128 v[84:87], v14 offset:1520
  ds_read_b128 v[88:91], v14 offset:3824
  ds_read_b128 v[92:95], v12 offset:192
  s_waitcnt lgkmcnt(9)
  v_mfma_f32_32x32x16_f16 v[128:143], v[96:99], v[100:103], v[128:143]
  v_cvt_pk_bf16_f32 v16, v120, v121
  v_cvt_pk_bf16_f32 v17, v122, v123
  v_cvt_pk_bf16_f32 v18, v124, v125
  v_cvt_pk_bf16_f32 v19, v126, v127
  v_mfma_f32_32x32x16_f16 v[144:159], v[96:99], v[104:107], v[144:159]
  v_lshlrev_b32 v120, 16, v16
  v_lshlrev_b32 v122, 16, v17
  v_lshlrev_b32 v124, 16, v18
  v_lshlrev_b32 v126, 16, v19
  s_waitcnt lgkmcnt(8)
  v_mfma_f32_32x32x16_f16 v[144:159], v[108:111], v[100:103], v[144:159]
  v_and_b32 v121, 0xffff0000, v16
  v_and_b32 v123, 0xffff0000, v17
  v_and_b32 v125, 0xffff0000, v18
  v_and_b32 v127, 0xffff0000, v19
  ds_read_b128 v[96:99], v12 offset:2208
  ds_read_b128 v[100:103], v14 offset:1488
  ds_read_b128 v[104:107], v14 offset:3792
  ds_read_b128 v[108:111], v12 offset:160
  s_waitcnt lgkmcnt(9)
  v_mfma_f32_32x32x16_f16 v[128:143], v[64:67], v[68:71], v[128:143]
  v_add_f32 v112, s60, v112
  v_add_f32 v113, s61, v113
  v_add_f32 v114, s62, v114
  v_add_f32 v115, s63, v115
  v_mfma_f32_32x32x16_f16 v[144:159], v[64:67], v[72:75], v[144:159]
  v_add_f32 v116, s60, v116
  v_add_f32 v117, s61, v117
  v_add_f32 v118, s62, v118
  v_add_f32 v119, s63, v119
  s_waitcnt lgkmcnt(8)
  v_mfma_f32_32x32x16_f16 v[144:159], v[76:79], v[68:71], v[144:159]
  v_add_f32 v120, s60, v120
  v_add_f32 v121, s61, v121
  v_add_f32 v122, s62, v122
  v_add_f32 v123, s63, v123
  ds_read_b128 v[64:67], v12 offset:2176
  ds_read_b128 v[68:71], v14 offset:1456
  ds_read_b128 v[72:75], v14 offset:3760
  ds_read_b128 v[76:79], v12 offset:128
  s_waitcnt lgkmcnt(9)
  v_mfma_f32_32x32x16_f16 v[128:143], v[80:83], v[84:87], v[128:143]
  v_add_f32 v124, s60, v124
  v_add_f32 v125, s61, v125
  v_add_f32 v126, s62, v126
  v_add_f32 v127, s63, v127
  v_mfma_f32_32x32x16_f16 v[144:159], v[80:83], v[88:91], v[144:159]
  v_cvt_pk_bf16_f32 v16, v112, v113
  v_cvt_pk_bf16_f32 v17, v114, v115
  v_cvt_pk_bf16_f32 v18, v116, v117
  v_cvt_pk_bf16_f32 v19, v118, v119
  s_waitcnt lgkmcnt(8)
  v_mfma_f32_32x32x16_f16 v[144:159], v[92:95], v[84:87], v[144:159]
  v_lshlrev_b32 v112, 16, v16
  v_lshlrev_b32 v114, 16, v17
  v_lshlrev_b32 v116, 16, v18
  v_lshlrev_b32 v118, 16, v19
  ds_read_b128 v[80:83], v12 offset:2144
  ds_read_b128 v[84:87], v14 offset:1408
  ds_read_b128 v[88:91], v14 offset:3712
  ds_read_b128 v[92:95], v12 offset:96
  s_waitcnt lgkmcnt(9)
  v_mfma_f32_32x32x16_f16 v[128:143], v[96:99], v[100:103], v[128:143]
  v_and_b32 v113, 0xffff0000, v16
  v_and_b32 v115, 0xffff0000, v17
  v_and_b32 v117, 0xffff0000, v18
  v_and_b32 v119, 0xffff0000, v19
  v_mfma_f32_32x32x16_f16 v[144:159], v[96:99], v[104:107], v[144:159]
  v_cvt_pk_bf16_f32 v16, v120, v121
  v_cvt_pk_bf16_f32 v17, v122, v123
  v_cvt_pk_bf16_f32 v18, v124, v125
  v_cvt_pk_bf16_f32 v19, v126, v127
  s_waitcnt lgkmcnt(8)
  v_mfma_f32_32x32x16_f16 v[144:159], v[108:111], v[100:103], v[144:159]
  v_lshlrev_b32 v120, 16, v16
  v_lshlrev_b32 v122, 16, v17
  v_lshlrev_b32 v124, 16, v18
  v_lshlrev_b32 v126, 16, v19
  ds_read_b128 v[96:99], v12 offset:2112
  ds_read_b128 v[100:103], v14 offset:1376
  ds_read_b128 v[104:107], v14 offset:3680
  ds_read_b128 v[108:111], v12 offset:64
  s_waitcnt lgkmcnt(9)
  v_mfma_f32_32x32x16_f16 v[128:143], v[64:67], v[68:71], v[128:143]
  v_and_b32 v121, 0xffff0000, v16
  v_and_b32 v123, 0xffff0000, v17
  v_and_b32 v125, 0xffff0000, v18
  v_and_b32 v127, 0xffff0000, v19
  v_mfma_f32_32x32x16_f16 v[144:159], v[64:67], v[72:75], v[144:159]
  s_waitcnt lgkmcnt(8)
  v_mfma_f32_32x32x16_f16 v[144:159], v[76:79], v[68:71], v[144:159]
  ds_read_b128 v[64:67], v12 offset:2080
  ds_read_b128 v[68:71], v14 offset:1344
  ds_read_b128 v[72:75], v14 offset:3648
  ds_read_b128 v[76:79], v12 offset:32
  s_waitcnt lgkmcnt(9)
  v_mfma_f32_32x32x16_f16 v[128:143], v[80:83], v[84:87], v[128:143]
  v_mfma_f32_32x32x16_f16 v[144:159], v[80:83], v[88:91], v[144:159]
  s_waitcnt lgkmcnt(8)
  v_mfma_f32_32x32x16_f16 v[144:159], v[92:95], v[84:87], v[144:159]
  ds_read_b128 v[80:83], v12 offset:2048
  ds_read_b128 v[84:87], v14 offset:1312
  ds_read_b128 v[88:91], v14 offset:3616
  ds_read_b128 v[92:95], v12 offset:0
  s_waitcnt lgkmcnt(9)
  v_mfma_f32_32x32x16_f16 v[128:143], v[96:99], v[100:103], v[128:143]
  v_mfma_f32_32x32x16_f16 v[144:159], v[96:99], v[104:107], v[144:159]
  s_waitcnt lgkmcnt(8)
  v_mfma_f32_32x32x16_f16 v[144:159], v[108:111], v[100:103], v[144:159]
  s_waitcnt lgkmcnt(5)
  v_mfma_f32_32x32x16_f16 v[128:143], v[64:67], v[68:71], v[128:143]
  v_mfma_f32_32x32x16_f16 v[144:159], v[64:67], v[72:75], v[144:159]
  s_waitcnt lgkmcnt(4)
  v_mfma_f32_32x32x16_f16 v[144:159], v[76:79], v[68:71], v[144:159]
  s_waitcnt lgkmcnt(1)
  v_mfma_f32_32x32x16_f16 v[128:143], v[80:83], v[84:87], v[128:143]
  v_mfma_f32_32x32x16_f16 v[144:159], v[80:83], v[88:91], v[144:159]
  s_waitcnt lgkmcnt(0)
  v_mfma_f32_32x32x16_f16 v[144:159], v[92:95], v[84:87], v[144:159]
  s_lshl_b32 s6, s20, 12
  s_add_u32 s6, s6, 126528
  v_add_u32 v9, s6, v8
  s_xor_b32 s7, s20, 4
  s_lshl_b32 s7, s7, 12
  s_add_u32 s7, s7, 126528
  v_add_u32 v10, s7, v8
  v_bfe_u32 v11, v2, 1, 4
  v_lshlrev_b32 v11, 7, v11
  v_and_b32 v12, 1, v2
  v_lshl_add_u32 v11, v12, 3, v11
  v_lshl_add_u32 v11, v13, 4, v11
  s_mul_i32 s6, s22, 4160
  s_lshl_b32 s7, s23, 11
  s_add_u32 s6, s6, s7
  v_add_u32 v11, s6, v11
  v_lshlrev_b32 v12, 1, v5
  v_mul_u32_u24 v13, 1152, v5
  s_lshl_b32 s6, s21, 3
  v_mov_b32 v14, v15
  s_nop 3
  s_cmp_eq_u32 s23, 0
  s_cbranch_scc1 kb_mu0
  ds_write_b128 v9, v[128:131] offset:0
  ds_write_b128 v9, v[132:135] offset:1024
  ds_write_b128 v9, v[136:139] offset:2048
  ds_write_b128 v9, v[140:143] offset:3072
  s_waitcnt lgkmcnt(0)
  s_barrier
  ds_read_b128 v[176:179], v10 offset:0
  ds_read_b128 v[180:183], v10 offset:1024
  ds_read_b128 v[184:187], v10 offset:2048
  ds_read_b128 v[188:191], v10 offset:3072
  s_waitcnt lgkmcnt(3)
  v_pk_add_f32 v[160:161], v[144:145], v[176:177]
  v_pk_add_f32 v[162:163], v[146:147], v[178:179]
  s_waitcnt lgkmcnt(2)
  v_pk_add_f32 v[164:165], v[148:149], v[180:181]
  v_pk_add_f32 v[166:167], v[150:151], v[182:183]
  s_waitcnt lgkmcnt(1)
  v_pk_add_f32 v[168:169], v[152:153], v[184:185]
  v_pk_add_f32 v[170:171], v[154:155], v[186:187]
  s_waitcnt lgkmcnt(0)
  v_pk_add_f32 v[172:173], v[156:157], v[188:189]
  v_pk_add_f32 v[174:175], v[158:159], v[190:191]
  s_branch kb_j
kb_mu0:
  ds_write_b128 v9, v[144:147] offset:0
  ds_write_b128 v9, v[148:151] offset:1024
  ds_write_b128 v9, v[152:155] offset:2048
  ds_write_b128 v9, v[156:159] offset:3072
  s_waitcnt lgkmcnt(0)
  s_barrier
  ds_read_b128 v[176:179], v10 offset:0
  ds_read_b128 v[180:183], v10 offset:1024
  ds_read_b128 v[184:187], v10 offset:2048
  ds_read_b128 v[188:191], v10 offset:3072
  s_waitcnt lgkmcnt(3)
  v_pk_add_f32 v[160:161], v[128:129], v[176:177]
  v_pk_add_f32 v[162:163], v[130:131], v[178:179]
  s_waitcnt lgkmcnt(2)
  v_pk_add_f32 v[164:165], v[132:133], v[180:181]
  v_pk_add_f32 v[166:167], v[134:135], v[182:183]
  s_waitcnt lgkmcnt(1)
  v_pk_add_f32 v[168:169], v[136:137], v[184:185]
  v_pk_add_f32 v[170:171], v[138:139], v[186:187]
  s_waitcnt lgkmcnt(0)
  v_pk_add_f32 v[172:173], v[140:141], v[188:189]
  v_pk_add_f32 v[174:175], v[142:143], v[190:191]
kb_j:
  v_pk_mul_f32 v[160:161], v[160:161], v[14:15]
  v_pk_mul_f32 v[162:163], v[162:163], v[14:15]
  v_pk_mul_f32 v[164:165], v[164:165], v[14:15]
  v_pk_mul_f32 v[166:167], v[166:167], v[14:15]
  v_pk_mul_f32 v[168:169], v[168:169], v[14:15]
  v_pk_mul_f32 v[170:171], v[170:171], v[14:15]
  v_pk_mul_f32 v[172:173], v[172:173], v[14:15]
  v_pk_mul_f32 v[174:175], v[174:175], v[14:15]
  v_cvt_pk_bf16_f32 v176, v160, v161
  v_cvt_pk_bf16_f32 v177, v162, v163
  v_cvt_pk_bf16_f32 v178, v164, v165
  v_cvt_pk_bf16_f32 v179, v166, v167
  v_cvt_pk_bf16_f32 v180, v168, v169
  v_cvt_pk_bf16_f32 v181, v170, v171
  v_cvt_pk_bf16_f32 v182, v172, v173
  v_cvt_pk_bf16_f32 v183, v174, v175
  ds_write_b64 v11, v[176:177] offset:0
  ds_write_b64 v11, v[178:179] offset:32
  ds_write_b64 v11, v[180:181] offset:64
  ds_write_b64 v11, v[182:183] offset:96
  s_waitcnt lgkmcnt(0)
  s_barrier
  ds_read_b32 v152, v12 offset:0
  ds_read_b32 v153, v12 offset:64
  ds_read_b32 v154, v12 offset:4160
  ds_read_b32 v155, v12 offset:4224
  ds_read_b32 v156, v12 offset:8320
  ds_read_b32 v157, v12 offset:8384
  ds_read_b32 v158, v12 offset:12480
  ds_read_b32 v159, v12 offset:12544
  s_waitcnt lgkmcnt(0)
  v_lshlrev_b32 v128, 16, v152
  v_lshlrev_b32 v129, 16, v154
  v_lshlrev_b32 v130, 16, v156
  v_lshlrev_b32 v131, 16, v158
  v_and_b32 v132, 0xffff0000, v152
  v_and_b32 v133, 0xffff0000, v154
  v_and_b32 v134, 0xffff0000, v156
  v_and_b32 v135, 0xffff0000, v158
  v_pk_add_f32 v[128:129], v[128:129], v[32:33]
  v_pk_add_f32 v[130:131], v[130:131], v[34:35]
  v_pk_add_f32 v[132:133], v[132:133], v[36:37]
  v_pk_add_f32 v[134:135], v[134:135], v[38:39]
  v_cvt_pk_bf16_f32 v16, v128, v129
  v_cvt_pk_bf16_f32 v17, v130, v131
  v_cvt_pk_bf16_f32 v18, v132, v133
  v_cvt_pk_bf16_f32 v19, v134, v135
  v_lshlrev_b32 v128, 16, v16
  v_lshlrev_b32 v130, 16, v17
  v_lshlrev_b32 v132, 16, v18
  v_lshlrev_b32 v134, 16, v19
  v_and_b32 v129, 0xffff0000, v16
  v_and_b32 v131, 0xffff0000, v17
  v_and_b32 v133, 0xffff0000, v18
  v_and_b32 v135, 0xffff0000, v19
  v_pk_add_f32 v[128:129], v[128:129], v[48:49]
  v_pk_add_f32 v[130:131], v[130:131], v[50:51]
  v_pk_add_f32 v[132:133], v[132:133], v[52:53]
  v_pk_add_f32 v[134:135], v[134:135], v[54:55]
  v_cvt_pk_bf16_f32 v16, v128, v129
  v_cvt_pk_bf16_f32 v17, v130, v131
  v_cvt_pk_bf16_f32 v18, v132, v133
  v_cvt_pk_bf16_f32 v19, v134, v135
  v_lshlrev_b32 v128, 16, v16
  v_lshlrev_b32 v130, 16, v17
  v_lshlrev_b32 v132, 16, v18
  v_lshlrev_b32 v134, 16, v19
  v_and_b32 v129, 0xffff0000, v16
  v_and_b32 v131, 0xffff0000, v17
  v_and_b32 v133, 0xffff0000, v18
  v_and_b32 v135, 0xffff0000, v19
  v_pk_add_f32 v[128:129], v[128:129], v[112:113]
  v_pk_add_f32 v[130:131], v[130:131], v[114:115]
  v_pk_add_f32 v[132:133], v[132:133], v[120:121]
  v_pk_add_f32 v[134:135], v[134:135], v[122:123]
  v_cvt_pk_bf16_f32 v172, v128, v129
  v_cvt_pk_bf16_f32 v173, v130, v131
  s_add_u32 s7, s6, 0
  buffer_store_dwordx2 v[172:173], v13, s[12:15], s7 offen
  v_cvt_pk_bf16_f32 v174, v132, v133
  v_cvt_pk_bf16_f32 v175, v134, v135
  s_add_u32 s7, s6, 1152
  buffer_store_dwordx2 v[174:175], v13, s[12:15], s7 offen
  v_lshlrev_b32 v136, 16, v153
  v_lshlrev_b32 v137, 16, v155
  v_lshlrev_b32 v138, 16, v157
  v_lshlrev_b32 v139, 16, v159
  v_and_b32 v140, 0xffff0000, v153
  v_and_b32 v141, 0xffff0000, v155
  v_and_b32 v142, 0xffff0000, v157
  v_and_b32 v143, 0xffff0000, v159
  v_pk_add_f32 v[136:137], v[136:137], v[40:41]
  v_pk_add_f32 v[138:139], v[138:139], v[42:43]
  v_pk_add_f32 v[140:141], v[140:141], v[44:45]
  v_pk_add_f32 v[142:143], v[142:143], v[46:47]
  v_cvt_pk_bf16_f32 v16, v136, v137
  v_cvt_pk_bf16_f32 v17, v138, v139
  v_cvt_pk_bf16_f32 v18, v140, v141
  v_cvt_pk_bf16_f32 v19, v142, v143
  v_lshlrev_b32 v136, 16, v16
  v_lshlrev_b32 v138, 16, v17
  v_lshlrev_b32 v140, 16, v18
  v_lshlrev_b32 v142, 16, v19
  v_and_b32 v137, 0xffff0000, v16
  v_and_b32 v139, 0xffff0000, v17
  v_and_b32 v141, 0xffff0000, v18
  v_and_b32 v143, 0xffff0000, v19
  v_pk_add_f32 v[136:137], v[136:137], v[56:57]
  v_pk_add_f32 v[138:139], v[138:139], v[58:59]
  v_pk_add_f32 v[140:141], v[140:141], v[60:61]
  v_pk_add_f32 v[142:143], v[142:143], v[62:63]
  v_cvt_pk_bf16_f32 v16, v136, v137
  v_cvt_pk_bf16_f32 v17, v138, v139
  v_cvt_pk_bf16_f32 v18, v140, v141
  v_cvt_pk_bf16_f32 v19, v142, v143
  v_lshlrev_b32 v136, 16, v16
  v_lshlrev_b32 v138, 16, v17
  v_lshlrev_b32 v140, 16, v18
  v_lshlrev_b32 v142, 16, v19
  v_and_b32 v137, 0xffff0000, v16
  v_and_b32 v139, 0xffff0000, v17
  v_and_b32 v141, 0xffff0000, v18
  v_and_b32 v143, 0xffff0000, v19
  v_pk_add_f32 v[136:137], v[136:137], v[116:117]
  v_pk_add_f32 v[138:139], v[138:139], v[118:119]
  v_pk_add_f32 v[140:141], v[140:141], v[124:125]
  v_pk_add_f32 v[142:143], v[142:143], v[126:127]
  v_cvt_pk_bf16_f32 v176, v136, v137
  v_cvt_pk_bf16_f32 v177, v138, v139
  s_add_u32 s7, s6, 36864
  buffer_store_dwordx2 v[176:177], v13, s[12:15], s7 offen
  v_cvt_pk_bf16_f32 v178, v140, v141
  v_cvt_pk_bf16_f32 v179, v142, v143
  s_add_u32 s7, s6, 38016
  buffer_store_dwordx2 v[178:179], v13, s[12:15], s7 offen
kb_end:
  s_endpgm

k_code_end:
  s_endpgm
.section .rodata,"a"
.p2align 6
.amdhsa_kernel ka_kernel
  .amdhsa_next_free_vgpr 512
  .amdhsa_next_free_sgpr 102
  .amdhsa_accum_offset 256
  .amdhsa_group_segment_fixed_size 0
  .amdhsa_kernarg_size 136
  .amdhsa_user_sgpr_count 2
  .amdhsa_user_sgpr_kernarg_segment_ptr 1
  .amdhsa_system_sgpr_workgroup_id_x 1
  .amdhsa_float_denorm_mode_32 3
  .amdhsa_float_denorm_mode_16_64 3
.end_amdhsa_kernel

.p2align 6
.amdhsa_kernel kb_kernel
  .amdhsa_next_free_vgpr 256
  .amdhsa_next_free_sgpr 102
  .amdhsa_accum_offset 256
  .amdhsa_group_segment_fixed_size 0
  .amdhsa_kernarg_size 136
  .amdhsa_user_sgpr_count 2
  .amdhsa_user_sgpr_kernarg_segment_ptr 1
  .amdhsa_system_sgpr_workgroup_id_x 1
  .amdhsa_float_denorm_mode_32 3
  .amdhsa_float_denorm_mode_16_64 3
.end_amdhsa_kernel
```
